```python
import torch

def _softmax(x, axis=-1):
    return torch.softmax(x, dim=axis)

def _gelu(x):
    return torch.nn.functional.gelu(x, approximate='tanh')

def _silu(x):
    return torch.nn.functional.silu(x)

def _sigmoid(x):
    return torch.sigmoid(x)

def _layernorm(x, axis=-1, eps=1e-05):
    m = x.mean(dim=axis, keepdim=True)
    v = x.var(dim=axis, keepdim=True, unbiased=False)
    return (x - m) / torch.sqrt(v + eps)

def _scatter_add(tgt, idx, src, axis=0):
    return tgt.clone().index_add_(axis, idx, src)

def _segment_sum(src, seg, n):
    out = torch.zeros((n,) + src.shape[1:], dtype=src.dtype)
    return out.index_add_(0, seg, src)

def _pad(x, pw):
    flat = tuple((v for pair in reversed(pw) for v in pair))
    return torch.nn.functional.pad(x, flat)
kernel_name = 'standalone__swin_window_attn__vision'

def setup_inputs():

    _w = lambda a: (lambda t: t.to(torch.bfloat16) if t.is_floating_point() else t)(torch.as_tensor(a))
    H = W = 256 // 7 * 7
    C, win = (384, 7)
    return {'x': _w((lambda *s: torch.randn(*s, dtype=torch.bfloat16) * 0.2)(1, H, W, C)), 'wqkv': _w((lambda *s: torch.randn(*s, dtype=torch.bfloat16) * 0.2)(C, 3 * C)), 'wo': _w((lambda *s: torch.randn(*s, dtype=torch.bfloat16) * 0.05)(C, C))}

def reference(x, wqkv, wo):
    B, H, W, C = x.shape
    win = 7
    nh, nw = (H // win, W // win)
    xw = (lambda x, *d: x.permute(*d))(x.reshape(B, nh, win, nw, win, C), 0, 1, 3, 2, 4, 5)
    xw = xw.reshape(B * nh * nw, win * win, C)
    qkv = xw @ wqkv
    q, k, v = (qkv[..., :C].clone(), qkv[..., C:2 * C].clone(), qkv[..., 2 * C:].clone())
    scale = C ** (-0.5)
    p = _softmax(torch.einsum('bqc,bkc->bqk', q, k) * scale, axis=-1)
    o = torch.einsum('bqk,bkc->bqc', p, v) @ wo
    o = (lambda x, *d: x.permute(*d))(o.reshape(B, nh, nw, win, win, C), 0, 1, 3, 2, 4, 5)
    return o.reshape(B, H, W, C)
```

```asm
; @launch grid=(256,1,1) block=(256,1,1) lds=163840
.amdgcn_target "amdgcn-amd-amdhsa--gfx950"
.text
.globl standalone__swin_window_attn__vision_kernel
.p2align 8
.type standalone__swin_window_attn__vision_kernel,@function
standalone__swin_window_attn__vision_kernel:
    s_cmp_ge_u32 s2, 256
    s_cbranch_scc1 L_end
    s_load_dwordx8 s[24:31], s[0:1], 0
    s_load_dwordx4 s[32:35], s[0:1], 32
    v_lshrrev_b32 v23, 6, v0
    v_and_b32 v20, 63, v0
    v_readfirstlane_b32 s16, v23
    v_and_b32 v21, 15, v20
    v_lshrrev_b32 v22, 4, v20
    v_lshrrev_b32 v32, 2, v21
    v_lshlrev_b32 v1, 4, v20
    v_lshlrev_b32 v28, 4, v22
    v_mov_b32 v43, 0
L_pc0:
    s_getpc_b64 s[36:37]
    s_lshr_b32 s40, s2, 3
    s_lshl_b32 s40, s40, 2
    s_add_u32 s40, s40, s16
    s_and_b32 s40, s40, 7
    s_lshl_b32 s40, s40, 13
    v_lshlrev_b32 v23, 7, v20
    v_add_u32 v23, s40, v23
    v_min_u32 v23, L_end - L_pc0, v23
    s_cmp_lt_u32 s2, 0
    s_cbranch_scc1 L_nopf
    global_load_dword v42, v23, s[36:37]
L_nopf:
    s_sub_u32 s40, s2, 96
    s_sub_u32 s41, s2, 144
    s_cmp_lt_u32 s2, 144
    s_cselect_b32 s40, s40, s41
    s_mul_i32 s41, s40, 171
    s_lshr_b32 s41, s41, 11
    s_mul_i32 s42, s41, 12
    s_sub_u32 s42, s40, s42
    s_add_u32 s43, s41, 8
    s_cmp_lt_u32 s2, 144
    s_cselect_b32 s41, s42, s41
    s_cselect_b32 s42, s43, s42
    s_lshr_b32 s45, s2, 1
    s_mul_i32 s43, s45, 32
    s_lshr_b32 s43, s43, 8
    s_mul_i32 s44, s43, 8
    s_sub_u32 s44, s45, s44
    s_lshl_b32 s43, s43, 1
    s_and_b32 s45, s2, 1
    s_add_u32 s43, s43, s45
    s_cmp_lt_u32 s2, 96
    s_cselect_b32 s41, s43, s41
    s_cselect_b32 s42, s44, s42
    v_lshlrev_b32 v23, 3, v32
    v_and_b32 v24, 3, v21
    v_add_u32 v23, v23, v24
    s_mul_i32 s43, s16, 192
    v_mul_u32_u24 v33, 2304, v23
    v_add3_u32 v33, v33, v28, s43
    s_cmp_ge_u32 s2, 144
    s_cbranch_scc1 L_ldN
    s_mul_i32 s44, s41, 73728
    s_mul_i32 s45, s42, 73728
    s_add_u32 s45, s45, 768
    v_add_u32 v34, s44, v33
    v_add_u32 v36, s45, v33
    v_add_u32 v35, 9216, v34
    v_add_u32 v37, 9216, v36
    s_waitcnt lgkmcnt(0)
    global_load_dwordx4 v[48:51], v34, s[26:27]
    global_load_dwordx4 v[96:99], v36, s[26:27]
    global_load_dwordx4 v[60:63], v35, s[26:27]
    global_load_dwordx4 v[108:111], v37, s[26:27]
    global_load_dwordx4 v[52:55], v34, s[26:27] offset:64
    global_load_dwordx4 v[100:103], v36, s[26:27] offset:64
    global_load_dwordx4 v[64:67], v35, s[26:27] offset:64
    global_load_dwordx4 v[112:115], v37, s[26:27] offset:64
    global_load_dwordx4 v[56:59], v34, s[26:27] offset:128
    global_load_dwordx4 v[104:107], v36, s[26:27] offset:128
    global_load_dwordx4 v[68:71], v35, s[26:27] offset:128
    global_load_dwordx4 v[116:119], v37, s[26:27] offset:128
    s_branch L_ldx
L_ldN:
    s_cmp_lt_u32 s2, 216
    s_cbranch_scc1 L_ldN1
    s_waitcnt lgkmcnt(0)
    global_load_dword v42, v1, s[26:27]
    s_branch L_ldx
L_ldN1:
    s_mul_i32 s44, s41, 147456
    s_add_u32 s44, s44, 1536
    v_add_u32 v34, s44, v33
    v_add_u32 v35, 9216, v34
    v_add_u32 v36, 73728, v34
    v_add_u32 v37, 82944, v34
    v_lshrrev_b32 v23, 2, v20
    v_mul_u32_u24 v38, 768, v23
    v_and_b32 v24, 3, v20
    v_lshlrev_b32 v24, 4, v24
    s_mul_i32 s45, s16, 73728
    s_lshl_b32 s46, s42, 6
    s_add_u32 s45, s45, s46
    v_add3_u32 v38, v38, v24, s45
    s_mul_i32 s46, s16, 6144
    s_waitcnt lgkmcnt(0)
    s_add_u32 m0, s46, 32768
    s_nop 0
    global_load_lds_dwordx4 v38, s[28:29]
    v_add_u32 v38, 12288, v38
    s_add_u32 m0, s46, 33792
    s_nop 0
    global_load_lds_dwordx4 v38, s[28:29]
    v_add_u32 v38, 12288, v38
    s_add_u32 m0, s46, 34816
    s_nop 0
    global_load_lds_dwordx4 v38, s[28:29]
    v_add_u32 v38, 12288, v38
    s_add_u32 m0, s46, 35840
    s_nop 0
    global_load_lds_dwordx4 v38, s[28:29]
    v_add_u32 v38, 12288, v38
    s_add_u32 m0, s46, 36864
    s_nop 0
    global_load_lds_dwordx4 v38, s[28:29]
    v_add_u32 v38, 12288, v38
    s_add_u32 m0, s46, 37888
    s_nop 0
    global_load_lds_dwordx4 v38, s[28:29]
    v_lshlrev_b32 v39, 3, v22
    v_add_u32 v39, v39, v32
    v_lshlrev_b32 v39, 6, v39
    v_and_b32 v23, 3, v21
    v_lshlrev_b32 v23, 4, v23
    s_add_u32 s46, s46, 32768
    v_add3_u32 v39, v39, v23, s46
    global_load_dwordx4 v[48:51], v34, s[26:27]
    global_load_dwordx4 v[60:63], v35, s[26:27]
    global_load_dwordx4 v[72:75], v36, s[26:27]
    global_load_dwordx4 v[84:87], v37, s[26:27]
    global_load_dwordx4 v[52:55], v34, s[26:27] offset:64
    global_load_dwordx4 v[64:67], v35, s[26:27] offset:64
    global_load_dwordx4 v[76:79], v36, s[26:27] offset:64
    global_load_dwordx4 v[88:91], v37, s[26:27] offset:64
    global_load_dwordx4 v[56:59], v34, s[26:27] offset:128
    global_load_dwordx4 v[68:71], v35, s[26:27] offset:128
    global_load_dwordx4 v[80:83], v36, s[26:27] offset:128
    global_load_dwordx4 v[92:95], v37, s[26:27] offset:128
L_ldx:
    s_mul_i32 s47, s2, 5
    s_add_u32 s48, s47, s16
    s_mul_i32 s49, s48, 1821
    s_lshr_b32 s49, s49, 16
    s_mul_i32 s49, s49, 1161216
    s_mul_i32 s3, s48, 5376
    s_add_u32 s49, s49, s3
    s_mov_b32 s18, 188160
    s_mov_b32 s4, s24
    s_and_b32 s5, s25, 0xffff
    s_mov_b32 s6, 48771072
    s_mov_b32 s7, 0x20000
    s_mov_b32 s8, s30
    s_and_b32 s9, s31, 0xffff
    s_mov_b32 s10, 48771072
    s_mov_b32 s11, 0x20000
    v_add_u32 v27, 0, v21
    v_mul_u32_u24 v23, 37, v27
    v_lshrrev_b32 v23, 8, v23
    v_mul_u32_u24 v24, 768, v27
    v_mad_u32_u24 v23, v23, s18, v24
    v_add3_u32 v6, v23, s49, v28
    v_add_u32 v27, 16, v21
    v_mul_u32_u24 v23, 37, v27
    v_lshrrev_b32 v23, 8, v23
    v_mul_u32_u24 v24, 768, v27
    v_mad_u32_u24 v23, v23, s18, v24
    v_add3_u32 v7, v23, s49, v28
    v_add_u32 v27, 32, v21
    v_mul_u32_u24 v23, 37, v27
    v_lshrrev_b32 v23, 8, v23
    v_mul_u32_u24 v24, 768, v27
    v_mad_u32_u24 v23, v23, s18, v24
    v_add3_u32 v8, v23, s49, v28
    s_mul_i32 s60, s2, 205
    s_lshr_b32 s60, s60, 10
    s_mul_i32 s61, s60, 5
    s_sub_u32 s61, s2, s61
    s_add_u32 s60, s60, 1280
    s_cmp_lt_u32 s2, 80
    s_cselect_b64 s[62:63], -1, 0
    s_cmp_eq_u32 s61, 0
    s_cselect_b64 s[64:65], -1, 0
    s_mul_i32 s61, s61, 10
    s_sub_u32 s61, s61, 3
    s_cmp_eq_u32 s16, 3
    s_cselect_b64 s[38:39], -1, 0
    s_add_u32 s48, s47, 4
    v_and_b32 v24, 3, v21
    v_cmp_eq_u32 s[50:51], 0, v24
    v_cmp_eq_u32 s[52:53], 1, v21
    v_cmp_eq_u32 s[54:55], 2, v21
    v_mov_b32 v26, s60
    v_add_u32 v23, s47, v32
    v_mov_b32 v25, s48
    v_cndmask_b32 v26, v26, v23, s[50:51]
    v_cndmask_b32 v26, v26, v25, s[52:53]
    v_sub_u32 v27, v21, v32
    v_add_u32 v27, s61, v27
    s_or_b64 s[50:51], s[50:51], s[52:53]
    s_or_b64 s[56:57], s[50:51], s[54:55]
    v_cmp_gt_u32 s[66:67], 48, v27
    v_mov_b32 v25, 48
    v_cndmask_b32 v27, v27, v25, s[56:57]
    s_andn2_b64 s[66:67], s[66:67], s[56:57]
    s_or_b64 s[56:57], s[66:67], s[54:55]
    s_and_b64 s[56:57], s[56:57], s[62:63]
    s_or_b64 s[56:57], s[56:57], s[50:51]
    s_and_b64 s[54:55], s[54:55], s[64:65]
    s_or_b64 s[54:55], s[54:55], s[66:67]
    s_and_b64 s[54:55], s[54:55], s[62:63]
    v_mul_u32_u24 v23, 1821, v26
    v_lshrrev_b32 v23, 16, v23
    s_mov_b32 s3, 1161216
    v_mul_u32_u24 v24, 5376, v26
    v_mad_u32_u24 v25, v23, s3, v24
    v_mul_u32_u24 v23, 37, v27
    v_lshrrev_b32 v23, 8, v23
    v_mul_u32_u24 v24, 768, v27
    v_mad_u32_u24 v23, v23, s18, v24
    v_add3_u32 v30, v23, v25, v28
    v_mov_b32 v29, 2147479552
    v_cndmask_b32 v31, v29, v30, s[56:57]
    s_mul_i32 s49, s48, 1821
    s_lshr_b32 s49, s49, 16
    s_mul_i32 s49, s49, 1161216
    s_mul_i32 s3, s48, 5376
    s_add_u32 s49, s49, s3
    s_lshl_b32 s56, s16, 4
    v_add_u32 v27, s56, v21
    v_mul_u32_u24 v23, 37, v27
    v_lshrrev_b32 v23, 8, v23
    v_mul_u32_u24 v24, 768, v27
    v_mad_u32_u24 v23, v23, s18, v24
    v_add3_u32 v30, v23, s49, v28
    v_cndmask_b32 v9, v30, v31, s[38:39]
    s_mul_i32 s17, s16, 6144
    s_add_u32 s17, s17, 3072
    v_add_u32 v4, s17, v1
    v_add_u32 v4, 49152, v4
    v_add_u32 v2, 65536, v1
    v_add_u32 v3, 131072, v1
    s_orn2_b64 s[56:57], s[52:53], s[38:39]
    v_cndmask_b32 v11, v29, v9, s[56:57]
    s_lshl_b32 s50, s16, 2
    v_cmp_eq_u32 s[52:53], s50, v21
    s_nop 1
    v_cndmask_b32 v10, v29, v31, s[52:53]
    s_lshr_b32 s50, s16, 1
    s_and_b32 s51, s16, 1
    s_lshl_b32 s56, s50, 6
    s_lshl_b32 s57, s51, 3
    s_add_u32 s56, s56, s57
    v_add_u32 v23, s56, v31
    v_cndmask_b32 v17, v29, v23, s[54:55]
    s_lshl_b32 s56, s50, 11
    s_add_u32 s56, s56, s57
    s_add_u32 s56, s56, 147456
    v_add_u32 v13, s56, v1
    s_mul_i32 s56, s16, 12288
    v_add_u32 v5, s56, v1
    s_add_u32 s56, s16, 1
    s_and_b32 s56, s56, 3
    s_mul_i32 s56, s56, 12288
    s_add_u32 s56, s56, 98304
    v_add_u32 v12, s56, v1
    s_mov_b32 s57, 147456
    s_cmp_eq_u32 s16, 3
    s_cselect_b32 s57, s57, 0x40000
    v_add_u32 v14, s57, v1
    v_mov_b32 v15, 0xff800000
    v_cmp_eq_u32 s[20:21], s16, v22
    v_cmp_eq_u32 s[22:23], 0, v22
    s_mov_b32 s19, 1033291584
    s_mul_i32 s49, s60, 1821
    s_lshr_b32 s49, s49, 16
    s_mul_i32 s49, s49, 1161216
    s_mul_i32 s3, s60, 5376
    s_add_u32 s49, s49, s3
    s_min_u32 s56, s16, 2
    s_mul_i32 s66, s56, 12288
    s_add_u32 s66, s66, 110592
    s_lshl_b32 s56, s56, 4
    v_add_u32 v27, s56, v21
    v_mul_u32_u24 v23, 37, v27
    v_lshrrev_b32 v23, 8, v23
    v_mul_u32_u24 v24, 768, v27
    v_mad_u32_u24 v23, v23, s18, v24
    v_add3_u32 v30, v23, s49, v28
    v_cndmask_b32 v16, v29, v30, s[62:63]
    s_mul_i32 s56, s16, 3072
    v_and_b32 v23, 3, v21
    v_lshlrev_b32 v23, 8, v23
    v_lshlrev_b32 v24, 2, v22
    v_add_u32 v24, v24, v32
    v_lshlrev_b32 v24, 4, v24
    s_add_u32 s57, s56, 98304
    v_add3_u32 v18, v23, v24, s57
    s_lshl_b32 s56, s16, 10
    s_add_u32 s56, s56, 110592
    v_add_u32 v19, s56, v1
    s_add_u32 s14, s34, 299008
    s_addc_u32 s15, s35, 0
    s_mov_b64 s[62:63], s[52:53]
    s_and_b64 s[64:65], s[52:53], s[20:21]
    s_andn2_b64 s[60:61], s[22:23], s[52:53]
    s_lshl_b32 s56, s16, 12
    v_lshlrev_b32 v0, 6, v20
    v_add_u32 v0, s56, v0
    s_cmp_ge_u32 s2, 72
    s_cbranch_scc1 L_c1
    s_cmp_eq_u32 s16, 0
    s_cbranch_scc1 L_c2
    buffer_load_dwordx4 a[0:3], v6, s[4:7], 0 offen
    buffer_load_dwordx4 a[4:7], v6, s[4:7], 0 offen offset:64
    buffer_load_dwordx4 a[48:51], v7, s[4:7], 0 offen
    buffer_load_dwordx4 a[52:55], v7, s[4:7], 0 offen offset:64
    buffer_load_dwordx4 a[96:99], v8, s[4:7], 0 offen
    buffer_load_dwordx4 a[100:103], v8, s[4:7], 0 offen offset:64
    buffer_load_dwordx4 a[144:147], v9, s[4:7], 0 offen
    buffer_load_dwordx4 a[148:151], v9, s[4:7], 0 offen offset:64
    s_waitcnt vmcnt(8)
    s_branch L_c3
L_c2:
    s_waitcnt vmcnt(0)
    s_branch L_c3
L_c1:
    s_waitcnt vmcnt(7)
    buffer_load_dwordx4 a[0:3], v6, s[4:7], 0 offen
    s_waitcnt vmcnt(7)
    buffer_load_dwordx4 a[4:7], v6, s[4:7], 0 offen offset:64
    s_waitcnt vmcnt(7)
    buffer_load_dwordx4 a[48:51], v7, s[4:7], 0 offen
    s_waitcnt vmcnt(7)
    buffer_load_dwordx4 a[52:55], v7, s[4:7], 0 offen offset:64
    s_waitcnt vmcnt(7)
    buffer_load_dwordx4 a[96:99], v8, s[4:7], 0 offen
    s_waitcnt vmcnt(7)
    buffer_load_dwordx4 a[100:103], v8, s[4:7], 0 offen offset:64
    s_waitcnt vmcnt(7)
    buffer_load_dwordx4 a[144:147], v9, s[4:7], 0 offen
    s_waitcnt vmcnt(7)
    buffer_load_dwordx4 a[148:151], v9, s[4:7], 0 offen offset:64
    buffer_load_dwordx4 a[8:11], v6, s[4:7], 0 offen offset:128
    buffer_load_dwordx4 a[12:15], v6, s[4:7], 0 offen offset:192
    buffer_load_dwordx4 a[56:59], v7, s[4:7], 0 offen offset:128
    buffer_load_dwordx4 a[60:63], v7, s[4:7], 0 offen offset:192
    buffer_load_dwordx4 a[104:107], v8, s[4:7], 0 offen offset:128
    buffer_load_dwordx4 a[108:111], v8, s[4:7], 0 offen offset:192
    buffer_load_dwordx4 a[152:155], v9, s[4:7], 0 offen offset:128
    buffer_load_dwordx4 a[156:159], v9, s[4:7], 0 offen offset:192
    buffer_load_dwordx4 a[16:19], v6, s[4:7], 0 offen offset:256
    buffer_load_dwordx4 a[20:23], v6, s[4:7], 0 offen offset:320
    buffer_load_dwordx4 a[64:67], v7, s[4:7], 0 offen offset:256
    buffer_load_dwordx4 a[68:71], v7, s[4:7], 0 offen offset:320
    s_waitcnt vmcnt(20)
L_c3:
    s_cmp_ge_u32 s2, 216
    s_cbranch_scc1 L_role
    s_cmp_ge_u32 s2, 144
    s_cbranch_scc1 L_cN
    s_lshl_b32 s56, s16, 13
    v_add_u32 v40, s56, v1
    v_mfma_f32_16x16x32_bf16 v[120:123], v[48:51], v[96:99], 0
    v_mfma_f32_16x16x32_bf16 v[124:127], v[60:63], v[96:99], 0
    v_mfma_f32_16x16x32_bf16 v[128:131], v[48:51], v[108:111], 0
    v_mfma_f32_16x16x32_bf16 v[132:135], v[60:63], v[108:111], 0
    v_mfma_f32_16x16x32_bf16 v[120:123], v[52:55], v[100:103], v[120:123]
    v_mfma_f32_16x16x32_bf16 v[124:127], v[64:67], v[100:103], v[124:127]
    v_mfma_f32_16x16x32_bf16 v[128:131], v[52:55], v[112:115], v[128:131]
    v_mfma_f32_16x16x32_bf16 v[132:135], v[64:67], v[112:115], v[132:135]
    v_mfma_f32_16x16x32_bf16 v[120:123], v[56:59], v[104:107], v[120:123]
    v_mfma_f32_16x16x32_bf16 v[124:127], v[68:71], v[104:107], v[124:127]
    v_mfma_f32_16x16x32_bf16 v[128:131], v[56:59], v[116:119], v[128:131]
    v_mfma_f32_16x16x32_bf16 v[132:135], v[68:71], v[116:119], v[132:135]
    s_nop 4
    ds_write_b128 v40, v[120:123]
    ds_write_b128 v40, v[124:127] offset:1024
    ds_write_b128 v40, v[128:131] offset:2048
    ds_write_b128 v40, v[132:135] offset:3072
    s_waitcnt lgkmcnt(0)
    s_barrier
    s_branch L_role
L_cN:
    s_lshl_b32 s56, s16, 13
    v_add_u32 v40, s56, v1
    ds_read_b64_tr_b16 v[96:97], v39
    ds_read_b64_tr_b16 v[98:99], v39 offset:256
    ds_read_b64_tr_b16 v[108:109], v39 offset:8
    ds_read_b64_tr_b16 v[110:111], v39 offset:264
    ds_read_b64_tr_b16 v[100:101], v39 offset:2048
    ds_read_b64_tr_b16 v[102:103], v39 offset:2304
    ds_read_b64_tr_b16 v[112:113], v39 offset:2056
    ds_read_b64_tr_b16 v[114:115], v39 offset:2312
    ds_read_b64_tr_b16 v[104:105], v39 offset:4096
    ds_read_b64_tr_b16 v[106:107], v39 offset:4352
    ds_read_b64_tr_b16 v[116:117], v39 offset:4104
    ds_read_b64_tr_b16 v[118:119], v39 offset:4360
    s_waitcnt lgkmcnt(10)
    v_mfma_f32_16x16x32_bf16 v[120:123], v[48:51], v[96:99], 0
    v_mfma_f32_16x16x32_bf16 v[124:127], v[60:63], v[96:99], 0
    s_waitcnt lgkmcnt(8)
    v_mfma_f32_16x16x32_bf16 v[128:131], v[48:51], v[108:111], 0
    v_mfma_f32_16x16x32_bf16 v[132:135], v[60:63], v[108:111], 0
    v_mfma_f32_16x16x32_bf16 v[136:139], v[72:75], v[96:99], 0
    v_mfma_f32_16x16x32_bf16 v[140:143], v[84:87], v[96:99], 0
    v_mfma_f32_16x16x32_bf16 v[144:147], v[72:75], v[108:111], 0
    v_mfma_f32_16x16x32_bf16 v[148:151], v[84:87], v[108:111], 0
    s_waitcnt lgkmcnt(6)
    v_mfma_f32_16x16x32_bf16 v[120:123], v[52:55], v[100:103], v[120:123]
    v_mfma_f32_16x16x32_bf16 v[124:127], v[64:67], v[100:103], v[124:127]
    s_waitcnt lgkmcnt(4)
    v_mfma_f32_16x16x32_bf16 v[128:131], v[52:55], v[112:115], v[128:131]
    v_mfma_f32_16x16x32_bf16 v[132:135], v[64:67], v[112:115], v[132:135]
    v_mfma_f32_16x16x32_bf16 v[136:139], v[76:79], v[100:103], v[136:139]
    v_mfma_f32_16x16x32_bf16 v[140:143], v[88:91], v[100:103], v[140:143]
    v_mfma_f32_16x16x32_bf16 v[144:147], v[76:79], v[112:115], v[144:147]
    v_mfma_f32_16x16x32_bf16 v[148:151], v[88:91], v[112:115], v[148:151]
    s_waitcnt lgkmcnt(2)
    v_mfma_f32_16x16x32_bf16 v[120:123], v[56:59], v[104:107], v[120:123]
    v_mfma_f32_16x16x32_bf16 v[124:127], v[68:71], v[104:107], v[124:127]
    s_waitcnt lgkmcnt(0)
    v_mfma_f32_16x16x32_bf16 v[128:131], v[56:59], v[116:119], v[128:131]
    v_mfma_f32_16x16x32_bf16 v[132:135], v[68:71], v[116:119], v[132:135]
    v_mfma_f32_16x16x32_bf16 v[136:139], v[80:83], v[104:107], v[136:139]
    v_mfma_f32_16x16x32_bf16 v[140:143], v[92:95], v[104:107], v[140:143]
    v_mfma_f32_16x16x32_bf16 v[144:147], v[80:83], v[116:119], v[144:147]
    v_mfma_f32_16x16x32_bf16 v[148:151], v[92:95], v[116:119], v[148:151]
    ds_write_b128 v40, v[120:123]
    ds_write_b128 v40, v[124:127] offset:1024
    s_nop 0
    ds_write_b128 v40, v[128:131] offset:2048
    ds_write_b128 v40, v[132:135] offset:3072
    ds_write_b128 v40, v[136:139] offset:4096
    ds_write_b128 v40, v[140:143] offset:5120
    ds_write_b128 v40, v[144:147] offset:6144
    ds_write_b128 v40, v[148:151] offset:7168
    s_waitcnt lgkmcnt(0)
    s_barrier
L_role:
    s_cmp_lg_u32 s16, 0
    s_cbranch_scc1 L_others
    s_cmp_ge_u32 s2, 216
    s_cbranch_scc1 L_poll0
    s_cmp_ge_u32 s2, 144
    s_cbranch_scc1 L_rN
    s_lshr_b32 s44, s41, 1
    s_mul_i32 s45, s44, 8
    s_add_u32 s45, s45, s42
    s_lshl_b32 s45, s45, 2
    s_mul_i32 s46, s42, 24
    s_lshl_b32 s44, s44, 2
    s_add_u32 s46, s46, s44
    s_cmp_lt_u32 s42, 8
    s_cselect_b32 s45, s45, s46
    s_and_b32 s44, s41, 1
    s_add_u32 s45, s45, s44
    s_lshl_b32 s45, s45, 10
    v_add_u32 v41, s45, v1
    ds_read_b128 v[48:51], v1
    ds_read_b128 v[52:55], v1 offset:8192
    ds_read_b128 v[56:59], v1 offset:16384
    ds_read_b128 v[60:63], v1 offset:24576
    ds_read_b128 v[64:67], v1 offset:1024
    ds_read_b128 v[68:71], v1 offset:9216
    ds_read_b128 v[72:75], v1 offset:17408
    ds_read_b128 v[76:79], v1 offset:25600
    ds_read_b128 v[80:83], v1 offset:2048
    ds_read_b128 v[84:87], v1 offset:10240
    ds_read_b128 v[88:91], v1 offset:18432
    ds_read_b128 v[92:95], v1 offset:26624
    ds_read_b128 v[96:99], v1 offset:3072
    ds_read_b128 v[100:103], v1 offset:11264
    ds_read_b128 v[104:107], v1 offset:19456
    ds_read_b128 v[108:111], v1 offset:27648
    s_waitcnt lgkmcnt(14)
    v_add_f32 v48, v48, v52
    v_add_f32 v49, v49, v53
    v_add_f32 v50, v50, v54
    v_add_f32 v51, v51, v55
    s_waitcnt lgkmcnt(12)
    v_add_f32 v56, v56, v60
    v_add_f32 v57, v57, v61
    v_add_f32 v58, v58, v62
    v_add_f32 v59, v59, v63
    v_add_f32 v48, v48, v56
    v_add_f32 v49, v49, v57
    v_add_f32 v50, v50, v58
    v_add_f32 v51, v51, v59
    v_cvt_pk_bf16_f32 v200, v48, v49
    v_cvt_pk_bf16_f32 v201, v50, v51
    s_waitcnt lgkmcnt(10)
    v_add_f32 v64, v64, v68
    v_add_f32 v65, v65, v69
    v_add_f32 v66, v66, v70
    v_add_f32 v67, v67, v71
    s_waitcnt lgkmcnt(8)
    v_add_f32 v72, v72, v76
    v_add_f32 v73, v73, v77
    v_add_f32 v74, v74, v78
    v_add_f32 v75, v75, v79
    v_add_f32 v64, v64, v72
    v_add_f32 v65, v65, v73
    v_add_f32 v66, v66, v74
    v_add_f32 v67, v67, v75
    v_cvt_pk_bf16_f32 v202, v64, v65
    v_cvt_pk_bf16_f32 v203, v66, v67
    global_store_dwordx4 v41, v[200:203], s[34:35] sc1
    s_waitcnt lgkmcnt(6)
    v_add_f32 v80, v80, v84
    v_add_f32 v81, v81, v85
    v_add_f32 v82, v82, v86
    v_add_f32 v83, v83, v87
    s_waitcnt lgkmcnt(4)
    v_add_f32 v88, v88, v92
    v_add_f32 v89, v89, v93
    v_add_f32 v90, v90, v94
    v_add_f32 v91, v91, v95
    v_add_f32 v80, v80, v88
    v_add_f32 v81, v81, v89
    v_add_f32 v82, v82, v90
    v_add_f32 v83, v83, v91
    v_cvt_pk_bf16_f32 v204, v80, v81
    v_cvt_pk_bf16_f32 v205, v82, v83
    s_waitcnt lgkmcnt(2)
    v_add_f32 v96, v96, v100
    v_add_f32 v97, v97, v101
    v_add_f32 v98, v98, v102
    v_add_f32 v99, v99, v103
    s_waitcnt lgkmcnt(0)
    v_add_f32 v104, v104, v108
    v_add_f32 v105, v105, v109
    v_add_f32 v106, v106, v110
    v_add_f32 v107, v107, v111
    v_add_f32 v96, v96, v104
    v_add_f32 v97, v97, v105
    v_add_f32 v98, v98, v106
    v_add_f32 v99, v99, v107
    v_cvt_pk_bf16_f32 v206, v96, v97
    v_cvt_pk_bf16_f32 v207, v98, v99
    global_store_dwordx4 v41, v[204:207], s[34:35] offset:2048 sc1
    v_mov_b32 v24, 1
    s_mov_b64 exec, 1
    s_cmp_lt_u32 s2, 72
    s_cbranch_scc1 L_prio
    s_waitcnt vmcnt(0)
    global_atomic_add v43, v24, s[32:33] offset:68 sc1
    s_mov_b64 exec, -1
    s_branch L_poll0
L_prio:
    s_waitcnt vmcnt(0)
    global_atomic_add v25, v43, v24, s[32:33] sc0 sc1
    s_waitcnt vmcnt(0)
    v_cmp_eq_u32 vcc, 71, v25
    s_nop 1
    s_cbranch_vccz L_nogo
    global_store_dword v43, v24, s[32:33] offset:128 sc1
L_nogo:
    s_barrier
    s_mov_b64 exec, -1
    buffer_load_dwordx4 a[0:3], v6, s[4:7], 0 offen
    buffer_load_dwordx4 a[4:7], v6, s[4:7], 0 offen offset:64
    buffer_load_dwordx4 a[48:51], v7, s[4:7], 0 offen
    buffer_load_dwordx4 a[52:55], v7, s[4:7], 0 offen offset:64
    buffer_load_dwordx4 a[96:99], v8, s[4:7], 0 offen
    buffer_load_dwordx4 a[100:103], v8, s[4:7], 0 offen offset:64
    buffer_load_dwordx4 a[144:147], v9, s[4:7], 0 offen
    buffer_load_dwordx4 a[148:151], v9, s[4:7], 0 offen offset:64
    buffer_load_dwordx4 a[8:11], v6, s[4:7], 0 offen offset:128
    buffer_load_dwordx4 a[12:15], v6, s[4:7], 0 offen offset:192
    buffer_load_dwordx4 a[56:59], v7, s[4:7], 0 offen offset:128
    buffer_load_dwordx4 a[60:63], v7, s[4:7], 0 offen offset:192
    buffer_load_dwordx4 a[104:107], v8, s[4:7], 0 offen offset:128
    buffer_load_dwordx4 a[108:111], v8, s[4:7], 0 offen offset:192
    buffer_load_dwordx4 a[152:155], v9, s[4:7], 0 offen offset:128
    buffer_load_dwordx4 a[156:159], v9, s[4:7], 0 offen offset:192
    buffer_load_dwordx4 a[16:19], v6, s[4:7], 0 offen offset:256
    buffer_load_dwordx4 a[20:23], v6, s[4:7], 0 offen offset:320
    buffer_load_dwordx4 a[64:67], v7, s[4:7], 0 offen offset:256
    buffer_load_dwordx4 a[68:71], v7, s[4:7], 0 offen offset:320
    s_branch L_poll0
L_rN:
    s_mul_i32 s45, s42, 24
    s_lshl_b32 s44, s41, 1
    s_add_u32 s45, s45, s44
    s_add_u32 s45, s45, 288
    s_lshl_b32 s45, s45, 10
    v_add_u32 v41, s45, v1
    v_add_u32 v44, 12288, v41
    ds_read_b128 v[48:51], v1
    ds_read_b128 v[52:55], v1 offset:8192
    ds_read_b128 v[56:59], v1 offset:16384
    ds_read_b128 v[60:63], v1 offset:24576
    ds_read_b128 v[64:67], v1 offset:1024
    ds_read_b128 v[68:71], v1 offset:9216
    ds_read_b128 v[72:75], v1 offset:17408
    ds_read_b128 v[76:79], v1 offset:25600
    ds_read_b128 v[80:83], v1 offset:2048
    ds_read_b128 v[84:87], v1 offset:10240
    ds_read_b128 v[88:91], v1 offset:18432
    ds_read_b128 v[92:95], v1 offset:26624
    ds_read_b128 v[96:99], v1 offset:3072
    ds_read_b128 v[100:103], v1 offset:11264
    ds_read_b128 v[104:107], v1 offset:19456
    ds_read_b128 v[108:111], v1 offset:27648
    ds_read_b128 v[112:115], v1 offset:4096
    ds_read_b128 v[116:119], v1 offset:12288
    ds_read_b128 v[120:123], v1 offset:20480
    ds_read_b128 v[124:127], v1 offset:28672
    ds_read_b128 v[128:131], v1 offset:5120
    ds_read_b128 v[132:135], v1 offset:13312
    ds_read_b128 v[136:139], v1 offset:21504
    ds_read_b128 v[140:143], v1 offset:29696
    ds_read_b128 v[144:147], v1 offset:6144
    ds_read_b128 v[148:151], v1 offset:14336
    ds_read_b128 v[152:155], v1 offset:22528
    ds_read_b128 v[156:159], v1 offset:30720
    ds_read_b128 v[160:163], v1 offset:7168
    ds_read_b128 v[164:167], v1 offset:15360
    ds_read_b128 v[168:171], v1 offset:23552
    ds_read_b128 v[172:175], v1 offset:31744
    s_waitcnt lgkmcnt(15)
    v_add_f32 v48, v48, v52
    v_add_f32 v49, v49, v53
    v_add_f32 v50, v50, v54
    v_add_f32 v51, v51, v55
    v_add_f32 v56, v56, v60
    v_add_f32 v57, v57, v61
    v_add_f32 v58, v58, v62
    v_add_f32 v59, v59, v63
    v_add_f32 v48, v48, v56
    v_add_f32 v49, v49, v57
    v_add_f32 v50, v50, v58
    v_add_f32 v51, v51, v59
    v_cvt_pk_bf16_f32 v200, v48, v49
    v_cvt_pk_bf16_f32 v201, v50, v51
    v_add_f32 v64, v64, v68
    v_add_f32 v65, v65, v69
    v_add_f32 v66, v66, v70
    v_add_f32 v67, v67, v71
    v_add_f32 v72, v72, v76
    v_add_f32 v73, v73, v77
    v_add_f32 v74, v74, v78
    v_add_f32 v75, v75, v79
    v_add_f32 v64, v64, v72
    v_add_f32 v65, v65, v73
    v_add_f32 v66, v66, v74
    v_add_f32 v67, v67, v75
    v_cvt_pk_bf16_f32 v202, v64, v65
    v_cvt_pk_bf16_f32 v203, v66, v67
    global_store_dwordx4 v41, v[200:203], s[34:35] sc1
    v_add_f32 v80, v80, v84
    v_add_f32 v81, v81, v85
    v_add_f32 v82, v82, v86
    v_add_f32 v83, v83, v87
    v_add_f32 v88, v88, v92
    v_add_f32 v89, v89, v93
    v_add_f32 v90, v90, v94
    v_add_f32 v91, v91, v95
    v_add_f32 v80, v80, v88
    v_add_f32 v81, v81, v89
    v_add_f32 v82, v82, v90
    v_add_f32 v83, v83, v91
    v_cvt_pk_bf16_f32 v204, v80, v81
    v_cvt_pk_bf16_f32 v205, v82, v83
    v_add_f32 v96, v96, v100
    v_add_f32 v97, v97, v101
    v_add_f32 v98, v98, v102
    v_add_f32 v99, v99, v103
    v_add_f32 v104, v104, v108
    v_add_f32 v105, v105, v109
    v_add_f32 v106, v106, v110
    v_add_f32 v107, v107, v111
    v_add_f32 v96, v96, v104
    v_add_f32 v97, v97, v105
    v_add_f32 v98, v98, v106
    v_add_f32 v99, v99, v107
    v_cvt_pk_bf16_f32 v206, v96, v97
    v_cvt_pk_bf16_f32 v207, v98, v99
    global_store_dwordx4 v44, v[204:207], s[34:35] sc1
    s_waitcnt lgkmcnt(14)
    v_add_f32 v112, v112, v116
    v_add_f32 v113, v113, v117
    v_add_f32 v114, v114, v118
    v_add_f32 v115, v115, v119
    s_waitcnt lgkmcnt(12)
    v_add_f32 v120, v120, v124
    v_add_f32 v121, v121, v125
    v_add_f32 v122, v122, v126
    v_add_f32 v123, v123, v127
    v_add_f32 v112, v112, v120
    v_add_f32 v113, v113, v121
    v_add_f32 v114, v114, v122
    v_add_f32 v115, v115, v123
    v_cvt_pk_bf16_f32 v208, v112, v113
    v_cvt_pk_bf16_f32 v209, v114, v115
    s_waitcnt lgkmcnt(10)
    v_add_f32 v128, v128, v132
    v_add_f32 v129, v129, v133
    v_add_f32 v130, v130, v134
    v_add_f32 v131, v131, v135
    s_waitcnt lgkmcnt(8)
    v_add_f32 v136, v136, v140
    v_add_f32 v137, v137, v141
    v_add_f32 v138, v138, v142
    v_add_f32 v139, v139, v143
    v_add_f32 v128, v128, v136
    v_add_f32 v129, v129, v137
    v_add_f32 v130, v130, v138
    v_add_f32 v131, v131, v139
    v_cvt_pk_bf16_f32 v210, v128, v129
    v_cvt_pk_bf16_f32 v211, v130, v131
    global_store_dwordx4 v41, v[208:211], s[34:35] offset:1024 sc1
    s_waitcnt lgkmcnt(6)
    v_add_f32 v144, v144, v148
    v_add_f32 v145, v145, v149
    v_add_f32 v146, v146, v150
    v_add_f32 v147, v147, v151
    s_waitcnt lgkmcnt(4)
    v_add_f32 v152, v152, v156
    v_add_f32 v153, v153, v157
    v_add_f32 v154, v154, v158
    v_add_f32 v155, v155, v159
    v_add_f32 v144, v144, v152
    v_add_f32 v145, v145, v153
    v_add_f32 v146, v146, v154
    v_add_f32 v147, v147, v155
    v_cvt_pk_bf16_f32 v212, v144, v145
    v_cvt_pk_bf16_f32 v213, v146, v147
    s_waitcnt lgkmcnt(2)
    v_add_f32 v160, v160, v164
    v_add_f32 v161, v161, v165
    v_add_f32 v162, v162, v166
    v_add_f32 v163, v163, v167
    s_waitcnt lgkmcnt(0)
    v_add_f32 v168, v168, v172
    v_add_f32 v169, v169, v173
    v_add_f32 v170, v170, v174
    v_add_f32 v171, v171, v175
    v_add_f32 v160, v160, v168
    v_add_f32 v161, v161, v169
    v_add_f32 v162, v162, v170
    v_add_f32 v163, v163, v171
    v_cvt_pk_bf16_f32 v214, v160, v161
    v_cvt_pk_bf16_f32 v215, v162, v163
    global_store_dwordx4 v44, v[212:215], s[34:35] offset:1024 sc1
L_poll0:
    s_mov_b32 s40, 0
L_poll:
    global_load_dword v42, v43, s[32:33] offset:128 sc1
    s_waitcnt vmcnt(0)
    v_cmp_gt_u32 vcc, 1, v42
    s_add_u32 s40, s40, 1
    s_nop 0
    s_cbranch_vccz L_pd
    s_sleep 1
    s_cmp_lt_u32 s40, 400000
    s_cbranch_scc1 L_poll
L_pd:
    v_add_u32 v23, 4096, v1
    s_mov_b32 m0, 4096
    s_nop 0
    global_load_lds_dwordx4 v23, s[34:35] offset:-4096 sc1
    global_load_lds_dwordx4 v23, s[34:35] offset:-3072 sc1
    global_load_lds_dwordx4 v23, s[34:35] offset:-2048 sc1
    global_load_lds_dwordx4 v23, s[34:35] offset:-1024 sc1
    global_load_lds_dwordx4 v23, s[34:35] sc1
    global_load_lds_dwordx4 v23, s[34:35] offset:1024 sc1
    global_load_lds_dwordx4 v23, s[34:35] offset:2048 sc1
    global_load_lds_dwordx4 v23, s[34:35] offset:3072 sc1
    v_add_u32 v23, 8192, v23
    s_mov_b32 m0, 12288
    s_nop 0
    global_load_lds_dwordx4 v23, s[34:35] offset:-4096 sc1
    global_load_lds_dwordx4 v23, s[34:35] offset:-3072 sc1
    global_load_lds_dwordx4 v23, s[34:35] offset:-2048 sc1
    global_load_lds_dwordx4 v23, s[34:35] offset:-1024 sc1
    global_load_lds_dwordx4 v23, s[34:35] sc1
    global_load_lds_dwordx4 v23, s[34:35] offset:1024 sc1
    global_load_lds_dwordx4 v23, s[34:35] offset:2048 sc1
    global_load_lds_dwordx4 v23, s[34:35] offset:3072 sc1
    v_add_u32 v23, 8192, v23
    s_mov_b32 m0, 20480
    s_nop 0
    global_load_lds_dwordx4 v23, s[34:35] offset:-4096 sc1
    global_load_lds_dwordx4 v23, s[34:35] offset:-3072 sc1
    global_load_lds_dwordx4 v23, s[34:35] offset:-2048 sc1
    global_load_lds_dwordx4 v23, s[34:35] offset:-1024 sc1
    global_load_lds_dwordx4 v23, s[34:35] sc1
    global_load_lds_dwordx4 v23, s[34:35] offset:1024 sc1
    global_load_lds_dwordx4 v23, s[34:35] offset:2048 sc1
    global_load_lds_dwordx4 v23, s[34:35] offset:3072 sc1
    v_add_u32 v23, 8192, v23
    s_mov_b32 m0, 28672
    s_nop 0
    global_load_lds_dwordx4 v23, s[34:35] offset:-4096 sc1
    global_load_lds_dwordx4 v23, s[34:35] offset:-3072 sc1
    global_load_lds_dwordx4 v23, s[34:35] offset:-2048 sc1
    global_load_lds_dwordx4 v23, s[34:35] offset:-1024 sc1
    global_load_lds_dwordx4 v23, s[34:35] sc1
    global_load_lds_dwordx4 v23, s[34:35] offset:1024 sc1
    global_load_lds_dwordx4 v23, s[34:35] offset:2048 sc1
    global_load_lds_dwordx4 v23, s[34:35] offset:3072 sc1
    v_add_u32 v23, 8192, v23
    s_mov_b32 m0, 36864
    s_nop 0
    global_load_lds_dwordx4 v23, s[34:35] offset:-4096 sc1
    global_load_lds_dwordx4 v23, s[34:35] offset:-3072 sc1
    global_load_lds_dwordx4 v23, s[34:35] offset:-2048 sc1
    global_load_lds_dwordx4 v23, s[34:35] offset:-1024 sc1
    global_load_lds_dwordx4 v23, s[34:35] sc1
    global_load_lds_dwordx4 v23, s[34:35] offset:1024 sc1
    global_load_lds_dwordx4 v23, s[34:35] offset:2048 sc1
    global_load_lds_dwordx4 v23, s[34:35] offset:3072 sc1
    v_add_u32 v23, 8192, v23
    s_mov_b32 m0, 45056
    s_nop 0
    global_load_lds_dwordx4 v23, s[34:35] offset:-4096 sc1
    global_load_lds_dwordx4 v23, s[34:35] offset:-3072 sc1
    global_load_lds_dwordx4 v23, s[34:35] offset:-2048 sc1
    global_load_lds_dwordx4 v23, s[34:35] offset:-1024 sc1
    global_load_lds_dwordx4 v23, s[34:35] sc1
    global_load_lds_dwordx4 v23, s[34:35] offset:1024 sc1
    global_load_lds_dwordx4 v23, s[34:35] offset:2048 sc1
    global_load_lds_dwordx4 v23, s[34:35] offset:3072 sc1
    v_add_u32 v23, 8192, v23
    s_barrier
    s_add_u32 m0, s17, 49152
    s_nop 0
    global_load_lds_dwordx4 v4, s[34:35] offset:-3072 sc1
    global_load_lds_dwordx4 v4, s[34:35] offset:-2048 sc1
    global_load_lds_dwordx4 v4, s[34:35] offset:-1024 sc1
    global_load_lds_dwordx4 v4, s[34:35] sc1
    global_load_lds_dwordx4 v4, s[34:35] offset:1024 sc1
    global_load_lds_dwordx4 v4, s[34:35] offset:2048 sc1
    v_add_u32 v4, 24576, v4
    s_add_u32 m0, s17, 73728
    s_nop 0
    global_load_lds_dwordx4 v4, s[34:35] offset:-3072 sc1
    global_load_lds_dwordx4 v4, s[34:35] offset:-2048 sc1
    global_load_lds_dwordx4 v4, s[34:35] offset:-1024 sc1
    global_load_lds_dwordx4 v4, s[34:35] sc1
    global_load_lds_dwordx4 v4, s[34:35] offset:1024 sc1
    global_load_lds_dwordx4 v4, s[34:35] offset:2048 sc1
    v_add_u32 v4, 24576, v4
    buffer_load_dwordx4 a[112:115], v8, s[4:7], 0 offen offset:256
    buffer_load_dwordx4 a[116:119], v8, s[4:7], 0 offen offset:320
    buffer_load_dwordx4 a[160:163], v9, s[4:7], 0 offen offset:256
    buffer_load_dwordx4 a[164:167], v9, s[4:7], 0 offen offset:320
    s_sub_u32 s40, s2, 144
    s_cmp_ge_u32 s40, 72
    v_mov_b32 v24, 1
    s_cselect_b64 exec, 0, 1
    global_atomic_add v43, v24, s[32:33] offset:192 sc1
    s_mov_b64 exec, -1
    s_waitcnt vmcnt(41)
    s_branch L_join
L_others:
    s_cmp_ge_u32 s2, 72
    s_cbranch_scc1 L_o1
    s_barrier
    buffer_load_dwordx4 a[8:11], v6, s[4:7], 0 offen offset:128
    buffer_load_dwordx4 a[12:15], v6, s[4:7], 0 offen offset:192
    buffer_load_dwordx4 a[56:59], v7, s[4:7], 0 offen offset:128
    buffer_load_dwordx4 a[60:63], v7, s[4:7], 0 offen offset:192
    buffer_load_dwordx4 a[104:107], v8, s[4:7], 0 offen offset:128
    buffer_load_dwordx4 a[108:111], v8, s[4:7], 0 offen offset:192
    buffer_load_dwordx4 a[152:155], v9, s[4:7], 0 offen offset:128
    buffer_load_dwordx4 a[156:159], v9, s[4:7], 0 offen offset:192
    buffer_load_dwordx4 a[16:19], v6, s[4:7], 0 offen offset:256
    buffer_load_dwordx4 a[20:23], v6, s[4:7], 0 offen offset:320
    buffer_load_dwordx4 a[64:67], v7, s[4:7], 0 offen offset:256
    buffer_load_dwordx4 a[68:71], v7, s[4:7], 0 offen offset:320
L_o1:
    s_mov_b64 exec, 0
    s_cmp_eq_u32 s16, 1
    s_cbranch_scc1 L_st0
    s_cmp_eq_u32 s16, 2
    s_cbranch_scc1 L_st1
    s_branch L_st2
L_stdone:
    s_mov_b64 exec, -1
    s_barrier
    s_add_u32 m0, s17, 49152
    s_nop 0
    global_load_lds_dwordx4 v4, s[34:35] offset:-3072 sc1
    global_load_lds_dwordx4 v4, s[34:35] offset:-2048 sc1
    global_load_lds_dwordx4 v4, s[34:35] offset:-1024 sc1
    global_load_lds_dwordx4 v4, s[34:35] sc1
    global_load_lds_dwordx4 v4, s[34:35] offset:1024 sc1
    global_load_lds_dwordx4 v4, s[34:35] offset:2048 sc1
    v_add_u32 v4, 24576, v4
    s_add_u32 m0, s17, 73728
    s_nop 0
    global_load_lds_dwordx4 v4, s[34:35] offset:-3072 sc1
    global_load_lds_dwordx4 v4, s[34:35] offset:-2048 sc1
    global_load_lds_dwordx4 v4, s[34:35] offset:-1024 sc1
    global_load_lds_dwordx4 v4, s[34:35] sc1
    global_load_lds_dwordx4 v4, s[34:35] offset:1024 sc1
    global_load_lds_dwordx4 v4, s[34:35] offset:2048 sc1
    v_add_u32 v4, 24576, v4
    buffer_load_dwordx4 a[112:115], v8, s[4:7], 0 offen offset:256
    buffer_load_dwordx4 a[116:119], v8, s[4:7], 0 offen offset:320
    buffer_load_dwordx4 a[160:163], v9, s[4:7], 0 offen offset:256
    buffer_load_dwordx4 a[164:167], v9, s[4:7], 0 offen offset:320
L_seq:
L_join:
    s_barrier
    ds_read_b128 v[20:23], v1
    ds_read_b128 v[24:27], v1 offset:1024
    ds_read_b128 v[28:31], v1 offset:2048
    ds_read_b128 v[32:35], v1 offset:3072
    s_waitcnt vmcnt(35) lgkmcnt(2)
    v_mfma_f32_16x16x32_bf16 v[36:39], v[20:23], a[0:3], 0
    ds_read_b128 v[40:43], v1 offset:4096
    ds_read_b128 v[44:47], v1 offset:5120
    s_waitcnt vmcnt(34)
    v_mfma_f32_16x16x32_bf16 v[36:39], v[24:27], a[4:7], v[36:39]
    s_waitcnt vmcnt(33)
    v_mfma_f32_16x16x32_bf16 v[48:51], v[20:23], a[48:51], 0
    s_waitcnt vmcnt(32)
    v_mfma_f32_16x16x32_bf16 v[48:51], v[24:27], a[52:55], v[48:51]
    s_waitcnt vmcnt(31)
    v_mfma_f32_16x16x32_bf16 v[52:55], v[20:23], a[96:99], 0
    s_waitcnt vmcnt(30)
    v_mfma_f32_16x16x32_bf16 v[52:55], v[24:27], a[100:103], v[52:55]
    s_waitcnt vmcnt(29)
    v_mfma_f32_16x16x32_bf16 v[56:59], v[20:23], a[144:147], 0
    s_waitcnt vmcnt(28)
    v_mfma_f32_16x16x32_bf16 v[56:59], v[24:27], a[148:151], v[56:59]
    ds_read_b128 v[60:63], v1 offset:6144
    s_waitcnt lgkmcnt(3)
    v_mfma_f32_16x16x32_bf16 v[64:67], v[28:31], a[0:3], 0
    ds_read_b128 v[68:71], v1 offset:7168
    v_mfma_f32_16x16x32_bf16 v[64:67], v[32:35], a[4:7], v[64:67]
    ds_write_b128 v12, a[144:147]
    v_mfma_f32_16x16x32_bf16 v[72:75], v[28:31], a[48:51], 0
    v_mfma_f32_16x16x32_bf16 v[72:75], v[32:35], a[52:55], v[72:75]
    v_mfma_f32_16x16x32_bf16 v[76:79], v[28:31], a[96:99], 0
    v_mfma_f32_16x16x32_bf16 v[76:79], v[32:35], a[100:103], v[76:79]
    v_mfma_f32_16x16x32_bf16 v[80:83], v[28:31], a[144:147], 0
    v_mfma_f32_16x16x32_bf16 v[80:83], v[32:35], a[148:151], v[80:83]
    ds_read_b128 v[84:87], v1 offset:8192
    s_waitcnt lgkmcnt(4)
    v_mfma_f32_16x16x32_bf16 v[88:91], v[40:43], a[0:3], 0
    ds_read_b128 v[92:95], v1 offset:9216
    v_mfma_f32_16x16x32_bf16 v[88:91], v[44:47], a[4:7], v[88:91]
    ds_write_b128 v12, a[148:151] offset:1024
    v_mfma_f32_16x16x32_bf16 v[96:99], v[40:43], a[48:51], 0
    v_mfma_f32_16x16x32_bf16 v[96:99], v[44:47], a[52:55], v[96:99]
    v_mfma_f32_16x16x32_bf16 v[100:103], v[40:43], a[96:99], 0
    v_mfma_f32_16x16x32_bf16 v[100:103], v[44:47], a[100:103], v[100:103]
    v_mfma_f32_16x16x32_bf16 v[104:107], v[40:43], a[144:147], 0
    v_mfma_f32_16x16x32_bf16 v[104:107], v[44:47], a[148:151], v[104:107]
    ds_read_b128 v[108:111], v1 offset:10240
    s_waitcnt lgkmcnt(5)
    v_mfma_f32_16x16x32_bf16 v[112:115], v[60:63], a[0:3], 0
    ds_read_b128 v[116:119], v1 offset:11264
    v_mfma_f32_16x16x32_bf16 v[112:115], v[68:71], a[4:7], v[112:115]
    v_mfma_f32_16x16x32_bf16 v[120:123], v[60:63], a[48:51], 0
    v_mfma_f32_16x16x32_bf16 v[120:123], v[68:71], a[52:55], v[120:123]
    v_mfma_f32_16x16x32_bf16 v[124:127], v[60:63], a[96:99], 0
    v_mfma_f32_16x16x32_bf16 v[124:127], v[68:71], a[100:103], v[124:127]
    v_mfma_f32_16x16x32_bf16 v[128:131], v[60:63], a[144:147], 0
    v_mfma_f32_16x16x32_bf16 v[128:131], v[68:71], a[148:151], v[128:131]
    ds_read_b128 v[132:135], v1 offset:12288
    s_waitcnt lgkmcnt(4)
    v_mfma_f32_16x16x32_bf16 v[136:139], v[84:87], a[0:3], 0
    ds_read_b128 v[140:143], v1 offset:13312
    v_mfma_f32_16x16x32_bf16 v[136:139], v[92:95], a[4:7], v[136:139]
    v_mfma_f32_16x16x32_bf16 v[144:147], v[84:87], a[48:51], 0
    v_mfma_f32_16x16x32_bf16 v[144:147], v[92:95], a[52:55], v[144:147]
    v_mfma_f32_16x16x32_bf16 v[148:151], v[84:87], a[96:99], 0
    v_mfma_f32_16x16x32_bf16 v[148:151], v[92:95], a[100:103], v[148:151]
    v_mfma_f32_16x16x32_bf16 v[152:155], v[84:87], a[144:147], 0
    v_mfma_f32_16x16x32_bf16 v[152:155], v[92:95], a[148:151], v[152:155]
    ds_read_b128 v[156:159], v1 offset:14336
    s_waitcnt lgkmcnt(3)
    v_mfma_f32_16x16x32_bf16 v[160:163], v[108:111], a[0:3], 0
    ds_read_b128 v[164:167], v1 offset:15360
    v_mfma_f32_16x16x32_bf16 v[160:163], v[116:119], a[4:7], v[160:163]
    s_waitcnt vmcnt(17)
    s_barrier
    v_mfma_f32_16x16x32_bf16 v[168:171], v[108:111], a[48:51], 0
    v_mfma_f32_16x16x32_bf16 v[168:171], v[116:119], a[52:55], v[168:171]
    v_mfma_f32_16x16x32_bf16 v[172:175], v[108:111], a[96:99], 0
    v_mfma_f32_16x16x32_bf16 v[172:175], v[116:119], a[100:103], v[172:175]
    v_mfma_f32_16x16x32_bf16 v[176:179], v[108:111], a[144:147], 0
    v_mfma_f32_16x16x32_bf16 v[176:179], v[116:119], a[148:151], v[176:179]
    ds_read_b128 v[180:183], v1 offset:16384
    s_waitcnt lgkmcnt(3)
    v_mfma_f32_16x16x32_bf16 v[184:187], v[132:135], a[0:3], 0
    ds_read_b128 v[188:191], v1 offset:17408
    v_mfma_f32_16x16x32_bf16 v[184:187], v[140:143], a[4:7], v[184:187]
    v_mfma_f32_16x16x32_bf16 v[192:195], v[132:135], a[48:51], 0
    v_mfma_f32_16x16x32_bf16 v[192:195], v[140:143], a[52:55], v[192:195]
    v_mfma_f32_16x16x32_bf16 v[196:199], v[132:135], a[96:99], 0
    v_mfma_f32_16x16x32_bf16 v[196:199], v[140:143], a[100:103], v[196:199]
    v_mfma_f32_16x16x32_bf16 v[200:203], v[132:135], a[144:147], 0
    v_mfma_f32_16x16x32_bf16 v[200:203], v[140:143], a[148:151], v[200:203]
    ds_read_b128 v[204:207], v1 offset:18432
    s_waitcnt lgkmcnt(3)
    v_mfma_f32_16x16x32_bf16 v[208:211], v[156:159], a[0:3], 0
    ds_read_b128 v[212:215], v1 offset:19456
    v_mfma_f32_16x16x32_bf16 v[208:211], v[164:167], a[4:7], v[208:211]
    v_mfma_f32_16x16x32_bf16 v[216:219], v[156:159], a[48:51], 0
    v_mfma_f32_16x16x32_bf16 v[216:219], v[164:167], a[52:55], v[216:219]
    buffer_load_dwordx4 a[24:27], v6, s[4:7], 0 offen offset:384
    v_mfma_f32_16x16x32_bf16 v[220:223], v[156:159], a[96:99], 0
    v_mfma_f32_16x16x32_bf16 v[220:223], v[164:167], a[100:103], v[220:223]
    v_mfma_f32_16x16x32_bf16 v[224:227], v[156:159], a[144:147], 0
    v_mfma_f32_16x16x32_bf16 v[224:227], v[164:167], a[148:151], v[224:227]
    ds_read_b128 v[228:231], v1 offset:20480
    s_waitcnt lgkmcnt(3)
    v_mfma_f32_16x16x32_bf16 v[232:235], v[180:183], a[0:3], 0
    ds_read_b128 v[236:239], v1 offset:21504
    v_mfma_f32_16x16x32_bf16 v[232:235], v[188:191], a[4:7], v[232:235]
    v_mfma_f32_16x16x32_bf16 v[240:243], v[180:183], a[48:51], 0
    v_mfma_f32_16x16x32_bf16 v[240:243], v[188:191], a[52:55], v[240:243]
    v_mfma_f32_16x16x32_bf16 v[244:247], v[180:183], a[96:99], 0
    v_mfma_f32_16x16x32_bf16 v[244:247], v[188:191], a[100:103], v[244:247]
    v_mfma_f32_16x16x32_bf16 v[248:251], v[180:183], a[144:147], 0
    v_mfma_f32_16x16x32_bf16 v[248:251], v[188:191], a[148:151], v[248:251]
    ds_read_b128 v[252:255], v1 offset:22528
    s_waitcnt lgkmcnt(3)
    v_mfma_f32_16x16x32_bf16 v[20:23], v[204:207], a[0:3], 0
    ds_read_b128 v[24:27], v1 offset:23552
    v_mfma_f32_16x16x32_bf16 v[20:23], v[212:215], a[4:7], v[20:23]
    v_mfma_f32_16x16x32_bf16 v[28:31], v[204:207], a[48:51], 0
    v_mfma_f32_16x16x32_bf16 v[28:31], v[212:215], a[52:55], v[28:31]
    v_mfma_f32_16x16x32_bf16 v[32:35], v[204:207], a[96:99], 0
    v_mfma_f32_16x16x32_bf16 v[32:35], v[212:215], a[100:103], v[32:35]
    v_mfma_f32_16x16x32_bf16 v[40:43], v[204:207], a[144:147], 0
    v_mfma_f32_16x16x32_bf16 v[40:43], v[212:215], a[148:151], v[40:43]
    ds_read_b128 v[44:47], v1 offset:24576
    s_waitcnt lgkmcnt(3)
    v_mfma_f32_16x16x32_bf16 v[60:63], v[228:231], a[0:3], 0
    ds_read_b128 v[68:71], v1 offset:25600
    v_mfma_f32_16x16x32_bf16 v[60:63], v[236:239], a[4:7], v[60:63]
    buffer_load_dwordx4 a[28:31], v6, s[4:7], 0 offen offset:448
    v_mfma_f32_16x16x32_bf16 v[84:87], v[228:231], a[48:51], 0
    v_mfma_f32_16x16x32_bf16 v[84:87], v[236:239], a[52:55], v[84:87]
    v_mfma_f32_16x16x32_bf16 v[92:95], v[228:231], a[96:99], 0
    v_mfma_f32_16x16x32_bf16 v[92:95], v[236:239], a[100:103], v[92:95]
    v_mfma_f32_16x16x32_bf16 v[108:111], v[228:231], a[144:147], 0
    v_mfma_f32_16x16x32_bf16 v[108:111], v[236:239], a[148:151], v[108:111]
    ds_read_b128 v[116:119], v1 offset:26624
    s_waitcnt lgkmcnt(3)
    v_mfma_f32_16x16x32_bf16 v[132:135], v[252:255], a[0:3], 0
    ds_read_b128 v[140:143], v1 offset:27648
    v_mfma_f32_16x16x32_bf16 v[132:135], v[24:27], a[4:7], v[132:135]
    v_mfma_f32_16x16x32_bf16 v[156:159], v[252:255], a[48:51], 0
    v_mfma_f32_16x16x32_bf16 v[156:159], v[24:27], a[52:55], v[156:159]
    v_mfma_f32_16x16x32_bf16 v[164:167], v[252:255], a[96:99], 0
    v_mfma_f32_16x16x32_bf16 v[164:167], v[24:27], a[100:103], v[164:167]
    v_mfma_f32_16x16x32_bf16 v[180:183], v[252:255], a[144:147], 0
    v_mfma_f32_16x16x32_bf16 v[180:183], v[24:27], a[148:151], v[180:183]
    ds_read_b128 v[188:191], v1 offset:28672
    s_waitcnt lgkmcnt(3)
    v_mfma_f32_16x16x32_bf16 a[192:195], v[44:47], a[0:3], 0
    ds_read_b128 v[204:207], v1 offset:29696
    v_mfma_f32_16x16x32_bf16 a[192:195], v[68:71], a[4:7], a[192:195]
    v_mfma_f32_16x16x32_bf16 a[196:199], v[44:47], a[48:51], 0
    v_mfma_f32_16x16x32_bf16 a[196:199], v[68:71], a[52:55], a[196:199]
    v_mov_b32 v212, 0
    v_mfma_f32_16x16x32_bf16 a[200:203], v[44:47], a[96:99], 0
    global_load_dword v213, v212, s[32:33] offset:68 sc1
    v_mfma_f32_16x16x32_bf16 a[200:203], v[68:71], a[100:103], a[200:203]
    buffer_load_dwordx4 a[72:75], v7, s[4:7], 0 offen offset:384
    v_mfma_f32_16x16x32_bf16 a[204:207], v[44:47], a[144:147], 0
    v_mfma_f32_16x16x32_bf16 a[204:207], v[68:71], a[148:151], a[204:207]
    ds_read_b128 v[228:231], v1 offset:30720
    s_waitcnt lgkmcnt(3)
    v_mfma_f32_16x16x32_bf16 a[208:211], v[116:119], a[0:3], 0
    ds_read_b128 v[236:239], v1 offset:31744
    v_mfma_f32_16x16x32_bf16 a[208:211], v[140:143], a[4:7], a[208:211]
    v_mfma_f32_16x16x32_bf16 a[212:215], v[116:119], a[48:51], 0
    v_mfma_f32_16x16x32_bf16 a[212:215], v[140:143], a[52:55], a[212:215]
    v_mfma_f32_16x16x32_bf16 a[216:219], v[116:119], a[96:99], 0
    v_mfma_f32_16x16x32_bf16 a[216:219], v[140:143], a[100:103], a[216:219]
    v_mfma_f32_16x16x32_bf16 a[220:223], v[116:119], a[144:147], 0
    v_mfma_f32_16x16x32_bf16 a[220:223], v[140:143], a[148:151], a[220:223]
    ds_read_b128 v[24:27], v1 offset:32768
    s_waitcnt lgkmcnt(3)
    v_mfma_f32_16x16x32_bf16 a[224:227], v[188:191], a[0:3], 0
    ds_read_b128 v[44:47], v1 offset:33792
    v_mfma_f32_16x16x32_bf16 a[224:227], v[204:207], a[4:7], a[224:227]
    v_mfma_f32_16x16x32_bf16 a[228:231], v[188:191], a[48:51], 0
    v_mfma_f32_16x16x32_bf16 a[228:231], v[204:207], a[52:55], a[228:231]
    v_mfma_f32_16x16x32_bf16 a[232:235], v[188:191], a[96:99], 0
    v_mfma_f32_16x16x32_bf16 a[232:235], v[204:207], a[100:103], a[232:235]
    v_mfma_f32_16x16x32_bf16 a[236:239], v[188:191], a[144:147], 0
    v_mfma_f32_16x16x32_bf16 a[236:239], v[204:207], a[148:151], a[236:239]
    ds_read_b128 v[68:71], v1 offset:34816
    s_waitcnt lgkmcnt(3)
    v_mfma_f32_16x16x32_bf16 a[240:243], v[228:231], a[0:3], 0
    ds_read_b128 v[116:119], v1 offset:35840
    v_mfma_f32_16x16x32_bf16 a[240:243], v[236:239], a[4:7], a[240:243]
    buffer_load_dwordx4 a[76:79], v7, s[4:7], 0 offen offset:448
    v_mfma_f32_16x16x32_bf16 a[244:247], v[228:231], a[48:51], 0
    v_mfma_f32_16x16x32_bf16 a[244:247], v[236:239], a[52:55], a[244:247]
    v_mfma_f32_16x16x32_bf16 a[248:251], v[228:231], a[96:99], 0
    v_mfma_f32_16x16x32_bf16 a[248:251], v[236:239], a[100:103], a[248:251]
    v_mfma_f32_16x16x32_bf16 a[252:255], v[228:231], a[144:147], 0
    v_mfma_f32_16x16x32_bf16 a[252:255], v[236:239], a[148:151], a[252:255]
    ds_read_b128 v[140:143], v1 offset:36864
    s_waitcnt lgkmcnt(3)
    v_mfma_f32_16x16x32_bf16 v[36:39], v[24:27], a[8:11], v[36:39]
    ds_read_b128 v[188:191], v1 offset:37888
    v_mfma_f32_16x16x32_bf16 v[36:39], v[44:47], a[12:15], v[36:39]
    v_mfma_f32_16x16x32_bf16 v[48:51], v[24:27], a[56:59], v[48:51]
    v_mfma_f32_16x16x32_bf16 v[48:51], v[44:47], a[60:63], v[48:51]
    v_mfma_f32_16x16x32_bf16 v[52:55], v[24:27], a[104:107], v[52:55]
    v_mfma_f32_16x16x32_bf16 v[52:55], v[44:47], a[108:111], v[52:55]
    v_mfma_f32_16x16x32_bf16 v[56:59], v[24:27], a[152:155], v[56:59]
    v_mfma_f32_16x16x32_bf16 v[56:59], v[44:47], a[156:159], v[56:59]
    ds_read_b128 v[204:207], v1 offset:38912
    s_waitcnt lgkmcnt(3)
    v_mfma_f32_16x16x32_bf16 v[64:67], v[68:71], a[8:11], v[64:67]
    ds_read_b128 v[228:231], v1 offset:39936
    v_mfma_f32_16x16x32_bf16 v[64:67], v[116:119], a[12:15], v[64:67]
    ds_write_b128 v12, a[152:155] offset:2048
    v_mfma_f32_16x16x32_bf16 v[72:75], v[68:71], a[56:59], v[72:75]
    v_mfma_f32_16x16x32_bf16 v[72:75], v[116:119], a[60:63], v[72:75]
    buffer_load_dwordx4 a[120:123], v8, s[4:7], 0 offen offset:384
    v_mfma_f32_16x16x32_bf16 v[76:79], v[68:71], a[104:107], v[76:79]
    v_mfma_f32_16x16x32_bf16 v[76:79], v[116:119], a[108:111], v[76:79]
    v_mfma_f32_16x16x32_bf16 v[80:83], v[68:71], a[152:155], v[80:83]
    v_mfma_f32_16x16x32_bf16 v[80:83], v[116:119], a[156:159], v[80:83]
    ds_read_b128 v[24:27], v1 offset:40960
    s_waitcnt lgkmcnt(4)
    v_mfma_f32_16x16x32_bf16 v[88:91], v[140:143], a[8:11], v[88:91]
    ds_read_b128 v[44:47], v1 offset:41984
    v_mfma_f32_16x16x32_bf16 v[88:91], v[188:191], a[12:15], v[88:91]
    ds_write_b128 v12, a[156:159] offset:3072
    v_mfma_f32_16x16x32_bf16 v[96:99], v[140:143], a[56:59], v[96:99]
    v_mfma_f32_16x16x32_bf16 v[96:99], v[188:191], a[60:63], v[96:99]
    v_mfma_f32_16x16x32_bf16 v[100:103], v[140:143], a[104:107], v[100:103]
    v_mfma_f32_16x16x32_bf16 v[100:103], v[188:191], a[108:111], v[100:103]
    v_mfma_f32_16x16x32_bf16 v[104:107], v[140:143], a[152:155], v[104:107]
    v_mfma_f32_16x16x32_bf16 v[104:107], v[188:191], a[156:159], v[104:107]
    ds_read_b128 v[236:239], v1 offset:43008
    s_waitcnt lgkmcnt(5)
    v_mfma_f32_16x16x32_bf16 v[112:115], v[204:207], a[8:11], v[112:115]
    ds_read_b128 v[252:255], v1 offset:44032
    v_mfma_f32_16x16x32_bf16 v[112:115], v[228:231], a[12:15], v[112:115]
    v_mfma_f32_16x16x32_bf16 v[120:123], v[204:207], a[56:59], v[120:123]
    v_mfma_f32_16x16x32_bf16 v[120:123], v[228:231], a[60:63], v[120:123]
    v_mfma_f32_16x16x32_bf16 v[124:127], v[204:207], a[104:107], v[124:127]
    v_mfma_f32_16x16x32_bf16 v[124:127], v[228:231], a[108:111], v[124:127]
    v_mfma_f32_16x16x32_bf16 v[128:131], v[204:207], a[152:155], v[128:131]
    v_mfma_f32_16x16x32_bf16 v[128:131], v[228:231], a[156:159], v[128:131]
    ds_read_b128 v[68:71], v1 offset:45056
    s_waitcnt lgkmcnt(4)
    v_mfma_f32_16x16x32_bf16 v[136:139], v[24:27], a[8:11], v[136:139]
    ds_read_b128 v[116:119], v1 offset:46080
    v_mfma_f32_16x16x32_bf16 v[136:139], v[44:47], a[12:15], v[136:139]
    buffer_load_dwordx4 a[124:127], v8, s[4:7], 0 offen offset:448
    v_mfma_f32_16x16x32_bf16 v[144:147], v[24:27], a[56:59], v[144:147]
    s_waitcnt vmcnt(17)
    s_barrier
    v_mfma_f32_16x16x32_bf16 v[144:147], v[44:47], a[60:63], v[144:147]
    s_add_u32 m0, s17, 0
    v_mfma_f32_16x16x32_bf16 v[148:151], v[24:27], a[104:107], v[148:151]
    global_load_lds_dwordx4 v4, s[34:35] offset:-3072 sc1
    v_mfma_f32_16x16x32_bf16 v[148:151], v[44:47], a[108:111], v[148:151]
    v_mfma_f32_16x16x32_bf16 v[152:155], v[24:27], a[152:155], v[152:155]
    v_mfma_f32_16x16x32_bf16 v[152:155], v[44:47], a[156:159], v[152:155]
    ds_read_b128 v[140:143], v1 offset:47104
    s_waitcnt lgkmcnt(3)
    v_mfma_f32_16x16x32_bf16 v[160:163], v[236:239], a[8:11], v[160:163]
    ds_read_b128 v[188:191], v1 offset:48128
    v_mfma_f32_16x16x32_bf16 v[160:163], v[252:255], a[12:15], v[160:163]
    global_load_lds_dwordx4 v4, s[34:35] offset:-2048 sc1
    v_mfma_f32_16x16x32_bf16 v[168:171], v[236:239], a[56:59], v[168:171]
    v_mfma_f32_16x16x32_bf16 v[168:171], v[252:255], a[60:63], v[168:171]
    v_mfma_f32_16x16x32_bf16 v[172:175], v[236:239], a[104:107], v[172:175]
    v_mfma_f32_16x16x32_bf16 v[172:175], v[252:255], a[108:111], v[172:175]
    v_mfma_f32_16x16x32_bf16 v[176:179], v[236:239], a[152:155], v[176:179]
    v_mfma_f32_16x16x32_bf16 v[176:179], v[252:255], a[156:159], v[176:179]
    ds_read_b128 v[24:27], v1 offset:49152
    s_waitcnt lgkmcnt(3)
    v_mfma_f32_16x16x32_bf16 v[184:187], v[68:71], a[8:11], v[184:187]
    ds_read_b128 v[44:47], v1 offset:50176
    v_mfma_f32_16x16x32_bf16 v[184:187], v[116:119], a[12:15], v[184:187]
    global_load_lds_dwordx4 v4, s[34:35] offset:-1024 sc1
    v_mfma_f32_16x16x32_bf16 v[192:195], v[68:71], a[56:59], v[192:195]
    v_mfma_f32_16x16x32_bf16 v[192:195], v[116:119], a[60:63], v[192:195]
    buffer_load_dwordx4 a[168:171], v9, s[4:7], 0 offen offset:384
    v_mfma_f32_16x16x32_bf16 v[196:199], v[68:71], a[104:107], v[196:199]
    v_mfma_f32_16x16x32_bf16 v[196:199], v[116:119], a[108:111], v[196:199]
    v_mfma_f32_16x16x32_bf16 v[200:203], v[68:71], a[152:155], v[200:203]
    v_mfma_f32_16x16x32_bf16 v[200:203], v[116:119], a[156:159], v[200:203]
    ds_read_b128 v[204:207], v1 offset:51200
    s_waitcnt lgkmcnt(3)
    v_mfma_f32_16x16x32_bf16 v[208:211], v[140:143], a[8:11], v[208:211]
    ds_read_b128 v[228:231], v1 offset:52224
    v_mfma_f32_16x16x32_bf16 v[208:211], v[188:191], a[12:15], v[208:211]
    global_load_lds_dwordx4 v4, s[34:35] sc1
    v_mfma_f32_16x16x32_bf16 v[216:219], v[140:143], a[56:59], v[216:219]
    v_mfma_f32_16x16x32_bf16 v[216:219], v[188:191], a[60:63], v[216:219]
    v_mfma_f32_16x16x32_bf16 v[220:223], v[140:143], a[104:107], v[220:223]
    v_mfma_f32_16x16x32_bf16 v[220:223], v[188:191], a[108:111], v[220:223]
    v_mfma_f32_16x16x32_bf16 v[224:227], v[140:143], a[152:155], v[224:227]
    v_mfma_f32_16x16x32_bf16 v[224:227], v[188:191], a[156:159], v[224:227]
    ds_read_b128 v[236:239], v1 offset:53248
    s_waitcnt lgkmcnt(3)
    v_mfma_f32_16x16x32_bf16 v[232:235], v[24:27], a[8:11], v[232:235]
    ds_read_b128 v[252:255], v1 offset:54272
    v_mfma_f32_16x16x32_bf16 v[232:235], v[44:47], a[12:15], v[232:235]
    global_load_lds_dwordx4 v4, s[34:35] offset:1024 sc1
    v_mfma_f32_16x16x32_bf16 v[240:243], v[24:27], a[56:59], v[240:243]
    v_mfma_f32_16x16x32_bf16 v[240:243], v[44:47], a[60:63], v[240:243]
    v_mfma_f32_16x16x32_bf16 v[244:247], v[24:27], a[104:107], v[244:247]
    v_mfma_f32_16x16x32_bf16 v[244:247], v[44:47], a[108:111], v[244:247]
    v_mfma_f32_16x16x32_bf16 v[248:251], v[24:27], a[152:155], v[248:251]
    v_mfma_f32_16x16x32_bf16 v[248:251], v[44:47], a[156:159], v[248:251]
    ds_read_b128 v[68:71], v1 offset:55296
    s_waitcnt lgkmcnt(3)
    v_mfma_f32_16x16x32_bf16 v[20:23], v[204:207], a[8:11], v[20:23]
    ds_read_b128 v[116:119], v1 offset:56320
    v_mfma_f32_16x16x32_bf16 v[20:23], v[228:231], a[12:15], v[20:23]
    buffer_load_dwordx4 a[172:175], v9, s[4:7], 0 offen offset:448
    v_mfma_f32_16x16x32_bf16 v[28:31], v[204:207], a[56:59], v[28:31]
    global_load_lds_dwordx4 v4, s[34:35] offset:2048 sc1
    v_mfma_f32_16x16x32_bf16 v[28:31], v[228:231], a[60:63], v[28:31]
    v_add_u32 v4, 24576, v4
    v_mfma_f32_16x16x32_bf16 v[32:35], v[204:207], a[104:107], v[32:35]
    v_mfma_f32_16x16x32_bf16 v[32:35], v[228:231], a[108:111], v[32:35]
    v_mfma_f32_16x16x32_bf16 v[40:43], v[204:207], a[152:155], v[40:43]
    v_mfma_f32_16x16x32_bf16 v[40:43], v[228:231], a[156:159], v[40:43]
    ds_read_b128 v[24:27], v1 offset:57344
    s_waitcnt lgkmcnt(3)
    v_mfma_f32_16x16x32_bf16 v[60:63], v[236:239], a[8:11], v[60:63]
    ds_read_b128 v[44:47], v1 offset:58368
    v_mfma_f32_16x16x32_bf16 v[60:63], v[252:255], a[12:15], v[60:63]
    v_mfma_f32_16x16x32_bf16 v[84:87], v[236:239], a[56:59], v[84:87]
    v_mfma_f32_16x16x32_bf16 v[84:87], v[252:255], a[60:63], v[84:87]
    v_mfma_f32_16x16x32_bf16 v[92:95], v[236:239], a[104:107], v[92:95]
    v_mfma_f32_16x16x32_bf16 v[92:95], v[252:255], a[108:111], v[92:95]
    v_mfma_f32_16x16x32_bf16 v[108:111], v[236:239], a[152:155], v[108:111]
    v_mfma_f32_16x16x32_bf16 v[108:111], v[252:255], a[156:159], v[108:111]
    ds_read_b128 v[140:143], v1 offset:59392
    s_waitcnt lgkmcnt(3)
    v_mfma_f32_16x16x32_bf16 v[132:135], v[68:71], a[8:11], v[132:135]
    ds_read_b128 v[188:191], v1 offset:60416
    v_mfma_f32_16x16x32_bf16 v[132:135], v[116:119], a[12:15], v[132:135]
    v_mfma_f32_16x16x32_bf16 v[156:159], v[68:71], a[56:59], v[156:159]
    v_mfma_f32_16x16x32_bf16 v[156:159], v[116:119], a[60:63], v[156:159]
    buffer_load_dwordx4 a[32:35], v6, s[4:7], 0 offen offset:512
    v_mfma_f32_16x16x32_bf16 v[164:167], v[68:71], a[104:107], v[164:167]
    v_mfma_f32_16x16x32_bf16 v[164:167], v[116:119], a[108:111], v[164:167]
    v_mfma_f32_16x16x32_bf16 v[180:183], v[68:71], a[152:155], v[180:183]
    v_mfma_f32_16x16x32_bf16 v[180:183], v[116:119], a[156:159], v[180:183]
    ds_read_b128 v[204:207], v1 offset:61440
    s_waitcnt lgkmcnt(3)
    v_mfma_f32_16x16x32_bf16 a[192:195], v[24:27], a[8:11], a[192:195]
    ds_read_b128 v[228:231], v1 offset:62464
    v_mfma_f32_16x16x32_bf16 a[192:195], v[44:47], a[12:15], a[192:195]
    v_mfma_f32_16x16x32_bf16 a[196:199], v[24:27], a[56:59], a[196:199]
    v_mfma_f32_16x16x32_bf16 a[196:199], v[44:47], a[60:63], a[196:199]
    v_mfma_f32_16x16x32_bf16 a[200:203], v[24:27], a[104:107], a[200:203]
    v_mfma_f32_16x16x32_bf16 a[200:203], v[44:47], a[108:111], a[200:203]
    v_mfma_f32_16x16x32_bf16 a[204:207], v[24:27], a[152:155], a[204:207]
    v_mfma_f32_16x16x32_bf16 a[204:207], v[44:47], a[156:159], a[204:207]
    ds_read_b128 v[68:71], v1 offset:63488
    s_waitcnt lgkmcnt(3)
    v_mfma_f32_16x16x32_bf16 a[208:211], v[140:143], a[8:11], a[208:211]
    ds_read_b128 v[116:119], v1 offset:64512
    v_mfma_f32_16x16x32_bf16 a[208:211], v[188:191], a[12:15], a[208:211]
    v_mfma_f32_16x16x32_bf16 a[212:215], v[140:143], a[56:59], a[212:215]
    v_mfma_f32_16x16x32_bf16 a[212:215], v[188:191], a[60:63], a[212:215]
    v_mfma_f32_16x16x32_bf16 a[216:219], v[140:143], a[104:107], a[216:219]
    v_mfma_f32_16x16x32_bf16 a[216:219], v[188:191], a[108:111], a[216:219]
    v_mfma_f32_16x16x32_bf16 a[220:223], v[140:143], a[152:155], a[220:223]
    v_mfma_f32_16x16x32_bf16 a[220:223], v[188:191], a[156:159], a[220:223]
    ds_read_b128 v[236:239], v2
    s_waitcnt lgkmcnt(3)
    v_mfma_f32_16x16x32_bf16 a[224:227], v[204:207], a[8:11], a[224:227]
    ds_read_b128 v[252:255], v2 offset:1024
    v_mfma_f32_16x16x32_bf16 a[224:227], v[228:231], a[12:15], a[224:227]
    buffer_load_dwordx4 a[36:39], v6, s[4:7], 0 offen offset:576
    v_mfma_f32_16x16x32_bf16 a[228:231], v[204:207], a[56:59], a[228:231]
    v_mfma_f32_16x16x32_bf16 a[228:231], v[228:231], a[60:63], a[228:231]
    v_mfma_f32_16x16x32_bf16 a[232:235], v[204:207], a[104:107], a[232:235]
    v_mfma_f32_16x16x32_bf16 a[232:235], v[228:231], a[108:111], a[232:235]
    v_mfma_f32_16x16x32_bf16 a[236:239], v[204:207], a[152:155], a[236:239]
    v_mfma_f32_16x16x32_bf16 a[236:239], v[228:231], a[156:159], a[236:239]
    ds_read_b128 v[24:27], v2 offset:2048
    s_waitcnt lgkmcnt(3)
    v_mfma_f32_16x16x32_bf16 a[240:243], v[68:71], a[8:11], a[240:243]
    ds_read_b128 v[44:47], v2 offset:3072
    v_mfma_f32_16x16x32_bf16 a[240:243], v[116:119], a[12:15], a[240:243]
    v_mfma_f32_16x16x32_bf16 a[244:247], v[68:71], a[56:59], a[244:247]
    v_mfma_f32_16x16x32_bf16 a[244:247], v[116:119], a[60:63], a[244:247]
    v_mfma_f32_16x16x32_bf16 a[248:251], v[68:71], a[104:107], a[248:251]
    v_mfma_f32_16x16x32_bf16 a[248:251], v[116:119], a[108:111], a[248:251]
    v_mfma_f32_16x16x32_bf16 a[252:255], v[68:71], a[152:155], a[252:255]
    v_mfma_f32_16x16x32_bf16 a[252:255], v[116:119], a[156:159], a[252:255]
    ds_read_b128 v[140:143], v2 offset:4096
    s_waitcnt lgkmcnt(3)
    v_mfma_f32_16x16x32_bf16 v[36:39], v[236:239], a[16:19], v[36:39]
    ds_read_b128 v[188:191], v2 offset:5120
    v_mfma_f32_16x16x32_bf16 v[36:39], v[252:255], a[20:23], v[36:39]
    s_waitcnt vmcnt(21)
    s_barrier
    v_mfma_f32_16x16x32_bf16 v[48:51], v[236:239], a[64:67], v[48:51]
    s_add_u32 m0, s17, 24576
    v_mfma_f32_16x16x32_bf16 v[48:51], v[252:255], a[68:71], v[48:51]
    buffer_load_dwordx4 a[80:83], v7, s[4:7], 0 offen offset:512
    s_waitcnt vmcnt(21)
    v_mfma_f32_16x16x32_bf16 v[52:55], v[236:239], a[112:115], v[52:55]
    global_load_lds_dwordx4 v4, s[34:35] offset:-3072 sc1
    s_waitcnt vmcnt(21)
    v_mfma_f32_16x16x32_bf16 v[52:55], v[252:255], a[116:119], v[52:55]
    s_waitcnt vmcnt(20)
    v_mfma_f32_16x16x32_bf16 v[56:59], v[236:239], a[160:163], v[56:59]
    s_waitcnt vmcnt(19)
    v_mfma_f32_16x16x32_bf16 v[56:59], v[252:255], a[164:167], v[56:59]
    ds_read_b128 v[68:71], v2 offset:6144
    s_waitcnt lgkmcnt(3)
    v_mfma_f32_16x16x32_bf16 v[64:67], v[24:27], a[16:19], v[64:67]
    ds_read_b128 v[116:119], v2 offset:7168
    v_mfma_f32_16x16x32_bf16 v[64:67], v[44:47], a[20:23], v[64:67]
    global_load_lds_dwordx4 v4, s[34:35] offset:-2048 sc1
    v_mfma_f32_16x16x32_bf16 v[72:75], v[24:27], a[64:67], v[72:75]
    ds_write_b128 v12, a[160:163] offset:4096
    v_mfma_f32_16x16x32_bf16 v[72:75], v[44:47], a[68:71], v[72:75]
    v_mfma_f32_16x16x32_bf16 v[76:79], v[24:27], a[112:115], v[76:79]
    v_mfma_f32_16x16x32_bf16 v[76:79], v[44:47], a[116:119], v[76:79]
    v_mfma_f32_16x16x32_bf16 v[80:83], v[24:27], a[160:163], v[80:83]
    v_mfma_f32_16x16x32_bf16 v[80:83], v[44:47], a[164:167], v[80:83]
    ds_read_b128 v[204:207], v2 offset:8192
    s_waitcnt lgkmcnt(4)
    v_mfma_f32_16x16x32_bf16 v[88:91], v[140:143], a[16:19], v[88:91]
    ds_read_b128 v[228:231], v2 offset:9216
    v_mfma_f32_16x16x32_bf16 v[88:91], v[188:191], a[20:23], v[88:91]
    global_load_lds_dwordx4 v4, s[34:35] offset:-1024 sc1
    v_mfma_f32_16x16x32_bf16 v[96:99], v[140:143], a[64:67], v[96:99]
    ds_write_b128 v12, a[164:167] offset:5120
    v_mfma_f32_16x16x32_bf16 v[96:99], v[188:191], a[68:71], v[96:99]
    v_mfma_f32_16x16x32_bf16 v[100:103], v[140:143], a[112:115], v[100:103]
L_st0:
    s_cbranch_execz L_st3
    v_mfma_f32_16x16x32_bf16 v[100:103], v[188:191], a[116:119], v[100:103]
    v_mfma_f32_16x16x32_bf16 v[104:107], v[140:143], a[160:163], v[104:107]
    v_mfma_f32_16x16x32_bf16 v[104:107], v[188:191], a[164:167], v[104:107]
    ds_read_b128 v[24:27], v2 offset:10240
    s_waitcnt lgkmcnt(5)
    v_mfma_f32_16x16x32_bf16 v[112:115], v[68:71], a[16:19], v[112:115]
    ds_read_b128 v[236:239], v2 offset:11264
    v_mfma_f32_16x16x32_bf16 v[112:115], v[116:119], a[20:23], v[112:115]
    buffer_load_dwordx4 a[84:87], v7, s[4:7], 0 offen offset:576
    v_mfma_f32_16x16x32_bf16 v[120:123], v[68:71], a[64:67], v[120:123]
    global_load_lds_dwordx4 v4, s[34:35] sc1
    v_mfma_f32_16x16x32_bf16 v[120:123], v[116:119], a[68:71], v[120:123]
    v_mfma_f32_16x16x32_bf16 v[124:127], v[68:71], a[112:115], v[124:127]
    v_mfma_f32_16x16x32_bf16 v[124:127], v[116:119], a[116:119], v[124:127]
    v_mfma_f32_16x16x32_bf16 v[128:131], v[68:71], a[160:163], v[128:131]
    v_mfma_f32_16x16x32_bf16 v[128:131], v[116:119], a[164:167], v[128:131]
    ds_read_b128 v[252:255], v2 offset:12288
    s_waitcnt lgkmcnt(4)
    v_mfma_f32_16x16x32_bf16 v[136:139], v[204:207], a[16:19], v[136:139]
    ds_read_b128 v[44:47], v2 offset:13312
    v_mfma_f32_16x16x32_bf16 v[136:139], v[228:231], a[20:23], v[136:139]
    global_load_lds_dwordx4 v4, s[34:35] offset:1024 sc1
    v_mfma_f32_16x16x32_bf16 v[144:147], v[204:207], a[64:67], v[144:147]
    v_mfma_f32_16x16x32_bf16 v[144:147], v[228:231], a[68:71], v[144:147]
    v_mfma_f32_16x16x32_bf16 v[148:151], v[204:207], a[112:115], v[148:151]
    v_mfma_f32_16x16x32_bf16 v[148:151], v[228:231], a[116:119], v[148:151]
    v_mfma_f32_16x16x32_bf16 v[152:155], v[204:207], a[160:163], v[152:155]
    v_mfma_f32_16x16x32_bf16 v[152:155], v[228:231], a[164:167], v[152:155]
    ds_read_b128 v[68:71], v2 offset:14336
    s_waitcnt lgkmcnt(3)
    v_mfma_f32_16x16x32_bf16 v[160:163], v[24:27], a[16:19], v[160:163]
    ds_read_b128 v[116:119], v2 offset:15360
    v_mfma_f32_16x16x32_bf16 v[160:163], v[236:239], a[20:23], v[160:163]
    global_load_lds_dwordx4 v4, s[34:35] offset:2048 sc1
    v_mfma_f32_16x16x32_bf16 v[168:171], v[24:27], a[64:67], v[168:171]
    v_add_u32 v4, 24576, v4
    v_mfma_f32_16x16x32_bf16 v[168:171], v[236:239], a[68:71], v[168:171]
    buffer_load_dwordx4 a[128:131], v8, s[4:7], 0 offen offset:512
    v_mfma_f32_16x16x32_bf16 v[172:175], v[24:27], a[112:115], v[172:175]
    v_mfma_f32_16x16x32_bf16 v[172:175], v[236:239], a[116:119], v[172:175]
    v_mfma_f32_16x16x32_bf16 v[176:179], v[24:27], a[160:163], v[176:179]
    v_mfma_f32_16x16x32_bf16 v[176:179], v[236:239], a[164:167], v[176:179]
    ds_read_b128 v[140:143], v2 offset:16384
    s_waitcnt lgkmcnt(3)
    v_mfma_f32_16x16x32_bf16 v[184:187], v[252:255], a[16:19], v[184:187]
    ds_read_b128 v[188:191], v2 offset:17408
    v_mfma_f32_16x16x32_bf16 v[184:187], v[44:47], a[20:23], v[184:187]
    v_mfma_f32_16x16x32_bf16 v[192:195], v[252:255], a[64:67], v[192:195]
    v_mfma_f32_16x16x32_bf16 v[192:195], v[44:47], a[68:71], v[192:195]
    v_mfma_f32_16x16x32_bf16 v[196:199], v[252:255], a[112:115], v[196:199]
    v_mfma_f32_16x16x32_bf16 v[196:199], v[44:47], a[116:119], v[196:199]
    v_mfma_f32_16x16x32_bf16 v[200:203], v[252:255], a[160:163], v[200:203]
    v_mfma_f32_16x16x32_bf16 v[200:203], v[44:47], a[164:167], v[200:203]
    ds_read_b128 v[24:27], v2 offset:18432
    s_waitcnt lgkmcnt(3)
    v_mfma_f32_16x16x32_bf16 v[208:211], v[68:71], a[16:19], v[208:211]
    ds_read_b128 v[204:207], v2 offset:19456
    v_mfma_f32_16x16x32_bf16 v[208:211], v[116:119], a[20:23], v[208:211]
    v_mfma_f32_16x16x32_bf16 v[216:219], v[68:71], a[64:67], v[216:219]
    v_mfma_f32_16x16x32_bf16 v[216:219], v[116:119], a[68:71], v[216:219]
    v_mfma_f32_16x16x32_bf16 v[220:223], v[68:71], a[112:115], v[220:223]
    v_mfma_f32_16x16x32_bf16 v[220:223], v[116:119], a[116:119], v[220:223]
    v_mfma_f32_16x16x32_bf16 v[224:227], v[68:71], a[160:163], v[224:227]
    v_mfma_f32_16x16x32_bf16 v[224:227], v[116:119], a[164:167], v[224:227]
    ds_read_b128 v[44:47], v2 offset:20480
    s_waitcnt lgkmcnt(3)
    v_mfma_f32_16x16x32_bf16 v[232:235], v[140:143], a[16:19], v[232:235]
    ds_read_b128 v[228:231], v2 offset:21504
    v_mfma_f32_16x16x32_bf16 v[232:235], v[188:191], a[20:23], v[232:235]
    buffer_load_dwordx4 a[132:135], v8, s[4:7], 0 offen offset:576
    v_mfma_f32_16x16x32_bf16 v[240:243], v[140:143], a[64:67], v[240:243]
    v_mfma_f32_16x16x32_bf16 v[240:243], v[188:191], a[68:71], v[240:243]
    v_mfma_f32_16x16x32_bf16 v[244:247], v[140:143], a[112:115], v[244:247]
    v_mfma_f32_16x16x32_bf16 v[244:247], v[188:191], a[116:119], v[244:247]
    v_mfma_f32_16x16x32_bf16 v[248:251], v[140:143], a[160:163], v[248:251]
    v_mfma_f32_16x16x32_bf16 v[248:251], v[188:191], a[164:167], v[248:251]
    ds_read_b128 v[236:239], v2 offset:22528
    s_waitcnt lgkmcnt(3)
    v_mfma_f32_16x16x32_bf16 v[20:23], v[24:27], a[16:19], v[20:23]
    ds_read_b128 v[252:255], v2 offset:23552
    v_mfma_f32_16x16x32_bf16 v[20:23], v[204:207], a[20:23], v[20:23]
    v_mfma_f32_16x16x32_bf16 v[28:31], v[24:27], a[64:67], v[28:31]
    v_mfma_f32_16x16x32_bf16 v[28:31], v[204:207], a[68:71], v[28:31]
    v_mfma_f32_16x16x32_bf16 v[32:35], v[24:27], a[112:115], v[32:35]
    v_mfma_f32_16x16x32_bf16 v[32:35], v[204:207], a[116:119], v[32:35]
    v_mfma_f32_16x16x32_bf16 v[40:43], v[24:27], a[160:163], v[40:43]
    v_mfma_f32_16x16x32_bf16 v[40:43], v[204:207], a[164:167], v[40:43]
    ds_read_b128 v[68:71], v2 offset:24576
    s_waitcnt lgkmcnt(3)
    v_mfma_f32_16x16x32_bf16 v[60:63], v[44:47], a[16:19], v[60:63]
    ds_read_b128 v[116:119], v2 offset:25600
    v_mfma_f32_16x16x32_bf16 v[60:63], v[228:231], a[20:23], v[60:63]
    v_mfma_f32_16x16x32_bf16 v[84:87], v[44:47], a[64:67], v[84:87]
    v_mfma_f32_16x16x32_bf16 v[84:87], v[228:231], a[68:71], v[84:87]
    buffer_load_dwordx4 a[176:179], v9, s[4:7], 0 offen offset:512
    v_mfma_f32_16x16x32_bf16 v[92:95], v[44:47], a[112:115], v[92:95]
    v_mfma_f32_16x16x32_bf16 v[92:95], v[228:231], a[116:119], v[92:95]
    v_mfma_f32_16x16x32_bf16 v[108:111], v[44:47], a[160:163], v[108:111]
    v_mfma_f32_16x16x32_bf16 v[108:111], v[228:231], a[164:167], v[108:111]
    ds_read_b128 v[24:27], v2 offset:26624
    s_waitcnt lgkmcnt(3)
    v_mfma_f32_16x16x32_bf16 v[132:135], v[236:239], a[16:19], v[132:135]
    ds_read_b128 v[140:143], v2 offset:27648
    v_mfma_f32_16x16x32_bf16 v[132:135], v[252:255], a[20:23], v[132:135]
    s_waitcnt vmcnt(25)
    v_cmp_gt_u32 vcc, 72, v213
    s_nop 0
    s_cbranch_vccnz L_slowC
L_backC:
    v_mfma_f32_16x16x32_bf16 v[156:159], v[236:239], a[64:67], v[156:159]
    v_mfma_f32_16x16x32_bf16 v[156:159], v[252:255], a[68:71], v[156:159]
    v_mfma_f32_16x16x32_bf16 v[164:167], v[236:239], a[112:115], v[164:167]
    v_mfma_f32_16x16x32_bf16 v[164:167], v[252:255], a[116:119], v[164:167]
    v_mfma_f32_16x16x32_bf16 v[180:183], v[236:239], a[160:163], v[180:183]
    v_mfma_f32_16x16x32_bf16 v[180:183], v[252:255], a[164:167], v[180:183]
    ds_read_b128 v[44:47], v2 offset:28672
    s_waitcnt lgkmcnt(3)
    v_mfma_f32_16x16x32_bf16 a[192:195], v[68:71], a[16:19], a[192:195]
    ds_read_b128 v[188:191], v2 offset:29696
    v_mfma_f32_16x16x32_bf16 a[192:195], v[116:119], a[20:23], a[192:195]
    s_waitcnt vmcnt(13)
    s_barrier
    v_mfma_f32_16x16x32_bf16 a[196:199], v[68:71], a[64:67], a[196:199]
    s_add_u32 m0, s17, 49152
    v_mfma_f32_16x16x32_bf16 a[196:199], v[116:119], a[68:71], a[196:199]
    global_load_lds_dwordx4 v4, s[34:35] offset:-3072 sc1
    v_mfma_f32_16x16x32_bf16 a[200:203], v[68:71], a[112:115], a[200:203]
    v_mfma_f32_16x16x32_bf16 a[200:203], v[116:119], a[116:119], a[200:203]
    v_mfma_f32_16x16x32_bf16 a[204:207], v[68:71], a[160:163], a[204:207]
    v_mfma_f32_16x16x32_bf16 a[204:207], v[116:119], a[164:167], a[204:207]
    ds_read_b128 v[204:207], v2 offset:30720
    s_waitcnt lgkmcnt(3)
    v_mfma_f32_16x16x32_bf16 a[208:211], v[24:27], a[16:19], a[208:211]
    ds_read_b128 v[212:215], v2 offset:31744
    v_mfma_f32_16x16x32_bf16 a[208:211], v[140:143], a[20:23], a[208:211]
    buffer_load_dwordx4 a[180:183], v9, s[4:7], 0 offen offset:576
    v_mfma_f32_16x16x32_bf16 a[212:215], v[24:27], a[64:67], a[212:215]
    global_load_lds_dwordx4 v4, s[34:35] offset:-2048 sc1
    v_mfma_f32_16x16x32_bf16 a[212:215], v[140:143], a[68:71], a[212:215]
    v_mfma_f32_16x16x32_bf16 a[216:219], v[24:27], a[112:115], a[216:219]
    v_mfma_f32_16x16x32_bf16 a[216:219], v[140:143], a[116:119], a[216:219]
    v_mfma_f32_16x16x32_bf16 a[220:223], v[24:27], a[160:163], a[220:223]
    v_mfma_f32_16x16x32_bf16 a[220:223], v[140:143], a[164:167], a[220:223]
    ds_read_b128 v[68:71], v1
    s_waitcnt lgkmcnt(3)
    v_mfma_f32_16x16x32_bf16 a[224:227], v[44:47], a[16:19], a[224:227]
    ds_read_b128 v[116:119], v1 offset:1024
    v_mfma_f32_16x16x32_bf16 a[224:227], v[188:191], a[20:23], a[224:227]
    global_load_lds_dwordx4 v4, s[34:35] offset:-1024 sc1
    v_mfma_f32_16x16x32_bf16 a[228:231], v[44:47], a[64:67], a[228:231]
    v_mfma_f32_16x16x32_bf16 a[228:231], v[188:191], a[68:71], a[228:231]
    v_mfma_f32_16x16x32_bf16 a[232:235], v[44:47], a[112:115], a[232:235]
    v_mfma_f32_16x16x32_bf16 a[232:235], v[188:191], a[116:119], a[232:235]
    v_mfma_f32_16x16x32_bf16 a[236:239], v[44:47], a[160:163], a[236:239]
    v_mfma_f32_16x16x32_bf16 a[236:239], v[188:191], a[164:167], a[236:239]
    ds_read_b128 v[228:231], v1 offset:2048
    s_waitcnt lgkmcnt(3)
    v_mfma_f32_16x16x32_bf16 a[240:243], v[204:207], a[16:19], a[240:243]
    ds_read_b128 v[236:239], v1 offset:3072
    v_mfma_f32_16x16x32_bf16 a[240:243], v[212:215], a[20:23], a[240:243]
    global_load_lds_dwordx4 v4, s[34:35] sc1
    v_mfma_f32_16x16x32_bf16 a[244:247], v[204:207], a[64:67], a[244:247]
    v_mfma_f32_16x16x32_bf16 a[244:247], v[212:215], a[68:71], a[244:247]
    buffer_load_dwordx4 a[40:43], v6, s[4:7], 0 offen offset:640
    v_mfma_f32_16x16x32_bf16 a[248:251], v[204:207], a[112:115], a[248:251]
    v_mfma_f32_16x16x32_bf16 a[248:251], v[212:215], a[116:119], a[248:251]
    v_mfma_f32_16x16x32_bf16 a[252:255], v[204:207], a[160:163], a[252:255]
    v_mfma_f32_16x16x32_bf16 a[252:255], v[212:215], a[164:167], a[252:255]
    ds_read_b128 v[252:255], v1 offset:4096
    s_waitcnt lgkmcnt(3)
    v_mfma_f32_16x16x32_bf16 v[36:39], v[68:71], a[24:27], v[36:39]
    ds_read_b128 v[24:27], v1 offset:5120
    v_mfma_f32_16x16x32_bf16 v[36:39], v[116:119], a[28:31], v[36:39]
    global_load_lds_dwordx4 v4, s[34:35] offset:1024 sc1
    v_mfma_f32_16x16x32_bf16 v[48:51], v[68:71], a[72:75], v[48:51]
    v_mfma_f32_16x16x32_bf16 v[48:51], v[116:119], a[76:79], v[48:51]
    v_mfma_f32_16x16x32_bf16 v[52:55], v[68:71], a[120:123], v[52:55]
    v_mfma_f32_16x16x32_bf16 v[52:55], v[116:119], a[124:127], v[52:55]
    v_mfma_f32_16x16x32_bf16 v[56:59], v[68:71], a[168:171], v[56:59]
    v_mfma_f32_16x16x32_bf16 v[56:59], v[116:119], a[172:175], v[56:59]
    ds_read_b128 v[44:47], v1 offset:6144
    s_waitcnt lgkmcnt(3)
    v_mfma_f32_16x16x32_bf16 v[64:67], v[228:231], a[24:27], v[64:67]
    ds_read_b128 v[140:143], v1 offset:7168
    v_mfma_f32_16x16x32_bf16 v[64:67], v[236:239], a[28:31], v[64:67]
    global_load_lds_dwordx4 v4, s[34:35] offset:2048 sc1
    v_mfma_f32_16x16x32_bf16 v[72:75], v[228:231], a[72:75], v[72:75]
    v_add_u32 v4, 24576, v4
    v_mfma_f32_16x16x32_bf16 v[72:75], v[236:239], a[76:79], v[72:75]
    ds_write_b128 v12, a[168:171] offset:6144
    v_mfma_f32_16x16x32_bf16 v[76:79], v[228:231], a[120:123], v[76:79]
    v_mfma_f32_16x16x32_bf16 v[76:79], v[236:239], a[124:127], v[76:79]
    v_mfma_f32_16x16x32_bf16 v[80:83], v[228:231], a[168:171], v[80:83]
    v_mfma_f32_16x16x32_bf16 v[80:83], v[236:239], a[172:175], v[80:83]
    ds_read_b128 v[68:71], v1 offset:8192
    s_waitcnt lgkmcnt(4)
    v_mfma_f32_16x16x32_bf16 v[88:91], v[252:255], a[24:27], v[88:91]
    ds_read_b128 v[116:119], v1 offset:9216
    v_mfma_f32_16x16x32_bf16 v[88:91], v[24:27], a[28:31], v[88:91]
    buffer_load_dwordx4 a[44:47], v6, s[4:7], 0 offen offset:704
    v_mfma_f32_16x16x32_bf16 v[96:99], v[252:255], a[72:75], v[96:99]
    ds_write_b128 v12, a[172:175] offset:7168
    v_mfma_f32_16x16x32_bf16 v[96:99], v[24:27], a[76:79], v[96:99]
    v_mfma_f32_16x16x32_bf16 v[100:103], v[252:255], a[120:123], v[100:103]
    v_mfma_f32_16x16x32_bf16 v[100:103], v[24:27], a[124:127], v[100:103]
    v_mfma_f32_16x16x32_bf16 v[104:107], v[252:255], a[168:171], v[104:107]
    v_mfma_f32_16x16x32_bf16 v[104:107], v[24:27], a[172:175], v[104:107]
    ds_read_b128 v[188:191], v1 offset:10240
    s_waitcnt lgkmcnt(5)
    v_mfma_f32_16x16x32_bf16 v[112:115], v[44:47], a[24:27], v[112:115]
    ds_read_b128 v[204:207], v1 offset:11264
    v_mfma_f32_16x16x32_bf16 v[112:115], v[140:143], a[28:31], v[112:115]
    v_mfma_f32_16x16x32_bf16 v[120:123], v[44:47], a[72:75], v[120:123]
    v_mfma_f32_16x16x32_bf16 v[120:123], v[140:143], a[76:79], v[120:123]
    v_mfma_f32_16x16x32_bf16 v[124:127], v[44:47], a[120:123], v[124:127]
    v_mfma_f32_16x16x32_bf16 v[124:127], v[140:143], a[124:127], v[124:127]
    v_mfma_f32_16x16x32_bf16 v[128:131], v[44:47], a[168:171], v[128:131]
    v_mfma_f32_16x16x32_bf16 v[128:131], v[140:143], a[172:175], v[128:131]
    ds_read_b128 v[212:215], v1 offset:12288
    s_waitcnt lgkmcnt(4)
    v_mfma_f32_16x16x32_bf16 v[136:139], v[68:71], a[24:27], v[136:139]
    ds_read_b128 v[228:231], v1 offset:13312
    v_mfma_f32_16x16x32_bf16 v[136:139], v[116:119], a[28:31], v[136:139]
    v_mfma_f32_16x16x32_bf16 v[144:147], v[68:71], a[72:75], v[144:147]
    v_mfma_f32_16x16x32_bf16 v[144:147], v[116:119], a[76:79], v[144:147]
    buffer_load_dwordx4 a[88:91], v7, s[4:7], 0 offen offset:640
    v_mfma_f32_16x16x32_bf16 v[148:151], v[68:71], a[120:123], v[148:151]
    v_mfma_f32_16x16x32_bf16 v[148:151], v[116:119], a[124:127], v[148:151]
    v_mfma_f32_16x16x32_bf16 v[152:155], v[68:71], a[168:171], v[152:155]
    v_mfma_f32_16x16x32_bf16 v[152:155], v[116:119], a[172:175], v[152:155]
    ds_read_b128 v[236:239], v1 offset:14336
    s_waitcnt lgkmcnt(3)
    v_mfma_f32_16x16x32_bf16 v[160:163], v[188:191], a[24:27], v[160:163]
    ds_read_b128 v[24:27], v1 offset:15360
    v_mfma_f32_16x16x32_bf16 v[160:163], v[204:207], a[28:31], v[160:163]
    v_mfma_f32_16x16x32_bf16 v[168:171], v[188:191], a[72:75], v[168:171]
    v_mfma_f32_16x16x32_bf16 v[168:171], v[204:207], a[76:79], v[168:171]
    v_mfma_f32_16x16x32_bf16 v[172:175], v[188:191], a[120:123], v[172:175]
    v_mfma_f32_16x16x32_bf16 v[172:175], v[204:207], a[124:127], v[172:175]
    v_mfma_f32_16x16x32_bf16 v[176:179], v[188:191], a[168:171], v[176:179]
    v_mfma_f32_16x16x32_bf16 v[176:179], v[204:207], a[172:175], v[176:179]
    ds_read_b128 v[44:47], v1 offset:16384
    s_waitcnt lgkmcnt(3)
    v_mfma_f32_16x16x32_bf16 v[184:187], v[212:215], a[24:27], v[184:187]
    ds_read_b128 v[68:71], v1 offset:17408
    v_mfma_f32_16x16x32_bf16 v[184:187], v[228:231], a[28:31], v[184:187]
    v_mfma_f32_16x16x32_bf16 v[192:195], v[212:215], a[72:75], v[192:195]
    v_mfma_f32_16x16x32_bf16 v[192:195], v[228:231], a[76:79], v[192:195]
    v_mfma_f32_16x16x32_bf16 v[196:199], v[212:215], a[120:123], v[196:199]
    v_mfma_f32_16x16x32_bf16 v[196:199], v[228:231], a[124:127], v[196:199]
    v_mfma_f32_16x16x32_bf16 v[200:203], v[212:215], a[168:171], v[200:203]
    v_mfma_f32_16x16x32_bf16 v[200:203], v[228:231], a[172:175], v[200:203]
    ds_read_b128 v[116:119], v1 offset:18432
    s_waitcnt lgkmcnt(3)
    v_mfma_f32_16x16x32_bf16 v[208:211], v[236:239], a[24:27], v[208:211]
    ds_read_b128 v[140:143], v1 offset:19456
    v_mfma_f32_16x16x32_bf16 v[208:211], v[24:27], a[28:31], v[208:211]
    buffer_load_dwordx4 a[92:95], v7, s[4:7], 0 offen offset:704
    v_mfma_f32_16x16x32_bf16 v[216:219], v[236:239], a[72:75], v[216:219]
    v_mfma_f32_16x16x32_bf16 v[216:219], v[24:27], a[76:79], v[216:219]
    v_mfma_f32_16x16x32_bf16 v[220:223], v[236:239], a[120:123], v[220:223]
    v_mfma_f32_16x16x32_bf16 v[220:223], v[24:27], a[124:127], v[220:223]
    v_mfma_f32_16x16x32_bf16 v[224:227], v[236:239], a[168:171], v[224:227]
    v_mfma_f32_16x16x32_bf16 v[224:227], v[24:27], a[172:175], v[224:227]
    ds_read_b128 v[188:191], v1 offset:20480
    s_waitcnt lgkmcnt(3)
    v_mfma_f32_16x16x32_bf16 v[232:235], v[44:47], a[24:27], v[232:235]
    ds_read_b128 v[204:207], v1 offset:21504
    v_mfma_f32_16x16x32_bf16 v[232:235], v[68:71], a[28:31], v[232:235]
    s_waitcnt vmcnt(14)
    s_barrier
    v_mfma_f32_16x16x32_bf16 v[240:243], v[44:47], a[72:75], v[240:243]
    s_add_u32 m0, s17, 73728
    v_mfma_f32_16x16x32_bf16 v[240:243], v[68:71], a[76:79], v[240:243]
    global_load_lds_dwordx4 v4, s[34:35] offset:-3072 sc1
    v_mfma_f32_16x16x32_bf16 v[244:247], v[44:47], a[120:123], v[244:247]
    v_mfma_f32_16x16x32_bf16 v[244:247], v[68:71], a[124:127], v[244:247]
    v_mfma_f32_16x16x32_bf16 v[248:251], v[44:47], a[168:171], v[248:251]
    v_mfma_f32_16x16x32_bf16 v[248:251], v[68:71], a[172:175], v[248:251]
    ds_read_b128 v[24:27], v1 offset:22528
    s_waitcnt lgkmcnt(3)
    v_mfma_f32_16x16x32_bf16 v[20:23], v[116:119], a[24:27], v[20:23]
    ds_read_b128 v[212:215], v1 offset:23552
    v_mfma_f32_16x16x32_bf16 v[20:23], v[140:143], a[28:31], v[20:23]
    global_load_lds_dwordx4 v4, s[34:35] offset:-2048 sc1
    v_mfma_f32_16x16x32_bf16 v[28:31], v[116:119], a[72:75], v[28:31]
    v_mfma_f32_16x16x32_bf16 v[28:31], v[140:143], a[76:79], v[28:31]
    buffer_load_dwordx4 a[136:139], v8, s[4:7], 0 offen offset:640
    v_mfma_f32_16x16x32_bf16 v[32:35], v[116:119], a[120:123], v[32:35]
    v_mfma_f32_16x16x32_bf16 v[32:35], v[140:143], a[124:127], v[32:35]
    v_mfma_f32_16x16x32_bf16 v[40:43], v[116:119], a[168:171], v[40:43]
    v_mfma_f32_16x16x32_bf16 v[40:43], v[140:143], a[172:175], v[40:43]
    ds_read_b128 v[228:231], v1 offset:24576
    s_waitcnt lgkmcnt(3)
    v_mfma_f32_16x16x32_bf16 v[60:63], v[188:191], a[24:27], v[60:63]
    ds_read_b128 v[236:239], v1 offset:25600
    v_mfma_f32_16x16x32_bf16 v[60:63], v[204:207], a[28:31], v[60:63]
    global_load_lds_dwordx4 v4, s[34:35] offset:-1024 sc1
    v_mfma_f32_16x16x32_bf16 v[84:87], v[188:191], a[72:75], v[84:87]
    v_mfma_f32_16x16x32_bf16 v[84:87], v[204:207], a[76:79], v[84:87]
    v_mfma_f32_16x16x32_bf16 v[92:95], v[188:191], a[120:123], v[92:95]
    v_mfma_f32_16x16x32_bf16 v[92:95], v[204:207], a[124:127], v[92:95]
    v_mfma_f32_16x16x32_bf16 v[108:111], v[188:191], a[168:171], v[108:111]
    v_mfma_f32_16x16x32_bf16 v[108:111], v[204:207], a[172:175], v[108:111]
    ds_read_b128 v[252:255], v1 offset:26624
    s_waitcnt lgkmcnt(3)
    v_mfma_f32_16x16x32_bf16 v[132:135], v[24:27], a[24:27], v[132:135]
    ds_read_b128 v[44:47], v1 offset:27648
    v_mfma_f32_16x16x32_bf16 v[132:135], v[212:215], a[28:31], v[132:135]
    global_load_lds_dwordx4 v4, s[34:35] sc1
    v_mfma_f32_16x16x32_bf16 v[156:159], v[24:27], a[72:75], v[156:159]
    v_mfma_f32_16x16x32_bf16 v[156:159], v[212:215], a[76:79], v[156:159]
    v_mfma_f32_16x16x32_bf16 v[164:167], v[24:27], a[120:123], v[164:167]
    v_mfma_f32_16x16x32_bf16 v[164:167], v[212:215], a[124:127], v[164:167]
    v_mfma_f32_16x16x32_bf16 v[180:183], v[24:27], a[168:171], v[180:183]
    v_mfma_f32_16x16x32_bf16 v[180:183], v[212:215], a[172:175], v[180:183]
    ds_read_b128 v[68:71], v1 offset:28672
    s_waitcnt lgkmcnt(3)
    v_mfma_f32_16x16x32_bf16 a[192:195], v[228:231], a[24:27], a[192:195]
    ds_read_b128 v[116:119], v1 offset:29696
    v_mfma_f32_16x16x32_bf16 a[192:195], v[236:239], a[28:31], a[192:195]
    buffer_load_dwordx4 a[140:143], v8, s[4:7], 0 offen offset:704
    v_mfma_f32_16x16x32_bf16 a[196:199], v[228:231], a[72:75], a[196:199]
    global_load_lds_dwordx4 v4, s[34:35] offset:1024 sc1
    v_mfma_f32_16x16x32_bf16 a[196:199], v[236:239], a[76:79], a[196:199]
    v_mfma_f32_16x16x32_bf16 a[200:203], v[228:231], a[120:123], a[200:203]
    v_mfma_f32_16x16x32_bf16 a[200:203], v[236:239], a[124:127], a[200:203]
    v_mfma_f32_16x16x32_bf16 a[204:207], v[228:231], a[168:171], a[204:207]
    v_mfma_f32_16x16x32_bf16 a[204:207], v[236:239], a[172:175], a[204:207]
    ds_read_b128 v[24:27], v1 offset:30720
    s_waitcnt lgkmcnt(3)
    v_mfma_f32_16x16x32_bf16 a[208:211], v[252:255], a[24:27], a[208:211]
    ds_read_b128 v[140:143], v1 offset:31744
    v_mfma_f32_16x16x32_bf16 a[208:211], v[44:47], a[28:31], a[208:211]
    global_load_lds_dwordx4 v4, s[34:35] offset:2048 sc1
    v_mfma_f32_16x16x32_bf16 a[212:215], v[252:255], a[72:75], a[212:215]
    v_add_u32 v4, 24576, v4
    v_mfma_f32_16x16x32_bf16 a[212:215], v[44:47], a[76:79], a[212:215]
    v_mfma_f32_16x16x32_bf16 a[216:219], v[252:255], a[120:123], a[216:219]
    v_mfma_f32_16x16x32_bf16 a[216:219], v[44:47], a[124:127], a[216:219]
    v_mfma_f32_16x16x32_bf16 a[220:223], v[252:255], a[168:171], a[220:223]
    v_mfma_f32_16x16x32_bf16 a[220:223], v[44:47], a[172:175], a[220:223]
    ds_read_b128 v[188:191], v1 offset:32768
    s_waitcnt lgkmcnt(3)
    v_mfma_f32_16x16x32_bf16 a[224:227], v[68:71], a[24:27], a[224:227]
    ds_read_b128 v[204:207], v1 offset:33792
    v_mfma_f32_16x16x32_bf16 a[224:227], v[116:119], a[28:31], a[224:227]
    v_mfma_f32_16x16x32_bf16 a[228:231], v[68:71], a[72:75], a[228:231]
    v_mfma_f32_16x16x32_bf16 a[228:231], v[116:119], a[76:79], a[228:231]
    buffer_load_dwordx4 a[184:187], v9, s[4:7], 0 offen offset:640
    v_mfma_f32_16x16x32_bf16 a[232:235], v[68:71], a[120:123], a[232:235]
    v_mfma_f32_16x16x32_bf16 a[232:235], v[116:119], a[124:127], a[232:235]
    v_mfma_f32_16x16x32_bf16 a[236:239], v[68:71], a[168:171], a[236:239]
    v_mfma_f32_16x16x32_bf16 a[236:239], v[116:119], a[172:175], a[236:239]
    ds_read_b128 v[212:215], v1 offset:34816
    s_waitcnt lgkmcnt(3)
    v_mfma_f32_16x16x32_bf16 a[240:243], v[24:27], a[24:27], a[240:243]
    ds_read_b128 v[228:231], v1 offset:35840
    v_mfma_f32_16x16x32_bf16 a[240:243], v[140:143], a[28:31], a[240:243]
    v_mfma_f32_16x16x32_bf16 a[244:247], v[24:27], a[72:75], a[244:247]
    v_mfma_f32_16x16x32_bf16 a[244:247], v[140:143], a[76:79], a[244:247]
    v_mfma_f32_16x16x32_bf16 a[248:251], v[24:27], a[120:123], a[248:251]
    v_mfma_f32_16x16x32_bf16 a[248:251], v[140:143], a[124:127], a[248:251]
    v_mfma_f32_16x16x32_bf16 a[252:255], v[24:27], a[168:171], a[252:255]
    v_mfma_f32_16x16x32_bf16 a[252:255], v[140:143], a[172:175], a[252:255]
    ds_read_b128 v[236:239], v1 offset:36864
    s_waitcnt lgkmcnt(3)
    v_mfma_f32_16x16x32_bf16 v[36:39], v[188:191], a[32:35], v[36:39]
    ds_read_b128 v[44:47], v1 offset:37888
    v_mfma_f32_16x16x32_bf16 v[36:39], v[204:207], a[36:39], v[36:39]
    v_mfma_f32_16x16x32_bf16 v[48:51], v[188:191], a[80:83], v[48:51]
    v_mfma_f32_16x16x32_bf16 v[48:51], v[204:207], a[84:87], v[48:51]
    s_waitcnt vmcnt(22)
    v_mfma_f32_16x16x32_bf16 v[52:55], v[188:191], a[128:131], v[52:55]
    s_waitcnt vmcnt(21)
    v_mfma_f32_16x16x32_bf16 v[52:55], v[204:207], a[132:135], v[52:55]
    s_waitcnt vmcnt(20)
    v_mfma_f32_16x16x32_bf16 v[56:59], v[188:191], a[176:179], v[56:59]
    s_waitcnt vmcnt(18)
    v_mfma_f32_16x16x32_bf16 v[56:59], v[204:207], a[180:183], v[56:59]
    ds_read_b128 v[24:27], v1 offset:38912
    s_waitcnt lgkmcnt(3)
    v_mfma_f32_16x16x32_bf16 v[64:67], v[212:215], a[32:35], v[64:67]
    ds_read_b128 v[68:71], v1 offset:39936
    v_mfma_f32_16x16x32_bf16 v[64:67], v[228:231], a[36:39], v[64:67]
    buffer_load_dwordx4 a[188:191], v9, s[4:7], 0 offen offset:704
    v_mfma_f32_16x16x32_bf16 v[72:75], v[212:215], a[80:83], v[72:75]
    ds_write_b128 v12, a[176:179] offset:8192
    v_mfma_f32_16x16x32_bf16 v[72:75], v[228:231], a[84:87], v[72:75]
    v_mfma_f32_16x16x32_bf16 v[76:79], v[212:215], a[128:131], v[76:79]
    v_mfma_f32_16x16x32_bf16 v[76:79], v[228:231], a[132:135], v[76:79]
    v_mfma_f32_16x16x32_bf16 v[80:83], v[212:215], a[176:179], v[80:83]
    v_mfma_f32_16x16x32_bf16 v[80:83], v[228:231], a[180:183], v[80:83]
    ds_read_b128 v[116:119], v1 offset:40960
    s_waitcnt lgkmcnt(4)
    v_mfma_f32_16x16x32_bf16 v[88:91], v[236:239], a[32:35], v[88:91]
    ds_read_b128 v[140:143], v1 offset:41984
    v_mfma_f32_16x16x32_bf16 v[88:91], v[44:47], a[36:39], v[88:91]
    ds_write_b128 v12, a[180:183] offset:9216
    v_mfma_f32_16x16x32_bf16 v[96:99], v[236:239], a[80:83], v[96:99]
    v_mfma_f32_16x16x32_bf16 v[96:99], v[44:47], a[84:87], v[96:99]
    v_mfma_f32_16x16x32_bf16 v[100:103], v[236:239], a[128:131], v[100:103]
    v_mfma_f32_16x16x32_bf16 v[100:103], v[44:47], a[132:135], v[100:103]
    v_mfma_f32_16x16x32_bf16 v[104:107], v[236:239], a[176:179], v[104:107]
    v_mfma_f32_16x16x32_bf16 v[104:107], v[44:47], a[180:183], v[104:107]
    ds_read_b128 v[188:191], v1 offset:43008
    s_waitcnt lgkmcnt(5)
    v_mfma_f32_16x16x32_bf16 v[112:115], v[24:27], a[32:35], v[112:115]
    ds_read_b128 v[204:207], v1 offset:44032
    v_mfma_f32_16x16x32_bf16 v[112:115], v[68:71], a[36:39], v[112:115]
    v_mfma_f32_16x16x32_bf16 v[120:123], v[24:27], a[80:83], v[120:123]
    v_mfma_f32_16x16x32_bf16 v[120:123], v[68:71], a[84:87], v[120:123]
    v_mfma_f32_16x16x32_bf16 v[124:127], v[24:27], a[128:131], v[124:127]
    v_mfma_f32_16x16x32_bf16 v[124:127], v[68:71], a[132:135], v[124:127]
    v_mfma_f32_16x16x32_bf16 v[128:131], v[24:27], a[176:179], v[128:131]
    v_mfma_f32_16x16x32_bf16 v[128:131], v[68:71], a[180:183], v[128:131]
    ds_read_b128 v[44:47], v1 offset:45056
    s_waitcnt lgkmcnt(4)
    v_mfma_f32_16x16x32_bf16 v[136:139], v[116:119], a[32:35], v[136:139]
    ds_read_b128 v[212:215], v1 offset:46080
    v_mfma_f32_16x16x32_bf16 v[136:139], v[140:143], a[36:39], v[136:139]
    s_waitcnt vmcnt(13)
    s_barrier
    v_mfma_f32_16x16x32_bf16 v[144:147], v[116:119], a[80:83], v[144:147]
    s_add_u32 m0, s17, 0
    v_mfma_f32_16x16x32_bf16 v[144:147], v[140:143], a[84:87], v[144:147]
    global_load_lds_dwordx4 v4, s[34:35] offset:-3072 sc1
    v_mfma_f32_16x16x32_bf16 v[148:151], v[116:119], a[128:131], v[148:151]
    v_mfma_f32_16x16x32_bf16 v[148:151], v[140:143], a[132:135], v[148:151]
    v_mfma_f32_16x16x32_bf16 v[152:155], v[116:119], a[176:179], v[152:155]
    v_mfma_f32_16x16x32_bf16 v[152:155], v[140:143], a[180:183], v[152:155]
    ds_read_b128 v[228:231], v1 offset:47104
    s_waitcnt lgkmcnt(3)
    v_mfma_f32_16x16x32_bf16 v[160:163], v[188:191], a[32:35], v[160:163]
    ds_read_b128 v[236:239], v1 offset:48128
    v_mfma_f32_16x16x32_bf16 v[160:163], v[204:207], a[36:39], v[160:163]
    global_load_lds_dwordx4 v4, s[34:35] offset:-2048 sc1
    v_mfma_f32_16x16x32_bf16 v[168:171], v[188:191], a[80:83], v[168:171]
    v_mfma_f32_16x16x32_bf16 v[168:171], v[204:207], a[84:87], v[168:171]
    v_mfma_f32_16x16x32_bf16 v[172:175], v[188:191], a[128:131], v[172:175]
    v_mfma_f32_16x16x32_bf16 v[172:175], v[204:207], a[132:135], v[172:175]
    v_mfma_f32_16x16x32_bf16 v[176:179], v[188:191], a[176:179], v[176:179]
    v_mfma_f32_16x16x32_bf16 v[176:179], v[204:207], a[180:183], v[176:179]
    ds_read_b128 v[252:255], v1 offset:49152
    s_waitcnt lgkmcnt(3)
    v_mfma_f32_16x16x32_bf16 v[184:187], v[44:47], a[32:35], v[184:187]
    ds_read_b128 v[24:27], v1 offset:50176
    v_mfma_f32_16x16x32_bf16 v[184:187], v[212:215], a[36:39], v[184:187]
    global_load_lds_dwordx4 v4, s[34:35] offset:-1024 sc1
    v_mfma_f32_16x16x32_bf16 v[192:195], v[44:47], a[80:83], v[192:195]
    v_mfma_f32_16x16x32_bf16 v[192:195], v[212:215], a[84:87], v[192:195]
    v_mfma_f32_16x16x32_bf16 v[196:199], v[44:47], a[128:131], v[196:199]
    v_mfma_f32_16x16x32_bf16 v[196:199], v[212:215], a[132:135], v[196:199]
    v_mfma_f32_16x16x32_bf16 v[200:203], v[44:47], a[176:179], v[200:203]
    v_mfma_f32_16x16x32_bf16 v[200:203], v[212:215], a[180:183], v[200:203]
    ds_read_b128 v[68:71], v1 offset:51200
    s_waitcnt lgkmcnt(3)
    v_mfma_f32_16x16x32_bf16 v[208:211], v[228:231], a[32:35], v[208:211]
    ds_read_b128 v[116:119], v1 offset:52224
    v_mfma_f32_16x16x32_bf16 v[208:211], v[236:239], a[36:39], v[208:211]
    global_load_lds_dwordx4 v4, s[34:35] sc1
    v_mfma_f32_16x16x32_bf16 v[216:219], v[228:231], a[80:83], v[216:219]
    v_mfma_f32_16x16x32_bf16 v[216:219], v[236:239], a[84:87], v[216:219]
    v_mfma_f32_16x16x32_bf16 v[220:223], v[228:231], a[128:131], v[220:223]
    v_mfma_f32_16x16x32_bf16 v[220:223], v[236:239], a[132:135], v[220:223]
    v_mfma_f32_16x16x32_bf16 v[224:227], v[228:231], a[176:179], v[224:227]
    v_mfma_f32_16x16x32_bf16 v[224:227], v[236:239], a[180:183], v[224:227]
    ds_read_b128 v[44:47], v1 offset:53248
    s_waitcnt lgkmcnt(3)
    v_mfma_f32_16x16x32_bf16 v[232:235], v[252:255], a[32:35], v[232:235]
    ds_read_b128 v[140:143], v1 offset:54272
    v_mfma_f32_16x16x32_bf16 v[232:235], v[24:27], a[36:39], v[232:235]
    global_load_lds_dwordx4 v4, s[34:35] offset:1024 sc1
    v_mfma_f32_16x16x32_bf16 v[240:243], v[252:255], a[80:83], v[240:243]
    v_mfma_f32_16x16x32_bf16 v[240:243], v[24:27], a[84:87], v[240:243]
    v_mfma_f32_16x16x32_bf16 v[244:247], v[252:255], a[128:131], v[244:247]
    v_mfma_f32_16x16x32_bf16 v[244:247], v[24:27], a[132:135], v[244:247]
    v_mfma_f32_16x16x32_bf16 v[248:251], v[252:255], a[176:179], v[248:251]
    v_mfma_f32_16x16x32_bf16 v[248:251], v[24:27], a[180:183], v[248:251]
    ds_read_b128 v[188:191], v1 offset:55296
    s_waitcnt lgkmcnt(3)
    v_mfma_f32_16x16x32_bf16 v[20:23], v[68:71], a[32:35], v[20:23]
    ds_read_b128 v[204:207], v1 offset:56320
    v_mfma_f32_16x16x32_bf16 v[20:23], v[116:119], a[36:39], v[20:23]
    global_load_lds_dwordx4 v4, s[34:35] offset:2048 sc1
    v_mfma_f32_16x16x32_bf16 v[28:31], v[68:71], a[80:83], v[28:31]
    v_add_u32 v4, 24576, v4
    v_mfma_f32_16x16x32_bf16 v[28:31], v[116:119], a[84:87], v[28:31]
    v_mfma_f32_16x16x32_bf16 v[32:35], v[68:71], a[128:131], v[32:35]
    v_mfma_f32_16x16x32_bf16 v[32:35], v[116:119], a[132:135], v[32:35]
    v_mfma_f32_16x16x32_bf16 v[40:43], v[68:71], a[176:179], v[40:43]
    v_mfma_f32_16x16x32_bf16 v[40:43], v[116:119], a[180:183], v[40:43]
    ds_read_b128 v[24:27], v1 offset:57344
    s_waitcnt lgkmcnt(3)
    v_mfma_f32_16x16x32_bf16 v[60:63], v[44:47], a[32:35], v[60:63]
    ds_read_b128 v[212:215], v1 offset:58368
    v_mfma_f32_16x16x32_bf16 v[60:63], v[140:143], a[36:39], v[60:63]
    v_mfma_f32_16x16x32_bf16 v[84:87], v[44:47], a[80:83], v[84:87]
    v_mfma_f32_16x16x32_bf16 v[84:87], v[140:143], a[84:87], v[84:87]
    v_mfma_f32_16x16x32_bf16 v[92:95], v[44:47], a[128:131], v[92:95]
    v_mfma_f32_16x16x32_bf16 v[92:95], v[140:143], a[132:135], v[92:95]
    v_mfma_f32_16x16x32_bf16 v[108:111], v[44:47], a[176:179], v[108:111]
    v_mfma_f32_16x16x32_bf16 v[108:111], v[140:143], a[180:183], v[108:111]
    ds_read_b128 v[228:231], v1 offset:59392
    s_waitcnt lgkmcnt(3)
    v_mfma_f32_16x16x32_bf16 v[132:135], v[188:191], a[32:35], v[132:135]
    ds_read_b128 v[236:239], v1 offset:60416
    v_mfma_f32_16x16x32_bf16 v[132:135], v[204:207], a[36:39], v[132:135]
    v_mfma_f32_16x16x32_bf16 v[156:159], v[188:191], a[80:83], v[156:159]
    v_mfma_f32_16x16x32_bf16 v[156:159], v[204:207], a[84:87], v[156:159]
    v_mfma_f32_16x16x32_bf16 v[164:167], v[188:191], a[128:131], v[164:167]
    v_mfma_f32_16x16x32_bf16 v[164:167], v[204:207], a[132:135], v[164:167]
    v_mfma_f32_16x16x32_bf16 v[180:183], v[188:191], a[176:179], v[180:183]
    v_mfma_f32_16x16x32_bf16 v[180:183], v[204:207], a[180:183], v[180:183]
    ds_read_b128 v[252:255], v1 offset:61440
    s_waitcnt lgkmcnt(3)
    v_mfma_f32_16x16x32_bf16 a[192:195], v[24:27], a[32:35], a[192:195]
    ds_read_b128 v[44:47], v1 offset:62464
    v_mfma_f32_16x16x32_bf16 a[192:195], v[212:215], a[36:39], a[192:195]
    v_mfma_f32_16x16x32_bf16 a[196:199], v[24:27], a[80:83], a[196:199]
    v_mfma_f32_16x16x32_bf16 a[196:199], v[212:215], a[84:87], a[196:199]
    v_mfma_f32_16x16x32_bf16 a[200:203], v[24:27], a[128:131], a[200:203]
    v_mfma_f32_16x16x32_bf16 a[200:203], v[212:215], a[132:135], a[200:203]
    v_mfma_f32_16x16x32_bf16 a[204:207], v[24:27], a[176:179], a[204:207]
    v_mfma_f32_16x16x32_bf16 a[204:207], v[212:215], a[180:183], a[204:207]
    ds_read_b128 v[68:71], v1 offset:63488
    s_waitcnt lgkmcnt(3)
    v_mfma_f32_16x16x32_bf16 a[208:211], v[228:231], a[32:35], a[208:211]
    ds_read_b128 v[116:119], v1 offset:64512
    v_add_u32 v140, L_join - L_pc0 + 24576, v0
    v_mfma_f32_16x16x32_bf16 a[208:211], v[236:239], a[36:39], a[208:211]
    v_min_u32 v140, L_end - L_pc0, v140
    v_mfma_f32_16x16x32_bf16 a[212:215], v[228:231], a[80:83], a[212:215]
    global_load_dword v141, v140, s[36:37]
    v_mfma_f32_16x16x32_bf16 a[212:215], v[236:239], a[84:87], a[212:215]
    v_mfma_f32_16x16x32_bf16 a[216:219], v[228:231], a[128:131], a[216:219]
    v_mfma_f32_16x16x32_bf16 a[216:219], v[236:239], a[132:135], a[216:219]
    v_mfma_f32_16x16x32_bf16 a[220:223], v[228:231], a[176:179], a[220:223]
    v_mfma_f32_16x16x32_bf16 a[220:223], v[236:239], a[180:183], a[220:223]
    ds_read_b128 v[24:27], v2
    s_waitcnt lgkmcnt(3)
    v_mfma_f32_16x16x32_bf16 a[224:227], v[252:255], a[32:35], a[224:227]
L_st1:
    s_cbranch_execz L_st4
    ds_read_b128 v[188:191], v2 offset:1024
    v_mfma_f32_16x16x32_bf16 a[224:227], v[44:47], a[36:39], a[224:227]
    v_mfma_f32_16x16x32_bf16 a[228:231], v[252:255], a[80:83], a[228:231]
    v_mfma_f32_16x16x32_bf16 a[228:231], v[44:47], a[84:87], a[228:231]
    v_mfma_f32_16x16x32_bf16 a[232:235], v[252:255], a[128:131], a[232:235]
    v_mfma_f32_16x16x32_bf16 a[232:235], v[44:47], a[132:135], a[232:235]
    v_mfma_f32_16x16x32_bf16 a[236:239], v[252:255], a[176:179], a[236:239]
    v_mfma_f32_16x16x32_bf16 a[236:239], v[44:47], a[180:183], a[236:239]
    ds_read_b128 v[204:207], v2 offset:2048
    s_waitcnt lgkmcnt(3)
    v_mfma_f32_16x16x32_bf16 a[240:243], v[68:71], a[32:35], a[240:243]
    ds_read_b128 v[212:215], v2 offset:3072
    v_mfma_f32_16x16x32_bf16 a[240:243], v[116:119], a[36:39], a[240:243]
    v_mfma_f32_16x16x32_bf16 a[244:247], v[68:71], a[80:83], a[244:247]
    v_mfma_f32_16x16x32_bf16 a[244:247], v[116:119], a[84:87], a[244:247]
    v_mfma_f32_16x16x32_bf16 a[248:251], v[68:71], a[128:131], a[248:251]
    v_mfma_f32_16x16x32_bf16 a[248:251], v[116:119], a[132:135], a[248:251]
    v_mfma_f32_16x16x32_bf16 a[252:255], v[68:71], a[176:179], a[252:255]
    v_mfma_f32_16x16x32_bf16 a[252:255], v[116:119], a[180:183], a[252:255]
    ds_read_b128 v[44:47], v2 offset:4096
    s_waitcnt lgkmcnt(3)
    v_mfma_f32_16x16x32_bf16 v[36:39], v[24:27], a[40:43], v[36:39]
    ds_read_b128 v[228:231], v2 offset:5120
    s_waitcnt vmcnt(19)
    v_mfma_f32_16x16x32_bf16 v[36:39], v[188:191], a[44:47], v[36:39]
    s_waitcnt vmcnt(9)
    s_barrier
    v_mfma_f32_16x16x32_bf16 v[48:51], v[24:27], a[88:91], v[48:51]
    s_add_u32 m0, s17, 24576
    v_mfma_f32_16x16x32_bf16 v[48:51], v[188:191], a[92:95], v[48:51]
    global_load_lds_dwordx4 v4, s[34:35] offset:-3072 sc1
    v_mfma_f32_16x16x32_bf16 v[52:55], v[24:27], a[136:139], v[52:55]
    v_mfma_f32_16x16x32_bf16 v[52:55], v[188:191], a[140:143], v[52:55]
    s_waitcnt vmcnt(9)
    v_mfma_f32_16x16x32_bf16 v[56:59], v[24:27], a[184:187], v[56:59]
    s_waitcnt vmcnt(8)
    v_mfma_f32_16x16x32_bf16 v[56:59], v[188:191], a[188:191], v[56:59]
    ds_read_b128 v[236:239], v2 offset:6144
    s_waitcnt lgkmcnt(3)
    v_mfma_f32_16x16x32_bf16 v[64:67], v[204:207], a[40:43], v[64:67]
    ds_read_b128 v[252:255], v2 offset:7168
    v_cvt_pk_bf16_f32 v36, v36, v37
    v_mfma_f32_16x16x32_bf16 v[64:67], v[212:215], a[44:47], v[64:67]
    global_load_lds_dwordx4 v4, s[34:35] offset:-2048 sc1
    v_mfma_f32_16x16x32_bf16 v[72:75], v[204:207], a[88:91], v[72:75]
    v_cvt_pk_bf16_f32 v37, v38, v39
    v_cvt_pk_bf16_f32 v48, v48, v49
    v_mfma_f32_16x16x32_bf16 v[72:75], v[212:215], a[92:95], v[72:75]
    v_cvt_pk_bf16_f32 v49, v50, v51
    v_mfma_f32_16x16x32_bf16 v[76:79], v[204:207], a[136:139], v[76:79]
    ds_write_b128 v12, a[184:187] offset:10240
    v_mfma_f32_16x16x32_bf16 v[76:79], v[212:215], a[140:143], v[76:79]
    v_cvt_pk_bf16_f32 v52, v52, v53
    v_cvt_pk_bf16_f32 v53, v54, v55
    v_mfma_f32_16x16x32_bf16 v[80:83], v[204:207], a[184:187], v[80:83]
    v_cvt_pk_bf16_f32 v56, v56, v57
    v_cvt_pk_bf16_f32 v57, v58, v59
    v_mfma_f32_16x16x32_bf16 v[80:83], v[212:215], a[188:191], v[80:83]
    ds_read_b128 v[24:27], v2 offset:8192
    s_waitcnt lgkmcnt(4)
    v_mfma_f32_16x16x32_bf16 v[88:91], v[44:47], a[40:43], v[88:91]
    ds_read_b128 v[68:71], v2 offset:9216
    v_cvt_pk_bf16_f32 v38, v64, v65
    v_mfma_f32_16x16x32_bf16 v[88:91], v[228:231], a[44:47], v[88:91]
    v_cvt_pk_bf16_f32 v39, v66, v67
    v_mfma_f32_16x16x32_bf16 v[96:99], v[44:47], a[88:91], v[96:99]
    v_cvt_pk_bf16_f32 v50, v72, v73
    v_cvt_pk_bf16_f32 v51, v74, v75
    v_mfma_f32_16x16x32_bf16 v[96:99], v[228:231], a[92:95], v[96:99]
    global_load_lds_dwordx4 v4, s[34:35] offset:-1024 sc1
    v_mfma_f32_16x16x32_bf16 v[100:103], v[44:47], a[136:139], v[100:103]
    v_cvt_pk_bf16_f32 v54, v76, v77
    v_cvt_pk_bf16_f32 v55, v78, v79
    v_mfma_f32_16x16x32_bf16 v[100:103], v[228:231], a[140:143], v[100:103]
    ds_write_b128 v12, a[188:191] offset:11264
    v_mfma_f32_16x16x32_bf16 v[104:107], v[44:47], a[184:187], v[104:107]
    v_cvt_pk_bf16_f32 v58, v80, v81
    v_cvt_pk_bf16_f32 v59, v82, v83
    v_mfma_f32_16x16x32_bf16 v[104:107], v[228:231], a[188:191], v[104:107]
    ds_read_b128 v[64:67], v2 offset:10240
    s_waitcnt lgkmcnt(5)
    v_mfma_f32_16x16x32_bf16 v[112:115], v[236:239], a[40:43], v[112:115]
    ds_read_b128 v[72:75], v2 offset:11264
    v_cvt_pk_bf16_f32 v88, v88, v89
    v_mfma_f32_16x16x32_bf16 v[112:115], v[252:255], a[44:47], v[112:115]
    ds_write_b128 v14, v[56:59]
    v_mfma_f32_16x16x32_bf16 v[120:123], v[236:239], a[88:91], v[120:123]
    global_load_lds_dwordx4 v4, s[34:35] sc1
    v_mfma_f32_16x16x32_bf16 v[120:123], v[252:255], a[92:95], v[120:123]
    v_cvt_pk_bf16_f32 v89, v90, v91
    v_cvt_pk_bf16_f32 v96, v96, v97
    v_mfma_f32_16x16x32_bf16 v[124:127], v[236:239], a[136:139], v[124:127]
    v_cvt_pk_bf16_f32 v97, v98, v99
    v_cvt_pk_bf16_f32 v100, v100, v101
    v_mfma_f32_16x16x32_bf16 v[124:127], v[252:255], a[140:143], v[124:127]
    v_cvt_pk_bf16_f32 v101, v102, v103
    v_mfma_f32_16x16x32_bf16 v[128:131], v[236:239], a[184:187], v[128:131]
    v_cvt_pk_bf16_f32 v104, v104, v105
    v_cvt_pk_bf16_f32 v105, v106, v107
    v_mfma_f32_16x16x32_bf16 v[128:131], v[252:255], a[188:191], v[128:131]
    ds_read_b128 v[44:47], v2 offset:12288
    s_waitcnt lgkmcnt(5)
    v_mfma_f32_16x16x32_bf16 v[136:139], v[24:27], a[40:43], v[136:139]
    ds_read_b128 v[76:79], v2 offset:13312
    v_cvt_pk_bf16_f32 v90, v112, v113
    v_mfma_f32_16x16x32_bf16 v[136:139], v[68:71], a[44:47], v[136:139]
    v_cvt_pk_bf16_f32 v91, v114, v115
    v_mfma_f32_16x16x32_bf16 v[144:147], v[24:27], a[88:91], v[144:147]
    v_cvt_pk_bf16_f32 v98, v120, v121
    v_cvt_pk_bf16_f32 v99, v122, v123
    v_mfma_f32_16x16x32_bf16 v[144:147], v[68:71], a[92:95], v[144:147]
    global_load_lds_dwordx4 v4, s[34:35] offset:1024 sc1
    v_mfma_f32_16x16x32_bf16 v[148:151], v[24:27], a[136:139], v[148:151]
    v_cvt_pk_bf16_f32 v102, v124, v125
    v_cvt_pk_bf16_f32 v103, v126, v127
    v_mfma_f32_16x16x32_bf16 v[148:151], v[68:71], a[140:143], v[148:151]
    v_mfma_f32_16x16x32_bf16 v[152:155], v[24:27], a[184:187], v[152:155]
    v_cvt_pk_bf16_f32 v106, v128, v129
    v_cvt_pk_bf16_f32 v107, v130, v131
    v_mfma_f32_16x16x32_bf16 v[152:155], v[68:71], a[188:191], v[152:155]
    ds_read_b128 v[80:83], v2 offset:14336
    s_waitcnt lgkmcnt(4)
    v_mfma_f32_16x16x32_bf16 v[160:163], v[64:67], a[40:43], v[160:163]
    ds_read_b128 v[116:119], v2 offset:15360
    v_cvt_pk_bf16_f32 v136, v136, v137
    v_mfma_f32_16x16x32_bf16 v[160:163], v[72:75], a[44:47], v[160:163]
    v_mov_b32 v140, 0
    v_cvt_pk_bf16_f32 v137, v138, v139
    v_mfma_f32_16x16x32_bf16 v[168:171], v[64:67], a[88:91], v[168:171]
    global_load_dword v142, v140, s[32:33] offset:192 sc1
    v_mfma_f32_16x16x32_bf16 v[168:171], v[72:75], a[92:95], v[168:171]
    ds_write_b128 v14, v[104:107] offset:1024
    v_mfma_f32_16x16x32_bf16 v[172:175], v[64:67], a[136:139], v[172:175]
    global_load_lds_dwordx4 v4, s[34:35] offset:2048 sc1
    v_mfma_f32_16x16x32_bf16 v[172:175], v[72:75], a[140:143], v[172:175]
    v_add_u32 v4, 24576, v4
    v_cvt_pk_bf16_f32 v144, v144, v145
    v_mfma_f32_16x16x32_bf16 v[176:179], v[64:67], a[184:187], v[176:179]
    v_cvt_pk_bf16_f32 v152, v152, v153
    v_cvt_pk_bf16_f32 v153, v154, v155
    v_mfma_f32_16x16x32_bf16 v[176:179], v[72:75], a[188:191], v[176:179]
    ds_read_b128 v[188:191], v2 offset:16384
    s_waitcnt lgkmcnt(4)
    v_mfma_f32_16x16x32_bf16 v[184:187], v[44:47], a[40:43], v[184:187]
    ds_read_b128 v[204:207], v2 offset:17408
    v_cvt_pk_bf16_f32 v138, v160, v161
    v_mfma_f32_16x16x32_bf16 v[184:187], v[76:79], a[44:47], v[184:187]
    v_cvt_pk_bf16_f32 v139, v162, v163
    v_cvt_pk_bf16_f32 v145, v146, v147
    v_mfma_f32_16x16x32_bf16 v[192:195], v[44:47], a[88:91], v[192:195]
    v_cvt_pk_bf16_f32 v146, v168, v169
    v_cvt_pk_bf16_f32 v147, v170, v171
    v_mfma_f32_16x16x32_bf16 v[192:195], v[76:79], a[92:95], v[192:195]
    v_cvt_pk_bf16_f32 v148, v148, v149
    v_cvt_pk_bf16_f32 v149, v150, v151
    v_mfma_f32_16x16x32_bf16 v[196:199], v[44:47], a[136:139], v[196:199]
    v_cvt_pk_bf16_f32 v150, v172, v173
    v_cvt_pk_bf16_f32 v151, v174, v175
    v_mfma_f32_16x16x32_bf16 v[196:199], v[76:79], a[140:143], v[196:199]
    v_mfma_f32_16x16x32_bf16 v[200:203], v[44:47], a[184:187], v[200:203]
    v_cvt_pk_bf16_f32 v154, v176, v177
    v_cvt_pk_bf16_f32 v155, v178, v179
    v_mfma_f32_16x16x32_bf16 v[200:203], v[76:79], a[188:191], v[200:203]
    ds_read_b128 v[212:215], v2 offset:18432
    s_waitcnt lgkmcnt(4)
    v_mfma_f32_16x16x32_bf16 v[208:211], v[80:83], a[40:43], v[208:211]
    ds_read_b128 v[228:231], v2 offset:19456
    v_cvt_pk_bf16_f32 v184, v184, v185
    v_mfma_f32_16x16x32_bf16 v[208:211], v[116:119], a[44:47], v[208:211]
    ds_write_b128 v14, v[152:155] offset:2048
    v_mfma_f32_16x16x32_bf16 v[216:219], v[80:83], a[88:91], v[216:219]
    v_cvt_pk_bf16_f32 v185, v186, v187
    v_cvt_pk_bf16_f32 v192, v192, v193
    v_mfma_f32_16x16x32_bf16 v[216:219], v[116:119], a[92:95], v[216:219]
    v_cvt_pk_bf16_f32 v193, v194, v195
    v_mfma_f32_16x16x32_bf16 v[220:223], v[80:83], a[136:139], v[220:223]
    v_cvt_pk_bf16_f32 v196, v196, v197
    v_cvt_pk_bf16_f32 v197, v198, v199
    v_mfma_f32_16x16x32_bf16 v[220:223], v[116:119], a[140:143], v[220:223]
    v_mfma_f32_16x16x32_bf16 v[224:227], v[80:83], a[184:187], v[224:227]
    v_cvt_pk_bf16_f32 v200, v200, v201
    v_cvt_pk_bf16_f32 v201, v202, v203
    v_mfma_f32_16x16x32_bf16 v[224:227], v[116:119], a[188:191], v[224:227]
    ds_read_b128 v[24:27], v2 offset:20480
    s_waitcnt lgkmcnt(4)
    v_mfma_f32_16x16x32_bf16 v[232:235], v[188:191], a[40:43], v[232:235]
    ds_read_b128 v[64:67], v2 offset:21504
    v_cvt_pk_bf16_f32 v186, v208, v209
    v_mfma_f32_16x16x32_bf16 v[232:235], v[204:207], a[44:47], v[232:235]
    v_cvt_pk_bf16_f32 v187, v210, v211
    v_mfma_f32_16x16x32_bf16 v[240:243], v[188:191], a[88:91], v[240:243]
    v_cvt_pk_bf16_f32 v194, v216, v217
    v_cvt_pk_bf16_f32 v195, v218, v219
    v_mfma_f32_16x16x32_bf16 v[240:243], v[204:207], a[92:95], v[240:243]
    v_mfma_f32_16x16x32_bf16 v[244:247], v[188:191], a[136:139], v[244:247]
    v_cvt_pk_bf16_f32 v198, v220, v221
    v_cvt_pk_bf16_f32 v199, v222, v223
    v_mfma_f32_16x16x32_bf16 v[244:247], v[204:207], a[140:143], v[244:247]
    v_mfma_f32_16x16x32_bf16 v[248:251], v[188:191], a[184:187], v[248:251]
    v_cvt_pk_bf16_f32 v202, v224, v225
    v_cvt_pk_bf16_f32 v203, v226, v227
    v_mfma_f32_16x16x32_bf16 v[248:251], v[204:207], a[188:191], v[248:251]
    ds_read_b128 v[68:71], v2 offset:22528
    s_waitcnt lgkmcnt(4)
    v_mfma_f32_16x16x32_bf16 v[20:23], v[212:215], a[40:43], v[20:23]
    ds_read_b128 v[72:75], v2 offset:23552
    v_cvt_pk_bf16_f32 v232, v232, v233
    v_mfma_f32_16x16x32_bf16 v[20:23], v[228:231], a[44:47], v[20:23]
    ds_write_b128 v14, v[200:203] offset:3072
    v_mfma_f32_16x16x32_bf16 v[28:31], v[212:215], a[88:91], v[28:31]
    v_cvt_pk_bf16_f32 v233, v234, v235
    v_cvt_pk_bf16_f32 v240, v240, v241
    v_mfma_f32_16x16x32_bf16 v[28:31], v[228:231], a[92:95], v[28:31]
    v_cvt_pk_bf16_f32 v241, v242, v243
    v_mfma_f32_16x16x32_bf16 v[32:35], v[212:215], a[136:139], v[32:35]
    v_cvt_pk_bf16_f32 v244, v244, v245
    v_cvt_pk_bf16_f32 v245, v246, v247
    v_mfma_f32_16x16x32_bf16 v[32:35], v[228:231], a[140:143], v[32:35]
    v_mfma_f32_16x16x32_bf16 v[40:43], v[212:215], a[184:187], v[40:43]
    v_cvt_pk_bf16_f32 v248, v248, v249
    v_cvt_pk_bf16_f32 v249, v250, v251
    v_mfma_f32_16x16x32_bf16 v[40:43], v[228:231], a[188:191], v[40:43]
    ds_read_b128 v[112:115], v2 offset:24576
    s_waitcnt lgkmcnt(4)
    v_mfma_f32_16x16x32_bf16 v[60:63], v[24:27], a[40:43], v[60:63]
    ds_read_b128 v[120:123], v2 offset:25600
    v_cvt_pk_bf16_f32 v234, v20, v21
    v_mfma_f32_16x16x32_bf16 v[60:63], v[64:67], a[44:47], v[60:63]
    v_cvt_pk_bf16_f32 v235, v22, v23
    v_mfma_f32_16x16x32_bf16 v[84:87], v[24:27], a[88:91], v[84:87]
    v_cvt_pk_bf16_f32 v242, v28, v29
    v_cvt_pk_bf16_f32 v243, v30, v31
    v_mfma_f32_16x16x32_bf16 v[84:87], v[64:67], a[92:95], v[84:87]
    v_mfma_f32_16x16x32_bf16 v[92:95], v[24:27], a[136:139], v[92:95]
    v_cvt_pk_bf16_f32 v246, v32, v33
    v_cvt_pk_bf16_f32 v247, v34, v35
    v_mfma_f32_16x16x32_bf16 v[92:95], v[64:67], a[140:143], v[92:95]
    v_mfma_f32_16x16x32_bf16 v[108:111], v[24:27], a[184:187], v[108:111]
    v_cvt_pk_bf16_f32 v250, v40, v41
    v_cvt_pk_bf16_f32 v251, v42, v43
    v_mfma_f32_16x16x32_bf16 v[108:111], v[64:67], a[188:191], v[108:111]
    ds_read_b128 v[124:127], v2 offset:26624
    s_waitcnt lgkmcnt(4)
    v_mfma_f32_16x16x32_bf16 v[132:135], v[68:71], a[40:43], v[132:135]
    ds_read_b128 v[128:131], v2 offset:27648
    v_cvt_pk_bf16_f32 v60, v60, v61
    v_mfma_f32_16x16x32_bf16 v[132:135], v[72:75], a[44:47], v[132:135]
    ds_write_b128 v14, v[248:251] offset:4096
    v_mfma_f32_16x16x32_bf16 v[156:159], v[68:71], a[88:91], v[156:159]
    v_cvt_pk_bf16_f32 v61, v62, v63
    v_cvt_pk_bf16_f32 v84, v84, v85
    v_mfma_f32_16x16x32_bf16 v[156:159], v[72:75], a[92:95], v[156:159]
    v_cvt_pk_bf16_f32 v85, v86, v87
    v_mfma_f32_16x16x32_bf16 v[164:167], v[68:71], a[136:139], v[164:167]
    v_cvt_pk_bf16_f32 v92, v92, v93
    v_cvt_pk_bf16_f32 v93, v94, v95
    v_mfma_f32_16x16x32_bf16 v[164:167], v[72:75], a[140:143], v[164:167]
    v_mfma_f32_16x16x32_bf16 v[180:183], v[68:71], a[184:187], v[180:183]
    v_cvt_pk_bf16_f32 v108, v108, v109
    v_cvt_pk_bf16_f32 v109, v110, v111
    v_mfma_f32_16x16x32_bf16 v[180:183], v[72:75], a[188:191], v[180:183]
    ds_read_b128 v[160:163], v2 offset:28672
    s_waitcnt lgkmcnt(4)
    v_mfma_f32_16x16x32_bf16 a[192:195], v[112:115], a[40:43], a[192:195]
    ds_read_b128 v[168:171], v2 offset:29696
    v_cvt_pk_bf16_f32 v62, v132, v133
    v_mfma_f32_16x16x32_bf16 a[192:195], v[120:123], a[44:47], a[192:195]
    s_waitcnt vmcnt(8)
    s_barrier
    v_mfma_f32_16x16x32_bf16 a[196:199], v[112:115], a[88:91], a[196:199]
    s_add_u32 m0, s17, 49152
    v_cvt_pk_bf16_f32 v63, v134, v135
    v_mfma_f32_16x16x32_bf16 a[196:199], v[120:123], a[92:95], a[196:199]
    v_cvt_pk_bf16_f32 v86, v156, v157
    v_cvt_pk_bf16_f32 v87, v158, v159
    v_mfma_f32_16x16x32_bf16 a[200:203], v[112:115], a[136:139], a[200:203]
    global_load_lds_dwordx4 v4, s[34:35] offset:-3072 sc1
    v_mfma_f32_16x16x32_bf16 a[200:203], v[120:123], a[140:143], a[200:203]
    v_cvt_pk_bf16_f32 v94, v164, v165
    v_cvt_pk_bf16_f32 v95, v166, v167
    v_mfma_f32_16x16x32_bf16 a[204:207], v[112:115], a[184:187], a[204:207]
    v_cvt_pk_bf16_f32 v110, v180, v181
    v_cvt_pk_bf16_f32 v111, v182, v183
    v_mfma_f32_16x16x32_bf16 a[204:207], v[120:123], a[188:191], a[204:207]
    ds_read_b128 v[236:239], v2 offset:30720
    s_waitcnt lgkmcnt(4)
    v_mfma_f32_16x16x32_bf16 a[208:211], v[124:127], a[40:43], a[208:211]
    ds_read_b128 v[252:255], v2 offset:31744
    v_accvgpr_read_b32 v44, a192
    v_mfma_f32_16x16x32_bf16 a[208:211], v[128:131], a[44:47], a[208:211]
    ds_write_b128 v14, v[108:111] offset:5120
    v_mfma_f32_16x16x32_bf16 a[212:215], v[124:127], a[88:91], a[212:215]
    global_load_lds_dwordx4 v4, s[34:35] offset:-2048 sc1
    v_mfma_f32_16x16x32_bf16 a[212:215], v[128:131], a[92:95], a[212:215]
    ds_read_b128 v[76:79], v2 offset:32768
    v_accvgpr_read_b32 v45, a193
    v_mfma_f32_16x16x32_bf16 a[216:219], v[124:127], a[136:139], a[216:219]
    ds_read_b128 v[80:83], v2 offset:33792
    v_accvgpr_read_b32 v46, a194
    v_mfma_f32_16x16x32_bf16 a[216:219], v[128:131], a[140:143], a[216:219]
    global_load_lds_dwordx4 v4, s[34:35] offset:-1024 sc1
    v_mfma_f32_16x16x32_bf16 a[220:223], v[124:127], a[184:187], a[220:223]
    v_accvgpr_read_b32 v116, a204
    v_accvgpr_read_b32 v117, a205
    v_mfma_f32_16x16x32_bf16 a[220:223], v[128:131], a[188:191], a[220:223]
    v_accvgpr_read_b32 v118, a206
    s_waitcnt lgkmcnt(5)
    v_mfma_f32_16x16x32_bf16 a[224:227], v[160:163], a[40:43], a[224:227]
    v_accvgpr_read_b32 v119, a207
    v_cvt_pk_bf16_f32 v172, v116, v117
    v_mfma_f32_16x16x32_bf16 a[224:227], v[168:171], a[44:47], a[224:227]
    v_cvt_pk_bf16_f32 v173, v118, v119
    v_accvgpr_read_b32 v47, a195
    v_mfma_f32_16x16x32_bf16 a[228:231], v[160:163], a[88:91], a[228:231]
    v_accvgpr_read_b32 v176, a208
    v_accvgpr_read_b32 v177, a209
    v_mfma_f32_16x16x32_bf16 a[228:231], v[168:171], a[92:95], a[228:231]
    ds_read_b128 a[204:207], v2 offset:45056
    v_accvgpr_read_b32 v178, a210
    v_mfma_f32_16x16x32_bf16 a[232:235], v[160:163], a[136:139], a[232:235]
    ds_read_b128 a[192:195], v2 offset:46080
    v_accvgpr_read_b32 v179, a211
    v_mfma_f32_16x16x32_bf16 a[232:235], v[168:171], a[140:143], a[232:235]
    global_load_lds_dwordx4 v4, s[34:35] sc1
    v_mfma_f32_16x16x32_bf16 a[236:239], v[160:163], a[184:187], a[236:239]
    v_accvgpr_read_b32 v188, a220
    v_accvgpr_read_b32 v189, a221
    v_mfma_f32_16x16x32_bf16 a[236:239], v[168:171], a[188:191], a[236:239]
    v_accvgpr_read_b32 v190, a222
    s_waitcnt lgkmcnt(5)
    v_mfma_f32_16x16x32_bf16 a[240:243], v[236:239], a[40:43], a[240:243]
    v_accvgpr_read_b32 v191, a223
    v_cvt_pk_bf16_f32 v174, v188, v189
    v_mfma_f32_16x16x32_bf16 a[240:243], v[252:255], a[44:47], a[240:243]
    global_load_lds_dwordx4 v4, s[34:35] offset:1024 sc1
    v_mfma_f32_16x16x32_bf16 a[244:247], v[236:239], a[88:91], a[244:247]
    v_cvt_pk_bf16_f32 v175, v190, v191
    v_cvt_pk_bf16_f32 v204, v44, v45
    v_mfma_f32_16x16x32_bf16 a[244:247], v[252:255], a[92:95], a[244:247]
    ds_read_b128 a[208:211], v2 offset:57344
    v_cvt_pk_bf16_f32 v205, v46, v47
    v_mfma_f32_16x16x32_bf16 a[248:251], v[236:239], a[136:139], a[248:251]
    ds_read_b128 a[220:223], v2 offset:58368
    v_cvt_pk_bf16_f32 v206, v176, v177
    v_mfma_f32_16x16x32_bf16 a[248:251], v[252:255], a[140:143], a[248:251]
    ds_write_b128 v14, v[172:175] offset:6144
    v_mfma_f32_16x16x32_bf16 a[252:255], v[236:239], a[184:187], a[252:255]
    v_cvt_pk_bf16_f32 v207, v178, v179
    v_accvgpr_read_b32 v208, a196
    v_mfma_f32_16x16x32_bf16 a[252:255], v[252:255], a[188:191], a[252:255]
    v_accvgpr_read_b32 v209, a197
    s_waitcnt lgkmcnt(5)
    v_mfma_f32_16x16x32_bf16 v[212:215], v[76:79], v[36:39], 0
    global_load_lds_dwordx4 v4, s[34:35] offset:2048 sc1
    v_mfma_f32_16x16x32_bf16 v[212:215], v[80:83], v[88:91], v[212:215]
    v_add_u32 v4, 24576, v4
    v_accvgpr_read_b32 v210, a198
    v_mfma_f32_16x16x32_bf16 v[216:219], v[76:79], v[48:51], 0
    v_accvgpr_read_b32 v211, a199
    v_accvgpr_read_b32 v220, a212
    v_mfma_f32_16x16x32_bf16 v[216:219], v[80:83], v[96:99], v[216:219]
    ds_read_b128 v[224:227], v3 offset:4096
    v_accvgpr_read_b32 v221, a213
    v_mfma_f32_16x16x32_bf16 v[20:23], v[76:79], v[52:55], 0
    ds_read_b128 v[24:27], v3 offset:5120
    v_accvgpr_read_b32 v222, a214
    v_mfma_f32_16x16x32_bf16 v[20:23], v[80:83], v[100:103], v[20:23]
    v_accvgpr_read_b32 v223, a215
    v_cvt_pk_bf16_f32 v28, v208, v209
    v_mfma_f32_16x16x32_bf16 v[32:35], v[76:79], v[56:59], 0
    v_cvt_pk_bf16_f32 v29, v210, v211
    v_cvt_pk_bf16_f32 v30, v220, v221
    v_mfma_f32_16x16x32_bf16 v[32:35], v[80:83], v[104:107], v[32:35]
    ds_read_b128 v[40:43], v1
    s_waitcnt lgkmcnt(6)
    v_mfma_f32_16x16x32_bf16 v[64:67], a[204:207], v[56:59], 0
    ds_read_b128 v[68:71], v1 offset:1024
    v_cvt_pk_bf16_f32 v31, v222, v223
    v_mfma_f32_16x16x32_bf16 v[64:67], a[192:195], v[104:107], v[64:67]
    v_accvgpr_read_b32 v72, a236
    v_accvgpr_read_b32 v73, a237
    v_mfma_f32_16x16x32_bf16 v[112:115], a[0:3], v[36:39], 0
    v_accvgpr_read_b32 v74, a238
    v_accvgpr_read_b32 v75, a239
    v_mfma_f32_16x16x32_bf16 v[112:115], a[4:7], v[88:91], v[112:115]
    v_accvgpr_read_b32 v120, a252
    v_accvgpr_read_b32 v121, a253
    v_mfma_f32_16x16x32_bf16 v[132:135], a[0:3], v[48:51], 0
    v_accvgpr_read_b32 v122, a254
    v_accvgpr_read_b32 v123, a255
    v_mfma_f32_16x16x32_bf16 v[132:135], a[4:7], v[96:99], v[132:135]
    v_cvt_pk_bf16_f32 v156, v72, v73
    v_cvt_pk_bf16_f32 v157, v74, v75
    v_mfma_f32_16x16x32_bf16 v[164:167], a[0:3], v[52:55], 0
    v_cvt_pk_bf16_f32 v158, v120, v121
    v_cvt_pk_bf16_f32 v159, v122, v123
    v_mfma_f32_16x16x32_bf16 v[164:167], a[4:7], v[100:103], v[164:167]
    ds_read_b128 v[180:183], v1 offset:2048
    s_waitcnt lgkmcnt(6)
    v_mfma_f32_16x16x32_bf16 v[228:231], a[208:211], v[56:59], 0
    ds_read_b128 v[44:47], v1 offset:3072
    v_accvgpr_read_b32 v116, a200
    v_mfma_f32_16x16x32_bf16 v[228:231], a[220:223], v[104:107], v[228:231]
    v_accvgpr_read_b32 v117, a201
    v_accvgpr_read_b32 v118, a202
    v_mfma_f32_16x16x32_bf16 v[124:127], a[48:51], v[36:39], 0
    v_accvgpr_read_b32 v119, a203
    v_accvgpr_read_b32 v128, a216
    v_mfma_f32_16x16x32_bf16 v[124:127], a[52:55], v[88:91], v[124:127]
    v_accvgpr_read_b32 v129, a217
    v_accvgpr_read_b32 v130, a218
    v_mfma_f32_16x16x32_bf16 v[160:163], a[48:51], v[48:51], 0
    v_accvgpr_read_b32 v131, a219
    v_cvt_pk_bf16_f32 v168, v116, v117
    v_mfma_f32_16x16x32_bf16 v[160:163], a[52:55], v[96:99], v[160:163]
    v_cvt_pk_bf16_f32 v169, v118, v119
    v_cvt_pk_bf16_f32 v170, v128, v129
    v_mfma_f32_16x16x32_bf16 v[176:179], a[48:51], v[52:55], 0
    v_cvt_pk_bf16_f32 v171, v130, v131
    v_accvgpr_read_b32 v188, a224
    v_mfma_f32_16x16x32_bf16 v[176:179], a[52:55], v[100:103], v[176:179]
    v_accvgpr_read_b32 v189, a225
    s_waitcnt lgkmcnt(4)
    v_mfma_f32_16x16x32_bf16 v[236:239], v[224:227], v[56:59], 0
    ds_write_b128 v14, v[156:159] offset:7168
    v_mfma_f32_16x16x32_bf16 v[236:239], v[24:27], v[104:107], v[236:239]
    v_accvgpr_read_b32 v190, a226
    v_accvgpr_read_b32 v191, a227
    v_mfma_f32_16x16x32_bf16 v[252:255], a[96:99], v[36:39], 0
    v_accvgpr_read_b32 v72, a240
    v_accvgpr_read_b32 v73, a241
    v_mfma_f32_16x16x32_bf16 v[252:255], a[100:103], v[88:91], v[252:255]
    ds_read_b128 a[192:195], v2 offset:34816
    v_accvgpr_read_b32 v74, a242
    v_mfma_f32_16x16x32_bf16 v[76:79], a[96:99], v[48:51], 0
    ds_read_b128 a[196:199], v2 offset:35840
    v_accvgpr_read_b32 v75, a243
    v_mfma_f32_16x16x32_bf16 v[76:79], a[100:103], v[96:99], v[76:79]
    v_cvt_pk_bf16_f32 v80, v188, v189
    v_cvt_pk_bf16_f32 v81, v190, v191
    v_mfma_f32_16x16x32_bf16 v[116:119], a[96:99], v[52:55], 0
    v_cvt_pk_bf16_f32 v82, v72, v73
    v_cvt_pk_bf16_f32 v83, v74, v75
    v_mfma_f32_16x16x32_bf16 v[116:119], a[100:103], v[100:103], v[116:119]
    v_accvgpr_read_b32 v120, a228
    s_waitcnt lgkmcnt(5)
    v_mfma_f32_16x16x32_bf16 v[128:131], v[40:43], a[0:3], 0
    v_accvgpr_read_b32 v121, a229
    v_accvgpr_read_b32 v122, a230
    v_mfma_f32_16x16x32_bf16 v[128:131], v[68:71], a[4:7], v[128:131]
    v_accvgpr_read_b32 v123, a231
    v_accvgpr_read_b32 v208, a244
    v_mfma_f32_16x16x32_bf16 v[220:223], v[40:43], a[48:51], 0
    v_accvgpr_read_b32 v209, a245
    v_accvgpr_read_b32 v210, a246
    v_mfma_f32_16x16x32_bf16 v[220:223], v[68:71], a[52:55], v[220:223]
    ds_read_b128 a[200:203], v2 offset:47104
    v_accvgpr_read_b32 v211, a247
    v_mfma_f32_16x16x32_bf16 v[24:27], v[40:43], a[96:99], 0
    ds_read_b128 a[204:207], v2 offset:48128
    v_cvt_pk_bf16_f32 v36, v120, v121
    v_mfma_f32_16x16x32_bf16 v[24:27], v[68:71], a[100:103], v[24:27]
    v_cvt_pk_bf16_f32 v37, v122, v123
    v_cvt_pk_bf16_f32 v38, v208, v209
    v_mfma_f32_16x16x32_bf16 v[48:51], v[40:43], a[144:147], 0
    v_cvt_pk_bf16_f32 v39, v210, v211
    v_accvgpr_read_b32 v52, a232
    v_mfma_f32_16x16x32_bf16 v[48:51], v[68:71], a[148:151], v[48:51]
    v_accvgpr_read_b32 v53, a233
    s_waitcnt lgkmcnt(5)
    v_mfma_f32_16x16x32_bf16 v[56:59], v[180:183], a[0:3], 0
    v_accvgpr_read_b32 v54, a234
    v_accvgpr_read_b32 v55, a235
    v_mfma_f32_16x16x32_bf16 v[56:59], v[44:47], a[4:7], v[56:59]
    v_accvgpr_read_b32 v40, a248
    v_accvgpr_read_b32 v41, a249
    v_mfma_f32_16x16x32_bf16 v[68:71], v[180:183], a[48:51], 0
    v_accvgpr_read_b32 v42, a250
    v_accvgpr_read_b32 v43, a251
    v_mfma_f32_16x16x32_bf16 v[68:71], v[44:47], a[52:55], v[68:71]
    ds_read_b128 a[208:211], v2 offset:59392
    v_cvt_pk_bf16_f32 v72, v52, v53
    v_mfma_f32_16x16x32_bf16 v[88:91], v[180:183], a[96:99], 0
    ds_read_b128 a[212:215], v2 offset:60416
    v_cvt_pk_bf16_f32 v73, v54, v55
    v_mfma_f32_16x16x32_bf16 v[88:91], v[44:47], a[100:103], v[88:91]
    v_cvt_pk_bf16_f32 v74, v40, v41
    v_cvt_pk_bf16_f32 v75, v42, v43
    v_mfma_f32_16x16x32_bf16 v[96:99], v[180:183], a[144:147], 0
    v_mfma_f32_16x16x32_bf16 v[96:99], v[44:47], a[148:151], v[96:99]
    s_waitcnt lgkmcnt(4)
    v_mfma_f32_16x16x32_bf16 v[212:215], a[192:195], v[136:139], v[212:215]
    v_mfma_f32_16x16x32_bf16 v[212:215], a[196:199], v[184:187], v[212:215]
    v_mfma_f32_16x16x32_bf16 v[216:219], a[192:195], v[144:147], v[216:219]
    v_mfma_f32_16x16x32_bf16 v[216:219], a[196:199], v[192:195], v[216:219]
    ds_read_b128 a[216:219], v3 offset:6144
    v_mfma_f32_16x16x32_bf16 v[20:23], a[192:195], v[148:151], v[20:23]
    ds_read_b128 a[220:223], v3 offset:7168
    v_mfma_f32_16x16x32_bf16 v[20:23], a[196:199], v[196:199], v[20:23]
    v_mfma_f32_16x16x32_bf16 v[32:35], a[192:195], v[152:155], v[32:35]
    v_mfma_f32_16x16x32_bf16 v[32:35], a[196:199], v[200:203], v[32:35]
    ds_read_b128 a[236:239], v1 offset:4096
    s_waitcnt lgkmcnt(5)
    v_mfma_f32_16x16x32_bf16 v[64:67], a[200:203], v[152:155], v[64:67]
    ds_read_b128 a[252:255], v1 offset:5120
    v_mfma_f32_16x16x32_bf16 v[64:67], a[204:207], v[200:203], v[64:67]
    v_mfma_f32_16x16x32_bf16 v[112:115], a[8:11], v[136:139], v[112:115]
    v_mfma_f32_16x16x32_bf16 v[112:115], a[12:15], v[184:187], v[112:115]
    v_mfma_f32_16x16x32_bf16 v[132:135], a[8:11], v[144:147], v[132:135]
    v_mfma_f32_16x16x32_bf16 v[132:135], a[12:15], v[192:195], v[132:135]
    v_mfma_f32_16x16x32_bf16 v[164:167], a[8:11], v[148:151], v[164:167]
    v_mfma_f32_16x16x32_bf16 v[164:167], a[12:15], v[196:199], v[164:167]
    ds_read_b128 a[224:227], v1 offset:6144
    s_waitcnt lgkmcnt(5)
    v_mfma_f32_16x16x32_bf16 v[228:231], a[208:211], v[152:155], v[228:231]
    ds_read_b128 a[228:231], v1 offset:7168
    v_mfma_f32_16x16x32_bf16 v[228:231], a[212:215], v[200:203], v[228:231]
    v_mfma_f32_16x16x32_bf16 v[124:127], a[56:59], v[136:139], v[124:127]
    v_mfma_f32_16x16x32_bf16 v[124:127], a[60:63], v[184:187], v[124:127]
    v_mfma_f32_16x16x32_bf16 v[160:163], a[56:59], v[144:147], v[160:163]
    v_mfma_f32_16x16x32_bf16 v[160:163], a[60:63], v[192:195], v[160:163]
    v_mfma_f32_16x16x32_bf16 v[176:179], a[56:59], v[148:151], v[176:179]
    v_mfma_f32_16x16x32_bf16 v[176:179], a[60:63], v[196:199], v[176:179]
    s_waitcnt lgkmcnt(4)
    v_mfma_f32_16x16x32_bf16 v[236:239], a[216:219], v[152:155], v[236:239]
    v_mfma_f32_16x16x32_bf16 v[236:239], a[220:223], v[200:203], v[236:239]
    v_mfma_f32_16x16x32_bf16 v[252:255], a[104:107], v[136:139], v[252:255]
    v_mfma_f32_16x16x32_bf16 v[252:255], a[108:111], v[184:187], v[252:255]
    ds_read_b128 a[232:235], v3 offset:16384
L_st2:
    s_cbranch_execz L_st5
    v_mfma_f32_16x16x32_bf16 v[76:79], a[104:107], v[144:147], v[76:79]
    ds_read_b128 a[240:243], v3 offset:17408
    v_mfma_f32_16x16x32_bf16 v[76:79], a[108:111], v[192:195], v[76:79]
    v_mfma_f32_16x16x32_bf16 v[116:119], a[104:107], v[148:151], v[116:119]
    v_mfma_f32_16x16x32_bf16 v[116:119], a[108:111], v[196:199], v[116:119]
    ds_read_b128 a[244:247], v1 offset:8192
    s_waitcnt lgkmcnt(5)
    v_mfma_f32_16x16x32_bf16 v[128:131], a[236:239], a[8:11], v[128:131]
    ds_read_b128 a[248:251], v1 offset:9216
    v_mfma_f32_16x16x32_bf16 v[128:131], a[252:255], a[12:15], v[128:131]
    ds_read_b128 a[192:195], v2 offset:32768
    v_mfma_f32_16x16x32_bf16 v[220:223], a[236:239], a[56:59], v[220:223]
    ds_read_b128 a[196:199], v2 offset:33792
    v_mfma_f32_16x16x32_bf16 v[220:223], a[252:255], a[60:63], v[220:223]
    v_mfma_f32_16x16x32_bf16 v[24:27], a[236:239], a[104:107], v[24:27]
    v_mfma_f32_16x16x32_bf16 v[24:27], a[252:255], a[108:111], v[24:27]
    v_mfma_f32_16x16x32_bf16 v[48:51], a[236:239], a[152:155], v[48:51]
    v_mfma_f32_16x16x32_bf16 v[48:51], a[252:255], a[156:159], v[48:51]
    ds_read_b128 a[200:203], v1 offset:10240
    s_waitcnt lgkmcnt(7)
    v_mfma_f32_16x16x32_bf16 v[56:59], a[224:227], a[8:11], v[56:59]
    ds_read_b128 a[204:207], v1 offset:11264
    v_mfma_f32_16x16x32_bf16 v[56:59], a[228:231], a[12:15], v[56:59]
    v_mfma_f32_16x16x32_bf16 v[68:71], a[224:227], a[56:59], v[68:71]
    v_mfma_f32_16x16x32_bf16 v[68:71], a[228:231], a[60:63], v[68:71]
    v_mfma_f32_16x16x32_bf16 v[88:91], a[224:227], a[104:107], v[88:91]
    v_mfma_f32_16x16x32_bf16 v[88:91], a[228:231], a[108:111], v[88:91]
    v_mfma_f32_16x16x32_bf16 v[96:99], a[224:227], a[152:155], v[96:99]
    v_mfma_f32_16x16x32_bf16 v[96:99], a[228:231], a[156:159], v[96:99]
    s_waitcnt lgkmcnt(2)
    v_mfma_f32_16x16x32_bf16 v[40:43], a[0:3], a[232:235], 0
    v_mfma_f32_16x16x32_bf16 v[40:43], a[4:7], a[240:243], v[40:43]
    v_mfma_f32_16x16x32_bf16 v[52:55], a[48:51], a[232:235], 0
    v_mfma_f32_16x16x32_bf16 v[52:55], a[52:55], a[240:243], v[52:55]
    ds_read_b128 a[208:211], v2 offset:36864
    v_mfma_f32_16x16x32_bf16 v[100:103], a[96:99], a[232:235], 0
    ds_read_b128 a[212:215], v2 offset:37888
    v_mfma_f32_16x16x32_bf16 v[100:103], a[100:103], a[240:243], v[100:103]
    v_mfma_f32_16x16x32_bf16 v[104:107], a[192:195], a[232:235], 0
    v_mfma_f32_16x16x32_bf16 v[104:107], a[196:199], a[240:243], v[104:107]
    v_mfma_f32_16x16x32_bf16 v[128:131], a[244:247], a[16:19], v[128:131]
    v_mfma_f32_16x16x32_bf16 v[128:131], a[248:251], a[20:23], v[128:131]
    v_mfma_f32_16x16x32_bf16 v[220:223], a[244:247], a[64:67], v[220:223]
    v_mfma_f32_16x16x32_bf16 v[220:223], a[248:251], a[68:71], v[220:223]
    ds_read_b128 a[216:219], v2 offset:49152
    v_mfma_f32_16x16x32_bf16 v[24:27], a[244:247], a[112:115], v[24:27]
    ds_read_b128 a[220:223], v2 offset:50176
    v_mfma_f32_16x16x32_bf16 v[24:27], a[248:251], a[116:119], v[24:27]
    v_mfma_f32_16x16x32_bf16 v[48:51], a[244:247], a[160:163], v[48:51]
    v_mfma_f32_16x16x32_bf16 v[48:51], a[248:251], a[164:167], v[48:51]
    s_waitcnt lgkmcnt(4)
    v_mfma_f32_16x16x32_bf16 v[56:59], a[200:203], a[16:19], v[56:59]
    v_mfma_f32_16x16x32_bf16 v[56:59], a[204:207], a[20:23], v[56:59]
    v_mfma_f32_16x16x32_bf16 v[68:71], a[200:203], a[64:67], v[68:71]
    v_mfma_f32_16x16x32_bf16 v[68:71], a[204:207], a[68:71], v[68:71]
    ds_read_b128 a[224:227], v2 offset:61440
    v_mfma_f32_16x16x32_bf16 v[88:91], a[200:203], a[112:115], v[88:91]
    ds_read_b128 a[228:231], v2 offset:62464
    v_mfma_f32_16x16x32_bf16 v[88:91], a[204:207], a[116:119], v[88:91]
    v_mfma_f32_16x16x32_bf16 v[96:99], a[200:203], a[160:163], v[96:99]
    v_mfma_f32_16x16x32_bf16 v[96:99], a[204:207], a[164:167], v[96:99]
    s_waitcnt lgkmcnt(4)
    v_mfma_f32_16x16x32_bf16 v[212:215], a[208:211], v[232:235], v[212:215]
    v_mfma_f32_16x16x32_bf16 v[212:215], a[212:215], v[60:63], v[212:215]
    v_mfma_f32_16x16x32_bf16 v[216:219], a[208:211], v[240:243], v[216:219]
    v_mfma_f32_16x16x32_bf16 v[216:219], a[212:215], v[84:87], v[216:219]
    ds_read_b128 a[236:239], v3 offset:8192
    v_mfma_f32_16x16x32_bf16 v[20:23], a[208:211], v[244:247], v[20:23]
    ds_read_b128 a[252:255], v3 offset:9216
    v_mfma_f32_16x16x32_bf16 v[20:23], a[212:215], v[92:95], v[20:23]
    v_mfma_f32_16x16x32_bf16 v[32:35], a[208:211], v[248:251], v[32:35]
    v_mfma_f32_16x16x32_bf16 v[32:35], a[212:215], v[108:111], v[32:35]
    ds_read_b128 a[192:195], v1 offset:12288
    s_waitcnt lgkmcnt(5)
    v_mfma_f32_16x16x32_bf16 v[64:67], a[216:219], v[248:251], v[64:67]
    ds_read_b128 a[196:199], v1 offset:13312
    v_mfma_f32_16x16x32_bf16 v[64:67], a[220:223], v[108:111], v[64:67]
    v_mfma_f32_16x16x32_bf16 v[112:115], a[16:19], v[232:235], v[112:115]
    v_mfma_f32_16x16x32_bf16 v[112:115], a[20:23], v[60:63], v[112:115]
    v_mfma_f32_16x16x32_bf16 v[132:135], a[16:19], v[240:243], v[132:135]
    v_mfma_f32_16x16x32_bf16 v[132:135], a[20:23], v[84:87], v[132:135]
    v_mfma_f32_16x16x32_bf16 v[164:167], a[16:19], v[244:247], v[164:167]
    v_mfma_f32_16x16x32_bf16 v[164:167], a[20:23], v[92:95], v[164:167]
    ds_read_b128 a[200:203], v1 offset:14336
    s_waitcnt lgkmcnt(5)
    v_mfma_f32_16x16x32_bf16 v[228:231], a[224:227], v[248:251], v[228:231]
    ds_read_b128 a[204:207], v1 offset:15360
    v_mfma_f32_16x16x32_bf16 v[228:231], a[228:231], v[108:111], v[228:231]
    v_mfma_f32_16x16x32_bf16 v[124:127], a[64:67], v[232:235], v[124:127]
    v_mfma_f32_16x16x32_bf16 v[124:127], a[68:71], v[60:63], v[124:127]
    v_mfma_f32_16x16x32_bf16 v[160:163], a[64:67], v[240:243], v[160:163]
    v_mfma_f32_16x16x32_bf16 v[160:163], a[68:71], v[84:87], v[160:163]
    v_mfma_f32_16x16x32_bf16 v[176:179], a[64:67], v[244:247], v[176:179]
    v_mfma_f32_16x16x32_bf16 v[176:179], a[68:71], v[92:95], v[176:179]
    s_waitcnt lgkmcnt(4)
    v_mfma_f32_16x16x32_bf16 v[236:239], a[236:239], v[248:251], v[236:239]
    v_mfma_f32_16x16x32_bf16 v[236:239], a[252:255], v[108:111], v[236:239]
    v_mfma_f32_16x16x32_bf16 v[252:255], a[112:115], v[232:235], v[252:255]
    v_mfma_f32_16x16x32_bf16 v[252:255], a[116:119], v[60:63], v[252:255]
    ds_read_b128 a[208:211], v3 offset:18432
    v_mfma_f32_16x16x32_bf16 v[76:79], a[112:115], v[240:243], v[76:79]
    ds_read_b128 a[212:215], v3 offset:19456
    v_mfma_f32_16x16x32_bf16 v[76:79], a[116:119], v[84:87], v[76:79]
    v_mfma_f32_16x16x32_bf16 v[116:119], a[112:115], v[244:247], v[116:119]
    v_mfma_f32_16x16x32_bf16 v[116:119], a[116:119], v[92:95], v[116:119]
    ds_read_b128 a[216:219], v1 offset:16384
    s_waitcnt lgkmcnt(5)
    v_mfma_f32_16x16x32_bf16 v[128:131], a[192:195], a[24:27], v[128:131]
    ds_read_b128 a[220:223], v1 offset:17408
    v_mfma_f32_16x16x32_bf16 v[128:131], a[196:199], a[28:31], v[128:131]
    ds_read_b128 a[224:227], v2 offset:34816
    v_mfma_f32_16x16x32_bf16 v[220:223], a[192:195], a[72:75], v[220:223]
    ds_read_b128 a[228:231], v2 offset:35840
    v_mfma_f32_16x16x32_bf16 v[220:223], a[196:199], a[76:79], v[220:223]
    v_mfma_f32_16x16x32_bf16 v[24:27], a[192:195], a[120:123], v[24:27]
    v_mfma_f32_16x16x32_bf16 v[24:27], a[196:199], a[124:127], v[24:27]
    v_mfma_f32_16x16x32_bf16 v[48:51], a[192:195], a[168:171], v[48:51]
    v_mfma_f32_16x16x32_bf16 v[48:51], a[196:199], a[172:175], v[48:51]
    ds_read_b128 a[232:235], v1 offset:18432
    s_waitcnt lgkmcnt(7)
    v_mfma_f32_16x16x32_bf16 v[56:59], a[200:203], a[24:27], v[56:59]
    ds_read_b128 a[236:239], v1 offset:19456
    v_mfma_f32_16x16x32_bf16 v[56:59], a[204:207], a[28:31], v[56:59]
    s_waitcnt vmcnt(6)
    s_barrier
    v_mfma_f32_16x16x32_bf16 v[68:71], a[200:203], a[72:75], v[68:71]
    s_add_u32 m0, s17, 73728
    v_mfma_f32_16x16x32_bf16 v[68:71], a[204:207], a[76:79], v[68:71]
    global_load_lds_dwordx4 v4, s[34:35] offset:-3072 sc1
    v_mfma_f32_16x16x32_bf16 v[88:91], a[200:203], a[120:123], v[88:91]
    v_mfma_f32_16x16x32_bf16 v[88:91], a[204:207], a[124:127], v[88:91]
    v_mfma_f32_16x16x32_bf16 v[96:99], a[200:203], a[168:171], v[96:99]
    v_mfma_f32_16x16x32_bf16 v[96:99], a[204:207], a[172:175], v[96:99]
    ds_read_b128 a[240:243], v1 offset:20480
    s_waitcnt lgkmcnt(3)
    v_mfma_f32_16x16x32_bf16 v[40:43], a[8:11], a[208:211], v[40:43]
    ds_read_b128 a[244:247], v1 offset:21504
    v_mfma_f32_16x16x32_bf16 v[40:43], a[12:15], a[212:215], v[40:43]
    global_load_lds_dwordx4 v4, s[34:35] offset:-2048 sc1
    v_mfma_f32_16x16x32_bf16 v[52:55], a[56:59], a[208:211], v[52:55]
    v_mfma_f32_16x16x32_bf16 v[52:55], a[60:63], a[212:215], v[52:55]
    v_mfma_f32_16x16x32_bf16 v[100:103], a[104:107], a[208:211], v[100:103]
    v_mfma_f32_16x16x32_bf16 v[100:103], a[108:111], a[212:215], v[100:103]
    v_mfma_f32_16x16x32_bf16 v[104:107], a[224:227], a[208:211], v[104:107]
    global_load_lds_dwordx4 v4, s[34:35] offset:-1024 sc1
    v_mfma_f32_16x16x32_bf16 v[104:107], a[228:231], a[212:215], v[104:107]
    ds_read_b128 a[248:251], v1 offset:22528
    v_mfma_f32_16x16x32_bf16 v[128:131], a[216:219], a[32:35], v[128:131]
    ds_read_b128 a[252:255], v1 offset:23552
    v_mfma_f32_16x16x32_bf16 v[128:131], a[220:223], a[36:39], v[128:131]
    v_mfma_f32_16x16x32_bf16 v[220:223], a[216:219], a[80:83], v[220:223]
    v_mfma_f32_16x16x32_bf16 v[220:223], a[220:223], a[84:87], v[220:223]
    global_load_lds_dwordx4 v4, s[34:35] sc1
    v_mfma_f32_16x16x32_bf16 v[24:27], a[216:219], a[128:131], v[24:27]
    v_mfma_f32_16x16x32_bf16 v[24:27], a[220:223], a[132:135], v[24:27]
    v_mfma_f32_16x16x32_bf16 v[48:51], a[216:219], a[176:179], v[48:51]
    v_mfma_f32_16x16x32_bf16 v[48:51], a[220:223], a[180:183], v[48:51]
    s_waitcnt lgkmcnt(4)
    v_mfma_f32_16x16x32_bf16 v[56:59], a[232:235], a[32:35], v[56:59]
    v_mfma_f32_16x16x32_bf16 v[56:59], a[236:239], a[36:39], v[56:59]
    global_load_lds_dwordx4 v4, s[34:35] offset:1024 sc1
    v_mfma_f32_16x16x32_bf16 v[68:71], a[232:235], a[80:83], v[68:71]
    v_mfma_f32_16x16x32_bf16 v[68:71], a[236:239], a[84:87], v[68:71]
    ds_read_b128 a[192:195], v2 offset:38912
    v_mfma_f32_16x16x32_bf16 v[88:91], a[232:235], a[128:131], v[88:91]
    ds_read_b128 a[196:199], v2 offset:39936
    v_mfma_f32_16x16x32_bf16 v[88:91], a[236:239], a[132:135], v[88:91]
    v_mfma_f32_16x16x32_bf16 v[96:99], a[232:235], a[176:179], v[96:99]
    v_mfma_f32_16x16x32_bf16 v[96:99], a[236:239], a[180:183], v[96:99]
    s_waitcnt lgkmcnt(4)
    v_mfma_f32_16x16x32_bf16 v[128:131], a[240:243], a[40:43], v[128:131]
    global_load_lds_dwordx4 v4, s[34:35] offset:2048 sc1
    v_mfma_f32_16x16x32_bf16 v[128:131], a[244:247], a[44:47], v[128:131]
    v_add_u32 v4, 24576, v4
    v_mfma_f32_16x16x32_bf16 v[220:223], a[240:243], a[88:91], v[220:223]
    v_mfma_f32_16x16x32_bf16 v[220:223], a[244:247], a[92:95], v[220:223]
    ds_read_b128 a[200:203], v2 offset:51200
    v_mfma_f32_16x16x32_bf16 v[24:27], a[240:243], a[136:139], v[24:27]
    ds_read_b128 a[204:207], v2 offset:52224
    v_mfma_f32_16x16x32_bf16 v[24:27], a[244:247], a[140:143], v[24:27]
    v_mfma_f32_16x16x32_bf16 v[48:51], a[240:243], a[184:187], v[48:51]
    v_mfma_f32_16x16x32_bf16 v[48:51], a[244:247], a[188:191], v[48:51]
    s_waitcnt lgkmcnt(4)
    v_mfma_f32_16x16x32_bf16 v[56:59], a[248:251], a[40:43], v[56:59]
    v_cvt_pk_bf16_f32 v128, v128, v129
    v_cvt_pk_bf16_f32 v129, v130, v131
    v_mfma_f32_16x16x32_bf16 v[56:59], a[252:255], a[44:47], v[56:59]
    v_mfma_f32_16x16x32_bf16 v[68:71], a[248:251], a[88:91], v[68:71]
    v_cvt_pk_bf16_f32 v220, v220, v221
    v_cvt_pk_bf16_f32 v221, v222, v223
    v_mfma_f32_16x16x32_bf16 v[68:71], a[252:255], a[92:95], v[68:71]
    ds_read_b128 a[208:211], v2 offset:63488
    v_mfma_f32_16x16x32_bf16 v[88:91], a[248:251], a[136:139], v[88:91]
    ds_read_b128 a[212:215], v2 offset:64512
    v_cvt_pk_bf16_f32 v24, v24, v25
    v_mfma_f32_16x16x32_bf16 v[88:91], a[252:255], a[140:143], v[88:91]
    v_cvt_pk_bf16_f32 v25, v26, v27
    v_mfma_f32_16x16x32_bf16 v[96:99], a[248:251], a[184:187], v[96:99]
    v_cvt_pk_bf16_f32 v48, v48, v49
    v_cvt_pk_bf16_f32 v49, v50, v51
    v_mfma_f32_16x16x32_bf16 v[96:99], a[252:255], a[188:191], v[96:99]
    s_waitcnt lgkmcnt(4)
    v_mfma_f32_16x16x32_bf16 v[212:215], a[192:195], v[204:207], v[212:215]
    v_cvt_pk_bf16_f32 v130, v56, v57
    v_cvt_pk_bf16_f32 v131, v58, v59
    v_mfma_f32_16x16x32_bf16 v[212:215], a[196:199], v[80:83], v[212:215]
    v_mfma_f32_16x16x32_bf16 v[216:219], a[192:195], v[28:31], v[216:219]
    v_cvt_pk_bf16_f32 v222, v68, v69
    v_cvt_pk_bf16_f32 v223, v70, v71
    v_mfma_f32_16x16x32_bf16 v[216:219], a[196:199], v[36:39], v[216:219]
    ds_read_b128 a[216:219], v3 offset:10240
    v_mfma_f32_16x16x32_bf16 v[20:23], a[192:195], v[168:171], v[20:23]
    ds_read_b128 a[220:223], v3 offset:11264
    v_cvt_pk_bf16_f32 v26, v88, v89
    v_mfma_f32_16x16x32_bf16 v[20:23], a[196:199], v[72:75], v[20:23]
    v_cvt_pk_bf16_f32 v27, v90, v91
    v_mfma_f32_16x16x32_bf16 v[32:35], a[192:195], v[172:175], v[32:35]
    v_cvt_pk_bf16_f32 v50, v96, v97
    v_cvt_pk_bf16_f32 v51, v98, v99
    v_mfma_f32_16x16x32_bf16 v[32:35], a[196:199], v[156:159], v[32:35]
    ds_read_b128 a[224:227], v1 offset:24576
    s_waitcnt lgkmcnt(5)
    v_mfma_f32_16x16x32_bf16 v[64:67], a[200:203], v[172:175], v[64:67]
    ds_write_b128 v14, v[48:51] offset:8192
    v_mfma_f32_16x16x32_bf16 v[64:67], a[204:207], v[156:159], v[64:67]
    ds_read_b128 a[228:231], v1 offset:25600
    v_mfma_f32_16x16x32_bf16 v[112:115], a[24:27], v[204:207], v[112:115]
    v_mfma_f32_16x16x32_bf16 v[112:115], a[28:31], v[80:83], v[112:115]
    v_mfma_f32_16x16x32_bf16 v[132:135], a[24:27], v[28:31], v[132:135]
    v_mfma_f32_16x16x32_bf16 v[132:135], a[28:31], v[36:39], v[132:135]
    v_mfma_f32_16x16x32_bf16 v[164:167], a[24:27], v[168:171], v[164:167]
    v_mfma_f32_16x16x32_bf16 v[164:167], a[28:31], v[72:75], v[164:167]
    ds_read_b128 a[232:235], v1 offset:26624
    s_waitcnt lgkmcnt(6)
    v_mfma_f32_16x16x32_bf16 v[228:231], a[208:211], v[172:175], v[228:231]
    ds_read_b128 a[192:195], v1 offset:27648
    v_mfma_f32_16x16x32_bf16 v[228:231], a[212:215], v[156:159], v[228:231]
    v_mfma_f32_16x16x32_bf16 v[124:127], a[72:75], v[204:207], v[124:127]
    v_mfma_f32_16x16x32_bf16 v[124:127], a[76:79], v[80:83], v[124:127]
    v_mfma_f32_16x16x32_bf16 v[160:163], a[72:75], v[28:31], v[160:163]
    v_mfma_f32_16x16x32_bf16 v[160:163], a[76:79], v[36:39], v[160:163]
    v_mfma_f32_16x16x32_bf16 v[176:179], a[72:75], v[168:171], v[176:179]
    v_mfma_f32_16x16x32_bf16 v[176:179], a[76:79], v[72:75], v[176:179]
    ds_read_b128 a[196:199], v1 offset:28672
    s_waitcnt lgkmcnt(6)
    v_mfma_f32_16x16x32_bf16 v[236:239], a[216:219], v[172:175], v[236:239]
    ds_read_b128 a[200:203], v1 offset:29696
    v_mfma_f32_16x16x32_bf16 v[236:239], a[220:223], v[156:159], v[236:239]
    v_mfma_f32_16x16x32_bf16 v[252:255], a[120:123], v[204:207], v[252:255]
    v_mfma_f32_16x16x32_bf16 v[252:255], a[124:127], v[80:83], v[252:255]
    v_mfma_f32_16x16x32_bf16 v[76:79], a[120:123], v[28:31], v[76:79]
    v_mfma_f32_16x16x32_bf16 v[76:79], a[124:127], v[36:39], v[76:79]
    v_mfma_f32_16x16x32_bf16 v[116:119], a[120:123], v[168:171], v[116:119]
    v_mfma_f32_16x16x32_bf16 v[116:119], a[124:127], v[72:75], v[116:119]
    s_waitcnt lgkmcnt(4)
    v_mfma_f32_16x16x32_bf16 v[120:123], a[224:227], a[0:3], 0
    buffer_load_dwordx4 a[204:207], v16, s[4:7], 0 offen
    v_mfma_f32_16x16x32_bf16 v[120:123], a[228:231], a[4:7], v[120:123]
    v_mfma_f32_16x16x32_bf16 v[188:191], a[224:227], a[48:51], 0
    v_mfma_f32_16x16x32_bf16 v[188:191], a[228:231], a[52:55], v[188:191]
    ds_read_b128 a[208:211], v3 offset:20480
    v_mfma_f32_16x16x32_bf16 v[208:211], a[224:227], a[96:99], 0
    ds_read_b128 a[212:215], v3 offset:21504
    v_mfma_f32_16x16x32_bf16 v[208:211], a[228:231], a[100:103], v[208:211]
    v_mfma_f32_16x16x32_bf16 v[224:227], a[224:227], a[144:147], 0
    v_mfma_f32_16x16x32_bf16 v[224:227], a[228:231], a[148:151], v[224:227]
    ds_read_b128 a[236:239], v1 offset:30720
    s_waitcnt lgkmcnt(5)
    v_mfma_f32_16x16x32_bf16 v[44:47], a[232:235], a[0:3], 0
    ds_read_b128 a[240:243], v1 offset:31744
    v_mfma_f32_16x16x32_bf16 v[44:47], a[192:195], a[4:7], v[44:47]
    ds_read_b128 a[244:247], v2 offset:36864
    v_mfma_f32_16x16x32_bf16 v[136:139], a[232:235], a[48:51], 0
    ds_read_b128 a[248:251], v2 offset:37888
    v_mfma_f32_16x16x32_bf16 v[136:139], a[192:195], a[52:55], v[136:139]
    buffer_load_dwordx4 a[252:255], v16, s[4:7], 0 offen offset:64
    v_mfma_f32_16x16x32_bf16 v[144:147], a[232:235], a[96:99], 0
    v_mfma_f32_16x16x32_bf16 v[144:147], a[192:195], a[100:103], v[144:147]
    v_mfma_f32_16x16x32_bf16 v[148:151], a[232:235], a[144:147], 0
    v_mfma_f32_16x16x32_bf16 v[148:151], a[192:195], a[148:151], v[148:151]
    ds_read_b128 a[216:219], v1 offset:32768
    s_waitcnt lgkmcnt(7)
    v_mfma_f32_16x16x32_bf16 v[120:123], a[196:199], a[8:11], v[120:123]
    ds_read_b128 a[220:223], v1 offset:33792
    v_mfma_f32_16x16x32_bf16 v[120:123], a[200:203], a[12:15], v[120:123]
    v_mfma_f32_16x16x32_bf16 v[188:191], a[196:199], a[56:59], v[188:191]
    v_mfma_f32_16x16x32_bf16 v[188:191], a[200:203], a[60:63], v[188:191]
    v_mfma_f32_16x16x32_bf16 v[208:211], a[196:199], a[104:107], v[208:211]
    v_mfma_f32_16x16x32_bf16 v[208:211], a[200:203], a[108:111], v[208:211]
    v_mfma_f32_16x16x32_bf16 v[224:227], a[196:199], a[152:155], v[224:227]
    v_mfma_f32_16x16x32_bf16 v[224:227], a[200:203], a[156:159], v[224:227]
    ds_read_b128 a[192:195], v1 offset:34816
    s_waitcnt lgkmcnt(3)
    v_mfma_f32_16x16x32_bf16 v[40:43], a[16:19], a[208:211], v[40:43]
    buffer_load_dwordx4 a[224:227], v16, s[4:7], 0 offen offset:128
    v_mfma_f32_16x16x32_bf16 v[40:43], a[20:23], a[212:215], v[40:43]
    ds_read_b128 a[228:231], v1 offset:35840
    v_mfma_f32_16x16x32_bf16 v[52:55], a[64:67], a[208:211], v[52:55]
    v_mfma_f32_16x16x32_bf16 v[52:55], a[68:71], a[212:215], v[52:55]
    v_mfma_f32_16x16x32_bf16 v[100:103], a[112:115], a[208:211], v[100:103]
    v_mfma_f32_16x16x32_bf16 v[100:103], a[116:119], a[212:215], v[100:103]
    v_mfma_f32_16x16x32_bf16 v[104:107], a[244:247], a[208:211], v[104:107]
    v_mfma_f32_16x16x32_bf16 v[104:107], a[248:251], a[212:215], v[104:107]
    v_mfma_f32_16x16x32_bf16 v[44:47], a[236:239], a[8:11], v[44:47]
    v_cmp_gt_u32 vcc, 72, v142
    s_nop 0
    s_cbranch_vccnz L_slowN
L_backN:
    v_mfma_f32_16x16x32_bf16 v[44:47], a[240:243], a[12:15], v[44:47]
    v_mfma_f32_16x16x32_bf16 v[136:139], a[236:239], a[56:59], v[136:139]
    v_mfma_f32_16x16x32_bf16 v[136:139], a[240:243], a[60:63], v[136:139]
    ds_read_b128 a[196:199], v3 offset:22528
    v_mfma_f32_16x16x32_bf16 v[144:147], a[236:239], a[104:107], v[144:147]
    ds_read_b128 a[200:203], v3 offset:23552
    v_mfma_f32_16x16x32_bf16 v[144:147], a[240:243], a[108:111], v[144:147]
    buffer_load_dwordx4 a[208:211], v16, s[4:7], 0 offen offset:192
    v_mfma_f32_16x16x32_bf16 v[148:151], a[236:239], a[152:155], v[148:151]
    v_mfma_f32_16x16x32_bf16 v[148:151], a[240:243], a[156:159], v[148:151]
    ds_read_b128 a[212:215], v1 offset:36864
    s_waitcnt lgkmcnt(5)
    v_mfma_f32_16x16x32_bf16 v[120:123], a[216:219], a[16:19], v[120:123]
    s_waitcnt vmcnt(10)
    s_barrier
    v_mfma_f32_16x16x32_bf16 v[120:123], a[220:223], a[20:23], v[120:123]
    ds_read_b128 a[232:235], v2 offset:38912
    s_nop 0
    v_mfma_f32_16x16x32_bf16 v[188:191], a[216:219], a[64:67], v[188:191]
    ds_read_b128 a[244:247], v2 offset:39936
    ds_read_b128 a[248:251], v1 offset:37888
    v_mfma_f32_16x16x32_bf16 v[188:191], a[220:223], a[68:71], v[188:191]
    s_add_u32 m0, s17, 0
    v_mfma_f32_16x16x32_bf16 v[208:211], a[216:219], a[112:115], v[208:211]
    global_load_lds_dwordx4 v4, s[34:35] offset:-3072 sc1
    v_mfma_f32_16x16x32_bf16 v[208:211], a[220:223], a[116:119], v[208:211]
    v_mfma_f32_16x16x32_bf16 v[224:227], a[216:219], a[160:163], v[224:227]
    v_mfma_f32_16x16x32_bf16 v[224:227], a[220:223], a[164:167], v[224:227]
    ds_read_b128 a[236:239], v1 offset:38912
    s_waitcnt lgkmcnt(7)
    v_mfma_f32_16x16x32_bf16 v[44:47], a[192:195], a[16:19], v[44:47]
    ds_read_b128 a[240:243], v1 offset:39936
    v_mfma_f32_16x16x32_bf16 v[44:47], a[228:231], a[20:23], v[44:47]
    buffer_load_dwordx4 v[152:155], v16, s[4:7], 0 offen offset:256
    v_mfma_f32_16x16x32_bf16 v[136:139], a[192:195], a[64:67], v[136:139]
    v_mfma_f32_16x16x32_bf16 v[136:139], a[228:231], a[68:71], v[136:139]
    v_mfma_f32_16x16x32_bf16 v[144:147], a[192:195], a[112:115], v[144:147]
    v_mfma_f32_16x16x32_bf16 v[144:147], a[228:231], a[116:119], v[144:147]
    v_mfma_f32_16x16x32_bf16 v[148:151], a[192:195], a[160:163], v[148:151]
    global_load_lds_dwordx4 v4, s[34:35] offset:-2048 sc1
    v_mfma_f32_16x16x32_bf16 v[148:151], a[228:231], a[164:167], v[148:151]
    ds_read_b128 a[216:219], v1 offset:40960
    s_waitcnt lgkmcnt(4)
    v_mfma_f32_16x16x32_bf16 v[40:43], a[24:27], a[196:199], v[40:43]
    ds_read_b128 a[220:223], v1 offset:41984
    v_mfma_f32_16x16x32_bf16 v[40:43], a[28:31], a[200:203], v[40:43]
    v_mfma_f32_16x16x32_bf16 v[52:55], a[72:75], a[196:199], v[52:55]
    v_mfma_f32_16x16x32_bf16 v[52:55], a[76:79], a[200:203], v[52:55]
    buffer_load_dwordx4 a[192:195], v16, s[4:7], 0 offen offset:320
    v_mfma_f32_16x16x32_bf16 v[100:103], a[120:123], a[196:199], v[100:103]
    v_mfma_f32_16x16x32_bf16 v[100:103], a[124:127], a[200:203], v[100:103]
    v_mfma_f32_16x16x32_bf16 v[104:107], a[232:235], a[196:199], v[104:107]
    v_mfma_f32_16x16x32_bf16 v[104:107], a[244:247], a[200:203], v[104:107]
    ds_read_b128 a[228:231], v1 offset:43008
    s_waitcnt lgkmcnt(5)
    v_mfma_f32_16x16x32_bf16 v[120:123], a[212:215], a[24:27], v[120:123]
    ds_read_b128 v[180:183], v1 offset:44032
    v_mfma_f32_16x16x32_bf16 v[120:123], a[248:251], a[28:31], v[120:123]
    global_load_lds_dwordx4 v4, s[34:35] offset:-1024 sc1
    v_mfma_f32_16x16x32_bf16 v[188:191], a[212:215], a[72:75], v[188:191]
    v_mfma_f32_16x16x32_bf16 v[188:191], a[248:251], a[76:79], v[188:191]
    v_mfma_f32_16x16x32_bf16 v[208:211], a[212:215], a[120:123], v[208:211]
    v_mfma_f32_16x16x32_bf16 v[208:211], a[248:251], a[124:127], v[208:211]
    v_mfma_f32_16x16x32_bf16 v[224:227], a[212:215], a[168:171], v[224:227]
    global_load_lds_dwordx4 v4, s[34:35] sc1
    v_mfma_f32_16x16x32_bf16 v[224:227], a[248:251], a[172:175], v[224:227]
    ds_read_b128 a[196:199], v1 offset:45056
    s_waitcnt lgkmcnt(5)
    v_mfma_f32_16x16x32_bf16 v[44:47], a[236:239], a[24:27], v[44:47]
    ds_read_b128 a[200:203], v1 offset:46080
    v_mfma_f32_16x16x32_bf16 v[44:47], a[240:243], a[28:31], v[44:47]
    v_mfma_f32_16x16x32_bf16 v[136:139], a[236:239], a[72:75], v[136:139]
    v_mfma_f32_16x16x32_bf16 v[136:139], a[240:243], a[76:79], v[136:139]
    buffer_load_dwordx4 a[212:215], v16, s[4:7], 0 offen offset:384
    v_mfma_f32_16x16x32_bf16 v[144:147], a[236:239], a[120:123], v[144:147]
    v_mfma_f32_16x16x32_bf16 v[144:147], a[240:243], a[124:127], v[144:147]
    v_mfma_f32_16x16x32_bf16 v[148:151], a[236:239], a[168:171], v[148:151]
    v_mfma_f32_16x16x32_bf16 v[148:151], a[240:243], a[172:175], v[148:151]
    ds_read_b128 a[232:235], v1 offset:47104
    s_waitcnt lgkmcnt(5)
    v_mfma_f32_16x16x32_bf16 v[120:123], a[216:219], a[32:35], v[120:123]
    ds_read_b128 a[244:247], v1 offset:48128
    v_mfma_f32_16x16x32_bf16 v[120:123], a[220:223], a[36:39], v[120:123]
    global_load_lds_dwordx4 v4, s[34:35] offset:1024 sc1
    v_mfma_f32_16x16x32_bf16 v[188:191], a[216:219], a[80:83], v[188:191]
    v_mfma_f32_16x16x32_bf16 v[188:191], a[220:223], a[84:87], v[188:191]
    v_mfma_f32_16x16x32_bf16 v[208:211], a[216:219], a[128:131], v[208:211]
    v_mfma_f32_16x16x32_bf16 v[208:211], a[220:223], a[132:135], v[208:211]
    v_mfma_f32_16x16x32_bf16 v[224:227], a[216:219], a[176:179], v[224:227]
    buffer_load_dwordx4 a[248:251], v16, s[4:7], 0 offen offset:448
    v_mfma_f32_16x16x32_bf16 v[224:227], a[220:223], a[180:183], v[224:227]
    ds_read_b128 a[236:239], v1 offset:49152
    s_waitcnt lgkmcnt(5)
    v_mfma_f32_16x16x32_bf16 v[44:47], a[228:231], a[32:35], v[44:47]
    ds_read_b128 a[240:243], v1 offset:50176
    v_mfma_f32_16x16x32_bf16 v[44:47], v[180:183], a[36:39], v[44:47]
    v_mfma_f32_16x16x32_bf16 v[136:139], a[228:231], a[80:83], v[136:139]
    v_mfma_f32_16x16x32_bf16 v[136:139], v[180:183], a[84:87], v[136:139]
    global_load_lds_dwordx4 v4, s[34:35] offset:2048 sc1
    v_mfma_f32_16x16x32_bf16 v[144:147], a[228:231], a[128:131], v[144:147]
    v_add_u32 v4, 24576, v4
    v_mfma_f32_16x16x32_bf16 v[144:147], v[180:183], a[132:135], v[144:147]
    v_mfma_f32_16x16x32_bf16 v[148:151], a[228:231], a[176:179], v[148:151]
    v_mfma_f32_16x16x32_bf16 v[148:151], v[180:183], a[180:183], v[148:151]
    ds_read_b128 a[216:219], v1 offset:51200
    s_waitcnt lgkmcnt(5)
    v_mfma_f32_16x16x32_bf16 v[120:123], a[196:199], a[40:43], v[120:123]
    buffer_load_dwordx4 a[220:223], v16, s[4:7], 0 offen offset:512
    v_mfma_f32_16x16x32_bf16 v[120:123], a[200:203], a[44:47], v[120:123]
    ds_read_b128 v[184:187], v1 offset:52224
    v_mfma_f32_16x16x32_bf16 v[188:191], a[196:199], a[88:91], v[188:191]
    v_mfma_f32_16x16x32_bf16 v[188:191], a[200:203], a[92:95], v[188:191]
    v_mfma_f32_16x16x32_bf16 v[208:211], a[196:199], a[136:139], v[208:211]
    v_mfma_f32_16x16x32_bf16 v[208:211], a[200:203], a[140:143], v[208:211]
    v_mfma_f32_16x16x32_bf16 v[224:227], a[196:199], a[184:187], v[224:227]
    v_mfma_f32_16x16x32_bf16 v[224:227], a[200:203], a[188:191], v[224:227]
    ds_read_b128 a[228:231], v1 offset:53248
    s_waitcnt lgkmcnt(5)
    v_mfma_f32_16x16x32_bf16 v[44:47], a[232:235], a[40:43], v[44:47]
    ds_read_b128 v[192:195], v1 offset:54272
    v_cvt_pk_bf16_f32 v120, v120, v121
    v_mfma_f32_16x16x32_bf16 v[44:47], a[244:247], a[44:47], v[44:47]
    v_cvt_pk_bf16_f32 v121, v122, v123
    v_mfma_f32_16x16x32_bf16 v[136:139], a[232:235], a[88:91], v[136:139]
    v_cvt_pk_bf16_f32 v188, v188, v189
    v_cvt_pk_bf16_f32 v189, v190, v191
    v_mfma_f32_16x16x32_bf16 v[136:139], a[244:247], a[92:95], v[136:139]
    buffer_load_dwordx4 a[196:199], v16, s[4:7], 0 offen offset:576
    v_mfma_f32_16x16x32_bf16 v[144:147], a[232:235], a[136:139], v[144:147]
    v_cvt_pk_bf16_f32 v208, v208, v209
    v_cvt_pk_bf16_f32 v209, v210, v211
    v_mfma_f32_16x16x32_bf16 v[144:147], a[244:247], a[140:143], v[144:147]
    v_mfma_f32_16x16x32_bf16 v[148:151], a[232:235], a[184:187], v[148:151]
    v_cvt_pk_bf16_f32 v224, v224, v225
    v_cvt_pk_bf16_f32 v225, v226, v227
    v_mfma_f32_16x16x32_bf16 v[148:151], a[244:247], a[188:191], v[148:151]
    ds_read_b128 a[200:203], v1 offset:55296
    s_waitcnt lgkmcnt(5)
    v_mfma_f32_16x16x32_bf16 v[196:199], a[236:239], a[0:3], 0
    ds_read_b128 v[200:203], v1 offset:56320
    v_cvt_pk_bf16_f32 v122, v44, v45
    v_mfma_f32_16x16x32_bf16 v[196:199], a[240:243], a[4:7], v[196:199]
    v_cvt_pk_bf16_f32 v123, v46, v47
    v_mfma_f32_16x16x32_bf16 v[60:63], a[236:239], a[48:51], 0
    v_cvt_pk_bf16_f32 v190, v136, v137
    v_cvt_pk_bf16_f32 v191, v138, v139
    v_mfma_f32_16x16x32_bf16 v[60:63], a[240:243], a[52:55], v[60:63]
    v_mfma_f32_16x16x32_bf16 v[108:111], a[236:239], a[96:99], 0
    v_cvt_pk_bf16_f32 v210, v144, v145
    v_cvt_pk_bf16_f32 v211, v146, v147
    v_mfma_f32_16x16x32_bf16 v[108:111], a[240:243], a[100:103], v[108:111]
    v_mfma_f32_16x16x32_bf16 v[232:235], a[236:239], a[144:147], 0
    v_cvt_pk_bf16_f32 v226, v148, v149
    v_cvt_pk_bf16_f32 v227, v150, v151
    v_mfma_f32_16x16x32_bf16 v[232:235], a[240:243], a[148:151], v[232:235]
    s_waitcnt lgkmcnt(4)
    v_mfma_f32_16x16x32_bf16 v[248:251], a[216:219], a[0:3], 0
    ds_write_b128 v14, v[224:227] offset:9216
    v_mfma_f32_16x16x32_bf16 v[248:251], v[184:187], a[4:7], v[248:251]
    buffer_load_dwordx4 a[232:235], v16, s[4:7], 0 offen offset:640
    v_mfma_f32_16x16x32_bf16 v[84:87], a[216:219], a[48:51], 0
    v_mfma_f32_16x16x32_bf16 v[84:87], v[184:187], a[52:55], v[84:87]
    ds_read_b128 a[244:247], v2 offset:40960
    v_mfma_f32_16x16x32_bf16 v[92:95], a[216:219], a[96:99], 0
    ds_read_b128 a[236:239], v2 offset:41984
    v_mfma_f32_16x16x32_bf16 v[92:95], v[184:187], a[100:103], v[92:95]
    v_mfma_f32_16x16x32_bf16 v[240:243], a[216:219], a[144:147], 0
    v_mfma_f32_16x16x32_bf16 v[240:243], v[184:187], a[148:151], v[240:243]
    s_waitcnt lgkmcnt(5)
    v_mfma_f32_16x16x32_bf16 v[196:199], a[228:231], a[8:11], v[196:199]
    v_mfma_f32_16x16x32_bf16 v[196:199], v[192:195], a[12:15], v[196:199]
    v_mfma_f32_16x16x32_bf16 v[60:63], a[228:231], a[56:59], v[60:63]
    v_mfma_f32_16x16x32_bf16 v[60:63], v[192:195], a[60:63], v[60:63]
    ds_read_b128 a[240:243], v2 offset:53248
    v_mfma_f32_16x16x32_bf16 v[108:111], a[228:231], a[104:107], v[108:111]
    ds_read_b128 a[216:219], v2 offset:54272
    v_mfma_f32_16x16x32_bf16 v[108:111], v[192:195], a[108:111], v[108:111]
    buffer_load_dwordx4 v[244:247], v16, s[4:7], 0 offen offset:704
    v_mfma_f32_16x16x32_bf16 v[232:235], a[228:231], a[152:155], v[232:235]
    v_mfma_f32_16x16x32_bf16 v[232:235], v[192:195], a[156:159], v[232:235]
    s_waitcnt lgkmcnt(5)
    v_mfma_f32_16x16x32_bf16 v[248:251], a[200:203], a[8:11], v[248:251]
    v_mfma_f32_16x16x32_bf16 v[248:251], v[200:203], a[12:15], v[248:251]
    v_mfma_f32_16x16x32_bf16 v[84:87], a[200:203], a[56:59], v[84:87]
    v_mfma_f32_16x16x32_bf16 v[84:87], v[200:203], a[60:63], v[84:87]
    ds_read_b128 v[56:59], v3
    v_mfma_f32_16x16x32_bf16 v[92:95], a[200:203], a[104:107], v[92:95]
    ds_read_b128 a[228:231], v3 offset:1024
    v_mfma_f32_16x16x32_bf16 v[92:95], v[200:203], a[108:111], v[92:95]
    v_mfma_f32_16x16x32_bf16 v[240:243], a[200:203], a[152:155], v[240:243]
    v_mfma_f32_16x16x32_bf16 v[240:243], v[200:203], a[156:159], v[240:243]
    s_waitcnt lgkmcnt(4)
    v_mfma_f32_16x16x32_bf16 v[212:215], a[244:247], v[128:131], v[212:215]
    v_mfma_f32_16x16x32_bf16 v[212:215], a[236:239], v[120:123], v[212:215]
    v_mfma_f32_16x16x32_bf16 v[216:219], a[244:247], v[220:223], v[216:219]
    v_mfma_f32_16x16x32_bf16 v[216:219], a[236:239], v[188:191], v[216:219]
    ds_read_b128 v[68:71], v3 offset:12288
    v_mfma_f32_16x16x32_bf16 v[20:23], a[244:247], v[24:27], v[20:23]
    ds_read_b128 a[200:203], v3 offset:13312
    v_mfma_f32_16x16x32_bf16 v[20:23], a[236:239], v[208:211], v[20:23]
    v_mfma_f32_16x16x32_bf16 v[32:35], a[244:247], v[48:51], v[32:35]
    v_mfma_f32_16x16x32_bf16 v[32:35], a[236:239], v[224:227], v[32:35]
    ds_read_b128 v[88:91], v1 offset:57344
    s_waitcnt lgkmcnt(5)
    v_mfma_f32_16x16x32_bf16 v[64:67], a[240:243], v[48:51], v[64:67]
    ds_read_b128 v[96:99], v1 offset:58368
    v_mfma_f32_16x16x32_bf16 v[64:67], a[216:219], v[224:227], v[64:67]
    v_mfma_f32_16x16x32_bf16 v[112:115], a[32:35], v[128:131], v[112:115]
    v_mfma_f32_16x16x32_bf16 v[112:115], a[36:39], v[120:123], v[112:115]
    v_mfma_f32_16x16x32_bf16 v[132:135], a[32:35], v[220:223], v[132:135]
    v_mfma_f32_16x16x32_bf16 v[132:135], a[36:39], v[188:191], v[132:135]
    v_mfma_f32_16x16x32_bf16 v[164:167], a[32:35], v[24:27], v[164:167]
    v_mfma_f32_16x16x32_bf16 v[164:167], a[36:39], v[208:211], v[164:167]
    ds_read_b128 a[236:239], v1 offset:59392
    s_waitcnt lgkmcnt(5)
    v_mfma_f32_16x16x32_bf16 v[228:231], v[56:59], v[48:51], v[228:231]
    ds_read_b128 a[240:243], v1 offset:60416
    v_mfma_f32_16x16x32_bf16 v[228:231], a[228:231], v[224:227], v[228:231]
    v_mfma_f32_16x16x32_bf16 v[124:127], a[80:83], v[128:131], v[124:127]
    v_mfma_f32_16x16x32_bf16 v[124:127], a[84:87], v[120:123], v[124:127]
    v_mfma_f32_16x16x32_bf16 v[160:163], a[80:83], v[220:223], v[160:163]
    v_mfma_f32_16x16x32_bf16 v[160:163], a[84:87], v[188:191], v[160:163]
    v_mfma_f32_16x16x32_bf16 v[176:179], a[80:83], v[24:27], v[176:179]
    v_mfma_f32_16x16x32_bf16 v[176:179], a[84:87], v[208:211], v[176:179]
    ds_read_b128 a[244:247], v1 offset:61440
    s_waitcnt lgkmcnt(5)
    v_mfma_f32_16x16x32_bf16 v[236:239], v[68:71], v[48:51], v[236:239]
    ds_read_b128 a[216:219], v1 offset:62464
L_st3:
    s_cbranch_execz L_st6
    v_mfma_f32_16x16x32_bf16 v[236:239], a[200:203], v[224:227], v[236:239]
    v_mfma_f32_16x16x32_bf16 v[252:255], a[128:131], v[128:131], v[252:255]
    v_mfma_f32_16x16x32_bf16 v[252:255], a[132:135], v[120:123], v[252:255]
    v_mfma_f32_16x16x32_bf16 v[76:79], a[128:131], v[220:223], v[76:79]
    v_mfma_f32_16x16x32_bf16 v[76:79], a[132:135], v[188:191], v[76:79]
    v_mfma_f32_16x16x32_bf16 v[116:119], a[128:131], v[24:27], v[116:119]
    v_mfma_f32_16x16x32_bf16 v[116:119], a[132:135], v[208:211], v[116:119]
    ds_read_b128 a[200:203], v1 offset:63488
    s_waitcnt lgkmcnt(5)
    v_mfma_f32_16x16x32_bf16 v[196:199], v[88:91], a[16:19], v[196:199]
    ds_read_b128 a[228:231], v1 offset:64512
    v_mfma_f32_16x16x32_bf16 v[196:199], v[96:99], a[20:23], v[196:199]
    s_waitcnt vmcnt(18)
    s_barrier
    v_mfma_f32_16x16x32_bf16 v[60:63], v[88:91], a[64:67], v[60:63]
    s_add_u32 m0, s17, 24576
    v_mfma_f32_16x16x32_bf16 v[60:63], v[96:99], a[68:71], v[60:63]
    global_load_lds_dwordx4 v4, s[34:35] offset:-3072 sc1
    v_mfma_f32_16x16x32_bf16 v[108:111], v[88:91], a[112:115], v[108:111]
    v_mfma_f32_16x16x32_bf16 v[108:111], v[96:99], a[116:119], v[108:111]
    v_mfma_f32_16x16x32_bf16 v[232:235], v[88:91], a[160:163], v[232:235]
    v_mfma_f32_16x16x32_bf16 v[232:235], v[96:99], a[164:167], v[232:235]
    ds_read_b128 v[28:31], v2
    s_waitcnt lgkmcnt(5)
    v_mfma_f32_16x16x32_bf16 v[248:251], a[236:239], a[16:19], v[248:251]
    ds_read_b128 v[36:39], v2 offset:1024
    v_mfma_f32_16x16x32_bf16 v[248:251], a[240:243], a[20:23], v[248:251]
    global_load_lds_dwordx4 v4, s[34:35] offset:-2048 sc1
    v_mfma_f32_16x16x32_bf16 v[84:87], a[236:239], a[64:67], v[84:87]
    v_mfma_f32_16x16x32_bf16 v[84:87], a[240:243], a[68:71], v[84:87]
    v_mfma_f32_16x16x32_bf16 v[92:95], a[236:239], a[112:115], v[92:95]
    v_mfma_f32_16x16x32_bf16 v[92:95], a[240:243], a[116:119], v[92:95]
    v_mfma_f32_16x16x32_bf16 v[240:243], a[236:239], a[160:163], v[240:243]
    global_load_lds_dwordx4 v4, s[34:35] offset:-1024 sc1
    v_mfma_f32_16x16x32_bf16 v[240:243], a[240:243], a[164:167], v[240:243]
    ds_read_b128 v[72:75], v2 offset:2048
    s_waitcnt lgkmcnt(5)
    v_mfma_f32_16x16x32_bf16 v[196:199], a[244:247], a[24:27], v[196:199]
    ds_read_b128 v[80:83], v2 offset:3072
    v_mfma_f32_16x16x32_bf16 v[196:199], a[216:219], a[28:31], v[196:199]
    v_mfma_f32_16x16x32_bf16 v[60:63], a[244:247], a[72:75], v[60:63]
    v_mfma_f32_16x16x32_bf16 v[60:63], a[216:219], a[76:79], v[60:63]
    global_load_lds_dwordx4 v4, s[34:35] sc1
    v_mfma_f32_16x16x32_bf16 v[108:111], a[244:247], a[120:123], v[108:111]
    v_mfma_f32_16x16x32_bf16 v[108:111], a[216:219], a[124:127], v[108:111]
    v_mfma_f32_16x16x32_bf16 v[232:235], a[244:247], a[168:171], v[232:235]
    v_mfma_f32_16x16x32_bf16 v[232:235], a[216:219], a[172:175], v[232:235]
    s_waitcnt lgkmcnt(4)
    v_mfma_f32_16x16x32_bf16 v[248:251], a[200:203], a[24:27], v[248:251]
    v_mfma_f32_16x16x32_bf16 v[248:251], a[228:231], a[28:31], v[248:251]
    global_load_lds_dwordx4 v4, s[34:35] offset:1024 sc1
    v_mfma_f32_16x16x32_bf16 v[84:87], a[200:203], a[72:75], v[84:87]
    v_mfma_f32_16x16x32_bf16 v[84:87], a[228:231], a[76:79], v[84:87]
    ds_read_b128 a[236:239], v3 offset:24576
    v_mfma_f32_16x16x32_bf16 v[92:95], a[200:203], a[120:123], v[92:95]
    ds_read_b128 a[216:219], v3 offset:25600
    v_mfma_f32_16x16x32_bf16 v[92:95], a[228:231], a[124:127], v[92:95]
    v_mfma_f32_16x16x32_bf16 v[240:243], a[200:203], a[168:171], v[240:243]
    v_mfma_f32_16x16x32_bf16 v[240:243], a[228:231], a[172:175], v[240:243]
    ds_read_b128 a[240:243], v2 offset:4096
    s_waitcnt lgkmcnt(5)
    v_mfma_f32_16x16x32_bf16 v[196:199], v[28:31], a[32:35], v[196:199]
    ds_read_b128 a[244:247], v2 offset:5120
    v_mfma_f32_16x16x32_bf16 v[196:199], v[36:39], a[36:39], v[196:199]
    ds_read_b128 v[156:159], v2 offset:40960
    v_mfma_f32_16x16x32_bf16 v[60:63], v[28:31], a[80:83], v[60:63]
    ds_read_b128 a[200:203], v2 offset:41984
    v_mfma_f32_16x16x32_bf16 v[60:63], v[36:39], a[84:87], v[60:63]
    global_load_lds_dwordx4 v4, s[34:35] offset:2048 sc1
    v_mfma_f32_16x16x32_bf16 v[108:111], v[28:31], a[128:131], v[108:111]
    v_add_u32 v4, 24576, v4
    v_mfma_f32_16x16x32_bf16 v[108:111], v[36:39], a[132:135], v[108:111]
    v_mfma_f32_16x16x32_bf16 v[232:235], v[28:31], a[176:179], v[232:235]
    v_mfma_f32_16x16x32_bf16 v[232:235], v[36:39], a[180:183], v[232:235]
    ds_read_b128 a[228:231], v2 offset:6144
    s_waitcnt lgkmcnt(7)
    v_mfma_f32_16x16x32_bf16 v[248:251], v[72:75], a[32:35], v[248:251]
    ds_read_b128 v[168:171], v2 offset:7168
    v_mfma_f32_16x16x32_bf16 v[248:251], v[80:83], a[36:39], v[248:251]
    v_mfma_f32_16x16x32_bf16 v[84:87], v[72:75], a[80:83], v[84:87]
    v_mfma_f32_16x16x32_bf16 v[84:87], v[80:83], a[84:87], v[84:87]
    v_mfma_f32_16x16x32_bf16 v[92:95], v[72:75], a[128:131], v[92:95]
    v_mfma_f32_16x16x32_bf16 v[92:95], v[80:83], a[132:135], v[92:95]
    v_mfma_f32_16x16x32_bf16 v[240:243], v[72:75], a[176:179], v[240:243]
    v_mfma_f32_16x16x32_bf16 v[240:243], v[80:83], a[180:183], v[240:243]
    ds_read_b128 v[172:175], v2 offset:8192
    s_waitcnt lgkmcnt(3)
    v_mfma_f32_16x16x32_bf16 v[40:43], a[32:35], a[236:239], v[40:43]
    ds_read_b128 v[204:207], v2 offset:9216
    v_mfma_f32_16x16x32_bf16 v[40:43], a[36:39], a[216:219], v[40:43]
    v_mfma_f32_16x16x32_bf16 v[52:55], a[80:83], a[236:239], v[52:55]
    v_mfma_f32_16x16x32_bf16 v[52:55], a[84:87], a[216:219], v[52:55]
    v_mfma_f32_16x16x32_bf16 v[100:103], a[128:131], a[236:239], v[100:103]
    v_mfma_f32_16x16x32_bf16 v[100:103], a[132:135], a[216:219], v[100:103]
    v_mfma_f32_16x16x32_bf16 v[104:107], v[156:159], a[236:239], v[104:107]
    v_mfma_f32_16x16x32_bf16 v[104:107], a[200:203], a[216:219], v[104:107]
    ds_read_b128 v[140:143], v2 offset:10240
    v_mfma_f32_16x16x32_bf16 v[196:199], a[240:243], a[40:43], v[196:199]
    ds_read_b128 v[180:183], v2 offset:11264
    v_mfma_f32_16x16x32_bf16 v[196:199], a[244:247], a[44:47], v[196:199]
    v_mfma_f32_16x16x32_bf16 v[60:63], a[240:243], a[88:91], v[60:63]
    v_mfma_f32_16x16x32_bf16 v[60:63], a[244:247], a[92:95], v[60:63]
    v_mfma_f32_16x16x32_bf16 v[108:111], a[240:243], a[136:139], v[108:111]
    v_mfma_f32_16x16x32_bf16 v[108:111], a[244:247], a[140:143], v[108:111]
    v_mfma_f32_16x16x32_bf16 v[232:235], a[240:243], a[184:187], v[232:235]
    v_mfma_f32_16x16x32_bf16 v[232:235], a[244:247], a[188:191], v[232:235]
    ds_read_b128 a[200:203], v2 offset:12288
    s_waitcnt lgkmcnt(5)
    v_mfma_f32_16x16x32_bf16 v[248:251], a[228:231], a[40:43], v[248:251]
    ds_read_b128 a[216:219], v2 offset:13312
    v_cvt_pk_bf16_f32 v196, v196, v197
    v_mfma_f32_16x16x32_bf16 v[248:251], v[168:171], a[44:47], v[248:251]
    v_cvt_pk_bf16_f32 v197, v198, v199
    v_mfma_f32_16x16x32_bf16 v[84:87], a[228:231], a[88:91], v[84:87]
    v_cvt_pk_bf16_f32 v60, v60, v61
    v_cvt_pk_bf16_f32 v61, v62, v63
    v_mfma_f32_16x16x32_bf16 v[84:87], v[168:171], a[92:95], v[84:87]
    v_mfma_f32_16x16x32_bf16 v[92:95], a[228:231], a[136:139], v[92:95]
    v_cvt_pk_bf16_f32 v108, v108, v109
    v_cvt_pk_bf16_f32 v109, v110, v111
    v_mfma_f32_16x16x32_bf16 v[92:95], v[168:171], a[140:143], v[92:95]
    v_mfma_f32_16x16x32_bf16 v[240:243], a[228:231], a[184:187], v[240:243]
    v_cvt_pk_bf16_f32 v232, v232, v233
    v_cvt_pk_bf16_f32 v233, v234, v235
    v_mfma_f32_16x16x32_bf16 v[240:243], v[168:171], a[188:191], v[240:243]
    ds_read_b128 a[236:239], v2 offset:14336
    s_waitcnt lgkmcnt(5)
    v_mfma_f32_16x16x32_bf16 v[44:47], v[172:175], a[0:3], 0
    ds_read_b128 a[240:243], v2 offset:15360
    v_cvt_pk_bf16_f32 v198, v248, v249
    v_mfma_f32_16x16x32_bf16 v[44:47], v[204:207], a[4:7], v[44:47]
    v_cvt_pk_bf16_f32 v199, v250, v251
    v_mfma_f32_16x16x32_bf16 v[136:139], v[172:175], a[48:51], 0
    v_cvt_pk_bf16_f32 v62, v84, v85
    v_cvt_pk_bf16_f32 v63, v86, v87
    v_mfma_f32_16x16x32_bf16 v[136:139], v[204:207], a[52:55], v[136:139]
    v_mfma_f32_16x16x32_bf16 v[144:147], v[172:175], a[96:99], 0
    v_cvt_pk_bf16_f32 v110, v92, v93
    v_cvt_pk_bf16_f32 v111, v94, v95
    v_mfma_f32_16x16x32_bf16 v[144:147], v[204:207], a[100:103], v[144:147]
    v_mfma_f32_16x16x32_bf16 v[148:151], v[172:175], a[144:147], 0
    v_cvt_pk_bf16_f32 v234, v240, v241
    v_cvt_pk_bf16_f32 v235, v242, v243
    v_mfma_f32_16x16x32_bf16 v[148:151], v[204:207], a[148:151], v[148:151]
    s_waitcnt lgkmcnt(4)
    v_mfma_f32_16x16x32_bf16 v[184:187], v[140:143], a[0:3], 0
    ds_write_b128 v14, v[232:235] offset:10240
    v_mfma_f32_16x16x32_bf16 v[184:187], v[180:183], a[4:7], v[184:187]
    v_mfma_f32_16x16x32_bf16 v[192:195], v[140:143], a[48:51], 0
    v_mfma_f32_16x16x32_bf16 v[192:195], v[180:183], a[52:55], v[192:195]
    ds_read_b128 a[244:247], v2 offset:43008
    v_mfma_f32_16x16x32_bf16 v[200:203], v[140:143], a[96:99], 0
    v_mfma_f32_16x16x32_bf16 v[200:203], v[180:183], a[100:103], v[200:203]
    v_mfma_f32_16x16x32_bf16 v[24:27], v[140:143], a[144:147], 0
    v_mfma_f32_16x16x32_bf16 v[24:27], v[180:183], a[148:151], v[24:27]
    ds_read_b128 a[228:231], v2 offset:55296
    s_waitcnt lgkmcnt(5)
    v_mfma_f32_16x16x32_bf16 v[44:47], a[200:203], a[8:11], v[44:47]
    v_mfma_f32_16x16x32_bf16 v[44:47], a[216:219], a[12:15], v[44:47]
    v_mfma_f32_16x16x32_bf16 v[136:139], a[200:203], a[56:59], v[136:139]
    v_mfma_f32_16x16x32_bf16 v[136:139], a[216:219], a[60:63], v[136:139]
    ds_read_b128 v[48:51], v3 offset:2048
    v_mfma_f32_16x16x32_bf16 v[144:147], a[200:203], a[104:107], v[144:147]
    v_mfma_f32_16x16x32_bf16 v[144:147], a[216:219], a[108:111], v[144:147]
    v_mfma_f32_16x16x32_bf16 v[148:151], a[200:203], a[152:155], v[148:151]
    v_mfma_f32_16x16x32_bf16 v[148:151], a[216:219], a[156:159], v[148:151]
    ds_read_b128 v[56:59], v3 offset:14336
    s_waitcnt lgkmcnt(5)
    v_mfma_f32_16x16x32_bf16 v[184:187], a[236:239], a[8:11], v[184:187]
    ds_read_b128 v[68:71], v2 offset:16384
    ds_read_b128 v[88:91], v2 offset:17408
    v_mfma_f32_16x16x32_bf16 v[184:187], a[240:243], a[12:15], v[184:187]
    v_mfma_f32_16x16x32_bf16 v[192:195], a[236:239], a[56:59], v[192:195]
    v_mfma_f32_16x16x32_bf16 v[192:195], a[240:243], a[60:63], v[192:195]
    v_mfma_f32_16x16x32_bf16 v[200:203], a[236:239], a[104:107], v[200:203]
    v_mfma_f32_16x16x32_bf16 v[200:203], a[240:243], a[108:111], v[200:203]
    v_mfma_f32_16x16x32_bf16 v[24:27], a[236:239], a[152:155], v[24:27]
    v_mfma_f32_16x16x32_bf16 v[24:27], a[240:243], a[156:159], v[24:27]
    ds_read_b128 a[200:203], v2 offset:18432
    s_waitcnt lgkmcnt(6)
    v_mfma_f32_16x16x32_bf16 v[212:215], a[244:247], v[196:199], v[212:215]
    ds_read_b128 a[216:219], v2 offset:19456
    v_mfma_f32_16x16x32_bf16 v[216:219], a[244:247], v[60:63], v[216:219]
    v_mfma_f32_16x16x32_bf16 v[20:23], a[244:247], v[108:111], v[20:23]
    v_mfma_f32_16x16x32_bf16 v[32:35], a[244:247], v[232:235], v[32:35]
    s_waitcnt lgkmcnt(6)
    v_mfma_f32_16x16x32_bf16 v[64:67], a[228:231], v[232:235], v[64:67]
    v_mfma_f32_16x16x32_bf16 v[112:115], a[40:43], v[196:199], v[112:115]
    v_mfma_f32_16x16x32_bf16 v[132:135], a[40:43], v[60:63], v[132:135]
    v_mfma_f32_16x16x32_bf16 v[164:167], a[40:43], v[108:111], v[164:167]
    v_add_u32 v96, L_join - L_pc0 + 40960, v0
    s_waitcnt lgkmcnt(5)
    v_mfma_f32_16x16x32_bf16 v[228:231], v[48:51], v[232:235], v[228:231]
    ds_read_b128 a[236:239], v2 offset:20480
    v_min_u32 v96, L_end - L_pc0, v96
    v_mfma_f32_16x16x32_bf16 v[124:127], a[88:91], v[196:199], v[124:127]
    global_load_dword v97, v96, s[36:37]
    v_mfma_f32_16x16x32_bf16 v[160:163], a[88:91], v[60:63], v[160:163]
    ds_read_b128 a[228:231], v2 offset:21504
    v_mfma_f32_16x16x32_bf16 v[176:179], a[88:91], v[108:111], v[176:179]
    s_waitcnt lgkmcnt(6)
    v_mfma_f32_16x16x32_bf16 v[236:239], v[56:59], v[232:235], v[236:239]
    v_mfma_f32_16x16x32_bf16 v[252:255], a[136:139], v[196:199], v[252:255]
    v_mfma_f32_16x16x32_bf16 v[76:79], a[136:139], v[60:63], v[76:79]
    v_mfma_f32_16x16x32_bf16 v[116:119], a[136:139], v[108:111], v[116:119]
    s_waitcnt lgkmcnt(4)
    v_mfma_f32_16x16x32_bf16 v[44:47], v[68:71], a[16:19], v[44:47]
    s_waitcnt vmcnt(11)
    s_barrier
    v_mfma_f32_16x16x32_bf16 v[44:47], v[88:91], a[20:23], v[44:47]
    s_add_u32 m0, s17, 49152
    v_mfma_f32_16x16x32_bf16 v[136:139], v[68:71], a[64:67], v[136:139]
    global_load_lds_dwordx4 v4, s[34:35] offset:-3072 sc1
    v_mfma_f32_16x16x32_bf16 v[136:139], v[88:91], a[68:71], v[136:139]
    ds_read_b128 a[240:243], v3 offset:16384
    ds_read_b128 a[244:247], v2 offset:22528
    v_mfma_f32_16x16x32_bf16 v[144:147], v[68:71], a[112:115], v[144:147]
    ds_read_b128 v[120:123], v3 offset:17408
    ds_read_b128 v[128:131], v2 offset:23552
    v_mfma_f32_16x16x32_bf16 v[144:147], v[88:91], a[116:119], v[144:147]
    ds_read_b128 v[188:191], v3 offset:18432
    v_mfma_f32_16x16x32_bf16 v[148:151], v[68:71], a[160:163], v[148:151]
    ds_read_b128 v[208:211], v3 offset:19456
    v_mfma_f32_16x16x32_bf16 v[148:151], v[88:91], a[164:167], v[148:151]
    s_waitcnt lgkmcnt(8)
    v_mfma_f32_16x16x32_bf16 v[184:187], a[200:203], a[16:19], v[184:187]
    global_load_lds_dwordx4 v4, s[34:35] offset:-2048 sc1
    v_mfma_f32_16x16x32_bf16 v[184:187], a[216:219], a[20:23], v[184:187]
    v_mfma_f32_16x16x32_bf16 v[192:195], a[200:203], a[64:67], v[192:195]
    v_mfma_f32_16x16x32_bf16 v[192:195], a[216:219], a[68:71], v[192:195]
    ds_read_b128 v[220:223], v2 offset:24576
    ds_read_b128 v[224:227], v2 offset:25600
    v_mfma_f32_16x16x32_bf16 v[200:203], a[200:203], a[112:115], v[200:203]
    v_mfma_f32_16x16x32_bf16 v[200:203], a[216:219], a[116:119], v[200:203]
    global_load_lds_dwordx4 v4, s[34:35] offset:-1024 sc1
    v_mfma_f32_16x16x32_bf16 v[24:27], a[200:203], a[160:163], v[24:27]
    v_mfma_f32_16x16x32_bf16 v[24:27], a[216:219], a[164:167], v[24:27]
    s_waitcnt lgkmcnt(8)
    v_mfma_f32_16x16x32_bf16 v[44:47], a[236:239], a[24:27], v[44:47]
    v_mfma_f32_16x16x32_bf16 v[44:47], a[228:231], a[28:31], v[44:47]
    v_mfma_f32_16x16x32_bf16 v[136:139], a[236:239], a[72:75], v[136:139]
    v_mfma_f32_16x16x32_bf16 v[136:139], a[228:231], a[76:79], v[136:139]
    global_load_lds_dwordx4 v4, s[34:35] sc1
    v_mfma_f32_16x16x32_bf16 v[144:147], a[236:239], a[120:123], v[144:147]
    v_mfma_f32_16x16x32_bf16 v[144:147], a[228:231], a[124:127], v[144:147]
    v_mfma_f32_16x16x32_bf16 v[148:151], a[236:239], a[168:171], v[148:151]
    v_mfma_f32_16x16x32_bf16 v[148:151], a[228:231], a[172:175], v[148:151]
    ds_read_b128 a[200:203], v3 offset:20480
    s_waitcnt lgkmcnt(3)
    v_mfma_f32_16x16x32_bf16 v[28:31], a[204:207], a[240:243], 0
    ds_read_b128 a[216:219], v3 offset:21504
    ds_read_b128 v[36:39], v2 offset:26624
    v_mfma_f32_16x16x32_bf16 v[28:31], a[252:255], v[120:123], v[28:31]
    ds_read_b128 a[236:239], v3 offset:22528
    ds_read_b128 a[228:231], v2 offset:27648
    v_mfma_f32_16x16x32_bf16 v[28:31], a[224:227], v[188:191], v[28:31]
    ds_read_b128 a[204:207], v3 offset:23552
    v_mfma_f32_16x16x32_bf16 v[28:31], a[208:211], v[208:211], v[28:31]
    v_mfma_f32_16x16x32_bf16 v[184:187], a[244:247], a[24:27], v[184:187]
    global_load_lds_dwordx4 v4, s[34:35] offset:1024 sc1
    v_mfma_f32_16x16x32_bf16 v[184:187], v[128:131], a[28:31], v[184:187]
    v_mfma_f32_16x16x32_bf16 v[192:195], a[244:247], a[72:75], v[192:195]
    v_mfma_f32_16x16x32_bf16 v[192:195], v[128:131], a[76:79], v[192:195]
    v_mfma_f32_16x16x32_bf16 v[200:203], a[244:247], a[120:123], v[200:203]
    v_mfma_f32_16x16x32_bf16 v[200:203], v[128:131], a[124:127], v[200:203]
    global_load_lds_dwordx4 v4, s[34:35] offset:2048 sc1
    v_mfma_f32_16x16x32_bf16 v[24:27], a[244:247], a[168:171], v[24:27]
    v_add_u32 v4, 24576, v4
    v_mfma_f32_16x16x32_bf16 v[24:27], v[128:131], a[172:175], v[24:27]
    ds_read_b128 a[208:211], v3 offset:26624
    s_waitcnt lgkmcnt(7)
    v_mfma_f32_16x16x32_bf16 v[44:47], v[220:223], a[32:35], v[44:47]
    ds_read_b128 a[224:227], v2 offset:28672
    ds_read_b128 a[240:243], v2 offset:29696
    v_mfma_f32_16x16x32_bf16 v[44:47], v[224:227], a[36:39], v[44:47]
    v_mfma_f32_16x16x32_bf16 v[136:139], v[220:223], a[80:83], v[136:139]
    ds_read_b128 a[252:255], v2 offset:43008
    v_mfma_f32_16x16x32_bf16 v[136:139], v[224:227], a[84:87], v[136:139]
    v_mfma_f32_16x16x32_bf16 v[144:147], v[220:223], a[128:131], v[144:147]
    v_mfma_f32_16x16x32_bf16 v[144:147], v[224:227], a[132:135], v[144:147]
    v_mfma_f32_16x16x32_bf16 v[148:151], v[220:223], a[176:179], v[148:151]
    v_mfma_f32_16x16x32_bf16 v[148:151], v[224:227], a[180:183], v[148:151]
    ds_read_b128 a[244:247], v2 offset:30720
    s_waitcnt lgkmcnt(5)
    v_mfma_f32_16x16x32_bf16 v[28:31], v[152:155], a[200:203], v[28:31]
    ds_read_b128 v[72:75], v2 offset:31744
    v_mfma_f32_16x16x32_bf16 v[28:31], a[192:195], a[216:219], v[28:31]
    v_mfma_f32_16x16x32_bf16 v[28:31], a[212:215], a[236:239], v[28:31]
    v_mfma_f32_16x16x32_bf16 v[28:31], a[248:251], a[204:207], v[28:31]
    v_mfma_f32_16x16x32_bf16 v[184:187], v[36:39], a[32:35], v[184:187]
    v_mfma_f32_16x16x32_bf16 v[184:187], a[228:231], a[36:39], v[184:187]
    v_mfma_f32_16x16x32_bf16 v[192:195], v[36:39], a[80:83], v[192:195]
    v_mfma_f32_16x16x32_bf16 v[192:195], a[228:231], a[84:87], v[192:195]
    v_mfma_f32_16x16x32_bf16 v[200:203], v[36:39], a[128:131], v[200:203]
    v_mfma_f32_16x16x32_bf16 v[200:203], a[228:231], a[132:135], v[200:203]
    v_mfma_f32_16x16x32_bf16 v[24:27], v[36:39], a[176:179], v[24:27]
    ds_read_b128 a[192:195], v1
    ds_read_b128 a[200:203], v1 offset:1024
    v_mfma_f32_16x16x32_bf16 v[24:27], a[228:231], a[180:183], v[24:27]
    ds_read_b128 a[204:207], v3 offset:24576
    s_waitcnt lgkmcnt(5)
    v_mfma_f32_16x16x32_bf16 v[40:43], a[40:43], a[208:211], v[40:43]
    ds_read_b128 a[212:215], v3 offset:25600
    v_mfma_f32_16x16x32_bf16 v[52:55], a[88:91], a[208:211], v[52:55]
    ds_read_b128 a[216:219], v3 offset:26624
    v_mfma_f32_16x16x32_bf16 v[100:103], a[136:139], a[208:211], v[100:103]
    v_mfma_f32_16x16x32_bf16 v[104:107], a[252:255], a[208:211], v[104:107]
    v_mfma_f32_16x16x32_bf16 v[44:47], a[224:227], a[40:43], v[44:47]
    v_mfma_f32_16x16x32_bf16 v[44:47], a[240:243], a[44:47], v[44:47]
    v_mfma_f32_16x16x32_bf16 v[136:139], a[224:227], a[88:91], v[136:139]
    ds_read_b128 a[228:231], v1 offset:2048
    ds_read_b128 a[236:239], v1 offset:3072
    v_mfma_f32_16x16x32_bf16 v[136:139], a[240:243], a[92:95], v[136:139]
    v_mfma_f32_16x16x32_bf16 v[144:147], a[224:227], a[136:139], v[144:147]
    v_mfma_f32_16x16x32_bf16 v[144:147], a[240:243], a[140:143], v[144:147]
    v_mfma_f32_16x16x32_bf16 v[148:151], a[224:227], a[184:187], v[148:151]
    v_mfma_f32_16x16x32_bf16 v[148:151], a[240:243], a[188:191], v[148:151]
    s_waitcnt lgkmcnt(7)
    v_mfma_f32_16x16x32_bf16 v[184:187], a[244:247], a[40:43], v[184:187]
    v_cvt_pk_bf16_f32 v44, v44, v45
    v_cvt_pk_bf16_f32 v45, v46, v47
    v_mfma_f32_16x16x32_bf16 v[184:187], v[72:75], a[44:47], v[184:187]
    v_mfma_f32_16x16x32_bf16 v[192:195], a[244:247], a[88:91], v[192:195]
    v_cvt_pk_bf16_f32 v136, v136, v137
    v_cvt_pk_bf16_f32 v137, v138, v139
    v_mfma_f32_16x16x32_bf16 v[192:195], v[72:75], a[92:95], v[192:195]
    v_mfma_f32_16x16x32_bf16 v[200:203], a[244:247], a[136:139], v[200:203]
    v_cvt_pk_bf16_f32 v144, v144, v145
    v_cvt_pk_bf16_f32 v145, v146, v147
    v_mfma_f32_16x16x32_bf16 v[200:203], v[72:75], a[140:143], v[200:203]
    v_mfma_f32_16x16x32_bf16 v[24:27], a[244:247], a[184:187], v[24:27]
    ds_read_b128 a[208:211], v2 offset:44032
    v_cvt_pk_bf16_f32 v148, v148, v149
    v_mfma_f32_16x16x32_bf16 v[24:27], v[72:75], a[188:191], v[24:27]
    v_cvt_pk_bf16_f32 v149, v150, v151
    s_waitcnt vmcnt(14) lgkmcnt(3)
    v_mfma_f32_16x16x32_bf16 v[28:31], a[220:223], a[204:207], v[28:31]
    v_cvt_pk_bf16_f32 v46, v184, v185
    v_cvt_pk_bf16_f32 v47, v186, v187
    v_mfma_f32_16x16x32_bf16 v[28:31], a[196:199], a[212:215], v[28:31]
    v_mfma_f32_16x16x32_bf16 v[28:31], a[232:235], a[216:219], v[28:31]
    ds_read_b128 a[224:227], v2 offset:56320
    v_mfma_f32_16x16x32_bf16 v[80:83], a[0:3], a[192:195], 0
    v_cvt_pk_bf16_f32 v138, v192, v193
    v_cvt_pk_bf16_f32 v139, v194, v195
    v_mfma_f32_16x16x32_bf16 v[80:83], a[4:7], a[200:203], v[80:83]
    v_cvt_pk_bf16_f32 v146, v200, v201
    v_cvt_pk_bf16_f32 v147, v202, v203
    v_mfma_f32_16x16x32_bf16 v[156:159], a[48:51], a[192:195], 0
    v_mfma_f32_16x16x32_bf16 v[156:159], a[52:55], a[200:203], v[156:159]
    v_cvt_pk_bf16_f32 v150, v24, v25
    v_cvt_pk_bf16_f32 v151, v26, v27
    v_mfma_f32_16x16x32_bf16 v[84:87], a[96:99], a[192:195], 0
    ds_read_b128 a[240:243], v3 offset:3072
    v_mfma_f32_16x16x32_bf16 v[84:87], a[100:103], a[200:203], v[84:87]
    ds_write_b128 v14, v[148:151] offset:11264
    v_mfma_f32_16x16x32_bf16 v[92:95], a[144:147], a[192:195], 0
    v_mfma_f32_16x16x32_bf16 v[92:95], a[148:151], a[200:203], v[92:95]
    ds_read_b128 a[248:251], v3 offset:15360
    s_waitcnt lgkmcnt(5)
    v_mfma_f32_16x16x32_bf16 v[80:83], a[8:11], a[228:231], v[80:83]
    ds_read_b128 a[252:255], v1 offset:4096
    ds_read_b128 a[196:199], v1 offset:5120
    v_mfma_f32_16x16x32_bf16 v[80:83], a[12:15], a[236:239], v[80:83]
    v_mfma_f32_16x16x32_bf16 v[156:159], a[56:59], a[228:231], v[156:159]
    v_mfma_f32_16x16x32_bf16 v[156:159], a[60:63], a[236:239], v[156:159]
    v_mfma_f32_16x16x32_bf16 v[84:87], a[104:107], a[228:231], v[84:87]
    v_mfma_f32_16x16x32_bf16 v[84:87], a[108:111], a[236:239], v[84:87]
    v_mfma_f32_16x16x32_bf16 v[92:95], a[152:155], a[228:231], v[92:95]
    v_mfma_f32_16x16x32_bf16 v[92:95], a[156:159], a[236:239], v[92:95]
    ds_read_b128 a[192:195], v1 offset:6144
    s_waitcnt lgkmcnt(7)
    v_mfma_f32_16x16x32_bf16 v[212:215], a[208:211], v[44:47], v[212:215]
    ds_read_b128 a[200:203], v1 offset:7168
    v_mfma_f32_16x16x32_bf16 v[216:219], a[208:211], v[136:139], v[216:219]
    v_mfma_f32_16x16x32_bf16 v[20:23], a[208:211], v[144:147], v[20:23]
    v_mfma_f32_16x16x32_bf16 v[32:35], a[208:211], v[148:151], v[32:35]
    s_waitcnt lgkmcnt(7)
    v_mfma_f32_16x16x32_bf16 v[64:67], a[224:227], v[148:151], v[64:67]
    v_mfma_f32_16x16x32_bf16 v[112:115], a[44:47], v[44:47], v[112:115]
    v_mfma_f32_16x16x32_bf16 v[132:135], a[44:47], v[136:139], v[132:135]
    v_mfma_f32_16x16x32_bf16 v[164:167], a[44:47], v[144:147], v[164:167]
    ds_read_b128 a[204:207], v1 offset:8192
    s_waitcnt lgkmcnt(7)
    v_mfma_f32_16x16x32_bf16 v[228:231], a[240:243], v[148:151], v[228:231]
    ds_read_b128 a[208:211], v1 offset:9216
    v_cndmask_b32 v212, v15, v212, s[20:21]
    v_mfma_f32_16x16x32_bf16 v[124:127], a[92:95], v[44:47], v[124:127]
    v_cndmask_b32 v216, v15, v216, s[20:21]
    v_cndmask_b32 v20, v15, v20, s[20:21]
    v_mfma_f32_16x16x32_bf16 v[160:163], a[92:95], v[136:139], v[160:163]
    v_cndmask_b32 v33, v15, v33, s[22:23]
    v_mfma_f32_16x16x32_bf16 v[176:179], a[92:95], v[144:147], v[176:179]
    v_max3_f32 v98, v64, v65, v66
    s_waitcnt lgkmcnt(6)
    v_mfma_f32_16x16x32_bf16 v[236:239], a[248:251], v[148:151], v[236:239]
    v_max3_f32 v99, v112, v113, v114
    v_mfma_f32_16x16x32_bf16 v[252:255], a[140:143], v[44:47], v[252:255]
    v_max3_f32 v96, v132, v133, v134
    v_mfma_f32_16x16x32_bf16 v[76:79], a[140:143], v[136:139], v[76:79]
    v_max3_f32 v140, v164, v165, v166
    v_mfma_f32_16x16x32_bf16 v[116:119], a[140:143], v[144:147], v[116:119]
    ds_read_b128 a[212:215], v1 offset:10240
    s_waitcnt lgkmcnt(5)
    v_mfma_f32_16x16x32_bf16 v[80:83], a[16:19], a[252:255], v[80:83]
    ds_read_b128 a[216:219], v1 offset:11264
    v_max3_f32 v141, v115, v124, v125
    v_mfma_f32_16x16x32_bf16 v[80:83], a[20:23], a[196:199], v[80:83]
    s_waitcnt vmcnt(7)
    s_barrier
    v_mfma_f32_16x16x32_bf16 v[156:159], a[64:67], a[252:255], v[156:159]
    s_add_u32 m0, s17, 73728
    v_max3_f32 v99, v99, v126, v127
    v_mfma_f32_16x16x32_bf16 v[156:159], a[68:71], a[196:199], v[156:159]
    global_load_lds_dwordx4 v4, s[34:35] offset:-3072 sc1
    v_mfma_f32_16x16x32_bf16 v[84:87], a[112:115], a[252:255], v[84:87]
    v_max3_f32 v141, v141, v252, v253
    v_max3_f32 v99, v99, v254, v255
    v_mfma_f32_16x16x32_bf16 v[84:87], a[116:119], a[196:199], v[84:87]
    v_max3_f32 v99, v99, v141, v212
    v_mov_b32 v141, v99
    v_mfma_f32_16x16x32_bf16 v[92:95], a[160:163], a[252:255], v[92:95]
    s_nop 0
    v_permlane16_swap_b32 v99, v141
    v_max_f32 v99, v99, v141
    v_mfma_f32_16x16x32_bf16 v[92:95], a[164:167], a[196:199], v[92:95]
    v_mov_b32 v141, v99
    s_waitcnt lgkmcnt(4)
    v_mfma_f32_16x16x32_bf16 v[80:83], a[24:27], a[192:195], v[80:83]
    global_load_lds_dwordx4 v4, s[34:35] offset:-2048 sc1
    v_mfma_f32_16x16x32_bf16 v[80:83], a[28:31], a[200:203], v[80:83]
    v_permlane32_swap_b32 v99, v141
    v_max_f32 v99, v99, v141
    v_mfma_f32_16x16x32_bf16 v[156:159], a[72:75], a[192:195], v[156:159]
    v_mul_f32 v99, s19, v99
    v_fma_f32 v112, v112, s19, -v99
    v_mfma_f32_16x16x32_bf16 v[156:159], a[76:79], a[200:203], v[156:159]
    ds_read_b128 a[220:223], v3 offset:27648
    ds_read_b128 a[224:227], v1 offset:12288
    v_mfma_f32_16x16x32_bf16 v[84:87], a[120:123], a[192:195], v[84:87]
    ds_read_b128 a[228:231], v1 offset:13312
    v_fma_f32 v113, v113, s19, -v99
    v_mfma_f32_16x16x32_bf16 v[84:87], a[124:127], a[200:203], v[84:87]
    global_load_lds_dwordx4 v4, s[34:35] offset:-1024 sc1
    v_mfma_f32_16x16x32_bf16 v[92:95], a[168:171], a[192:195], v[92:95]
    ds_read_b128 a[232:235], v2 offset:44032
    v_fma_f32 v114, v114, s19, -v99
    v_mfma_f32_16x16x32_bf16 v[92:95], a[172:175], a[200:203], v[92:95]
    v_fma_f32 v115, v115, s19, -v99
    s_waitcnt lgkmcnt(6)
    v_mfma_f32_16x16x32_bf16 v[80:83], a[32:35], a[204:207], v[80:83]
    v_exp_f32 v112, v112
    v_mfma_f32_16x16x32_bf16 v[80:83], a[36:39], a[208:211], v[80:83]
    v_exp_f32 v113, v113
    v_mfma_f32_16x16x32_bf16 v[156:159], a[80:83], a[204:207], v[156:159]
    v_exp_f32 v114, v114
    v_mfma_f32_16x16x32_bf16 v[156:159], a[84:87], a[208:211], v[156:159]
    global_load_lds_dwordx4 v4, s[34:35] sc1
    v_mfma_f32_16x16x32_bf16 v[84:87], a[128:131], a[204:207], v[84:87]
    ds_read_b128 a[236:239], v1 offset:14336
    ds_read_b128 a[240:243], v1 offset:15360
    v_mfma_f32_16x16x32_bf16 v[84:87], a[132:135], a[208:211], v[84:87]
    v_exp_f32 v115, v115
    v_mfma_f32_16x16x32_bf16 v[92:95], a[176:179], a[204:207], v[92:95]
    v_fma_f32 v124, v124, s19, -v99
    v_fma_f32 v125, v125, s19, -v99
    v_mfma_f32_16x16x32_bf16 v[92:95], a[180:183], a[208:211], v[92:95]
    ds_read_b128 a[244:247], v3 offset:27648
    s_waitcnt lgkmcnt(7)
    v_mfma_f32_16x16x32_bf16 v[80:83], a[40:43], a[212:215], v[80:83]
    v_exp_f32 v124, v124
    v_mfma_f32_16x16x32_bf16 v[80:83], a[44:47], a[216:219], v[80:83]
    global_load_lds_dwordx4 v4, s[34:35] offset:1024 sc1
    v_mfma_f32_16x16x32_bf16 v[156:159], a[88:91], a[212:215], v[156:159]
    v_exp_f32 v125, v125
    v_mfma_f32_16x16x32_bf16 v[156:159], a[92:95], a[216:219], v[156:159]
    v_fma_f32 v126, v126, s19, -v99
    v_fma_f32 v127, v127, s19, -v99
    v_mfma_f32_16x16x32_bf16 v[84:87], a[136:139], a[212:215], v[84:87]
    ds_read_b128 a[248:251], v1 offset:16384
    ds_read_b128 a[192:195], v1 offset:17408
    v_mfma_f32_16x16x32_bf16 v[84:87], a[140:143], a[216:219], v[84:87]
    v_exp_f32 v126, v126
    v_mfma_f32_16x16x32_bf16 v[92:95], a[184:187], a[212:215], v[92:95]
    v_exp_f32 v127, v127
    v_mfma_f32_16x16x32_bf16 v[92:95], a[188:191], a[216:219], v[92:95]
    v_fma_f32 v252, v252, s19, -v99
    s_waitcnt lgkmcnt(5)
    v_mfma_f32_16x16x32_bf16 v[40:43], a[44:47], a[220:223], v[40:43]
    global_load_lds_dwordx4 v4, s[34:35] offset:2048 sc1
    v_mfma_f32_16x16x32_bf16 v[52:55], a[92:95], a[220:223], v[52:55]
    v_add_u32 v4, 24576, v4
    v_cvt_pk_bf16_f32 v168, v80, v81
    v_mfma_f32_16x16x32_bf16 v[100:103], a[140:143], a[220:223], v[100:103]
    v_cvt_pk_bf16_f32 v169, v82, v83
    v_cvt_pk_bf16_f32 v170, v156, v157
    v_mfma_f32_16x16x32_bf16 v[104:107], a[232:235], a[220:223], v[104:107]
    v_cvt_pk_bf16_f32 v171, v158, v159
    v_mfma_f32_16x16x32_bf16 v[172:175], a[0:3], a[224:227], 0
    ds_read_b128 a[196:199], v1 offset:18432
    ds_read_b128 a[200:203], v1 offset:19456
    v_mfma_f32_16x16x32_bf16 v[172:175], a[4:7], a[228:231], v[172:175]
    v_cvt_pk_bf16_f32 v180, v84, v85
    v_cvt_pk_bf16_f32 v181, v86, v87
    v_mfma_f32_16x16x32_bf16 v[204:207], a[48:51], a[224:227], 0
    v_cvt_pk_bf16_f32 v142, v92, v93
    v_cvt_pk_bf16_f32 v143, v94, v95
    v_mfma_f32_16x16x32_bf16 v[204:207], a[52:55], a[228:231], v[204:207]
    ds_write_b64 v13, v[142:143] offset:12288
    v_mfma_f32_16x16x32_bf16 v[240:243], a[96:99], a[224:227], 0
    v_exp_f32 v252, v252
    v_mfma_f32_16x16x32_bf16 v[240:243], a[100:103], a[228:231], v[240:243]
    v_fma_f32 v253, v253, s19, -v99
    v_fma_f32 v254, v254, s19, -v99
    v_mfma_f32_16x16x32_bf16 v[248:251], a[144:147], a[224:227], 0
    v_exp_f32 v253, v253
    v_mfma_f32_16x16x32_bf16 v[248:251], a[148:151], a[228:231], v[248:251]
    s_add_u32 m0, s66, 0
    s_waitcnt lgkmcnt(5)
    v_mfma_f32_16x16x32_bf16 v[28:31], v[244:247], a[244:247], v[28:31]
    ds_read_b128 a[204:207], v1 offset:20480
    v_mfma_f32_16x16x32_bf16 v[172:175], a[8:11], a[236:239], v[172:175]
    ds_read_b128 a[252:255], v1 offset:21504
    v_fma_f32 v255, v255, s19, -v99
    v_mfma_f32_16x16x32_bf16 v[172:175], a[12:15], a[240:243], v[172:175]
    buffer_load_dwordx4 v16, s[4:7], 0 offen lds
    v_mfma_f32_16x16x32_bf16 v[204:207], a[56:59], a[236:239], v[204:207]
    v_exp_f32 v254, v254
    v_mfma_f32_16x16x32_bf16 v[204:207], a[60:63], a[240:243], v[204:207]
    s_add_u32 m0, s66, 960
    v_fma_f32 v212, v212, s19, -v99
    v_mfma_f32_16x16x32_bf16 v[240:243], a[104:107], a[236:239], v[240:243]
    v_exp_f32 v255, v255
    v_mfma_f32_16x16x32_bf16 v[240:243], a[108:111], a[240:243], v[240:243]
    v_exp_f32 v212, v212
    v_mfma_f32_16x16x32_bf16 v[248:251], a[152:155], a[236:239], v[248:251]
    buffer_load_dwordx4 v16, s[4:7], 0 offen offset:64 lds
    v_mfma_f32_16x16x32_bf16 v[248:251], a[156:159], a[240:243], v[248:251]
    ds_read_b128 a[208:211], v1 offset:22528
    s_waitcnt lgkmcnt(6)
    v_mfma_f32_16x16x32_bf16 v[172:175], a[16:19], a[248:251], v[172:175]
    ds_read_b128 a[212:215], v1 offset:23552
    s_add_u32 m0, s66, 1920
    v_mfma_f32_16x16x32_bf16 v[172:175], a[20:23], a[192:195], v[172:175]
L_st4:
    s_cbranch_execz L_st7
    ds_write_b128 v19, v[28:31] offset:40960
    v_mfma_f32_16x16x32_bf16 v[204:207], a[64:67], a[248:251], v[204:207]
    v_add_f32 v99, v112, v113
    v_add_f32 v141, v114, v115
    v_mfma_f32_16x16x32_bf16 v[204:207], a[68:71], a[192:195], v[204:207]
    buffer_load_dwordx4 v16, s[4:7], 0 offen offset:128 lds
    v_mfma_f32_16x16x32_bf16 v[240:243], a[112:115], a[248:251], v[240:243]
    v_add_f32 v99, v99, v124
    v_add_f32 v141, v141, v125
    v_mfma_f32_16x16x32_bf16 v[240:243], a[116:119], a[192:195], v[240:243]
    s_add_u32 m0, s66, 2880
    v_add_f32 v99, v99, v126
    v_mfma_f32_16x16x32_bf16 v[248:251], a[160:163], a[248:251], v[248:251]
    v_add_f32 v141, v141, v127
    v_add_f32 v99, v99, v252
    v_mfma_f32_16x16x32_bf16 v[248:251], a[164:167], a[192:195], v[248:251]
    ds_read_b128 a[216:219], v1 offset:24576
    s_waitcnt lgkmcnt(7)
    v_mfma_f32_16x16x32_bf16 v[172:175], a[24:27], a[196:199], v[172:175]
    buffer_load_dwordx4 v16, s[4:7], 0 offen offset:192 lds
    v_mfma_f32_16x16x32_bf16 v[172:175], a[28:31], a[200:203], v[172:175]
    ds_read_b128 a[220:223], v1 offset:25600
    v_add_f32 v141, v141, v253
    v_mfma_f32_16x16x32_bf16 v[204:207], a[72:75], a[196:199], v[204:207]
    s_add_u32 m0, s66, 3840
    v_add_f32 v99, v99, v254
    v_mfma_f32_16x16x32_bf16 v[204:207], a[76:79], a[200:203], v[204:207]
    v_add_f32 v141, v141, v255
    v_add_f32 v99, v99, v212
    v_mfma_f32_16x16x32_bf16 v[240:243], a[120:123], a[196:199], v[240:243]
    v_add_f32 v99, v99, v141
    v_mov_b32 v141, v99
    v_mfma_f32_16x16x32_bf16 v[240:243], a[124:127], a[200:203], v[240:243]
    buffer_load_dwordx4 v16, s[4:7], 0 offen offset:256 lds
    v_mfma_f32_16x16x32_bf16 v[248:251], a[168:171], a[196:199], v[248:251]
    v_permlane16_swap_b32 v99, v141
    v_add_f32 v99, v99, v141
    v_mfma_f32_16x16x32_bf16 v[248:251], a[172:175], a[200:203], v[248:251]
    ds_read_b128 a[224:227], v1 offset:26624
    s_waitcnt lgkmcnt(6)
    v_mfma_f32_16x16x32_bf16 v[172:175], a[32:35], a[204:207], v[172:175]
    ds_read_b128 a[228:231], v1 offset:27648
    s_add_u32 m0, s66, 4800
    v_mfma_f32_16x16x32_bf16 v[172:175], a[36:39], a[252:255], v[172:175]
    v_mov_b32 v141, v99
    v_max3_f32 v142, v135, v160, v161
    v_mfma_f32_16x16x32_bf16 v[204:207], a[80:83], a[204:207], v[204:207]
    buffer_load_dwordx4 v16, s[4:7], 0 offen offset:320 lds
    v_mfma_f32_16x16x32_bf16 v[204:207], a[84:87], a[252:255], v[204:207]
    v_permlane32_swap_b32 v99, v141
    v_add_f32 v99, v99, v141
    v_mfma_f32_16x16x32_bf16 v[240:243], a[128:131], a[204:207], v[240:243]
    s_add_u32 m0, s66, 5760
    v_max3_f32 v96, v96, v162, v163
    v_mfma_f32_16x16x32_bf16 v[240:243], a[132:135], a[252:255], v[240:243]
    v_rcp_f32 v99, v99
    v_mfma_f32_16x16x32_bf16 v[248:251], a[176:179], a[204:207], v[248:251]
    v_mul_f32 v112, v112, v99
    v_mul_f32 v113, v113, v99
    v_mfma_f32_16x16x32_bf16 v[248:251], a[180:183], a[252:255], v[248:251]
    ds_read_b128 a[232:235], v1 offset:28672
    s_waitcnt lgkmcnt(6)
    v_mfma_f32_16x16x32_bf16 v[172:175], a[40:43], a[208:211], v[172:175]
    buffer_load_dwordx4 v16, s[4:7], 0 offen offset:384 lds
    v_mfma_f32_16x16x32_bf16 v[172:175], a[44:47], a[212:215], v[172:175]
    ds_read_b128 a[244:247], v1 offset:29696
    s_add_u32 m0, s66, 6720
    v_mfma_f32_16x16x32_bf16 v[204:207], a[88:91], a[208:211], v[204:207]
    v_mul_f32 v114, v114, v99
    v_mul_f32 v115, v115, v99
    v_mfma_f32_16x16x32_bf16 v[204:207], a[92:95], a[212:215], v[204:207]
    v_mul_f32 v124, v124, v99
    v_mul_f32 v125, v125, v99
    v_mfma_f32_16x16x32_bf16 v[240:243], a[136:139], a[208:211], v[240:243]
    v_mul_f32 v126, v126, v99
    v_mul_f32 v127, v127, v99
    v_mfma_f32_16x16x32_bf16 v[240:243], a[140:143], a[212:215], v[240:243]
    buffer_load_dwordx4 v16, s[4:7], 0 offen offset:448 lds
    v_mfma_f32_16x16x32_bf16 v[248:251], a[184:187], a[208:211], v[248:251]
    s_add_u32 m0, s66, 7680
    v_cvt_pk_bf16_f32 v48, v112, v113
    v_mfma_f32_16x16x32_bf16 v[248:251], a[188:191], a[212:215], v[248:251]
    ds_read_b128 a[192:195], v1 offset:30720
    s_waitcnt lgkmcnt(5)
    v_mfma_f32_16x16x32_bf16 v[56:59], a[0:3], a[216:219], 0
    ds_read_b128 a[196:199], v1 offset:31744
    v_cvt_pk_bf16_f32 v60, v172, v173
    v_mfma_f32_16x16x32_bf16 v[56:59], a[4:7], a[220:223], v[56:59]
    v_cvt_pk_bf16_f32 v61, v174, v175
    v_cvt_pk_bf16_f32 v49, v114, v115
    v_mfma_f32_16x16x32_bf16 v[68:71], a[48:51], a[216:219], 0
    buffer_load_dwordx4 v16, s[4:7], 0 offen offset:512 lds
    v_mfma_f32_16x16x32_bf16 v[68:71], a[52:55], a[220:223], v[68:71]
    s_add_u32 m0, s66, 8640
    v_cvt_pk_bf16_f32 v62, v204, v205
    v_mfma_f32_16x16x32_bf16 v[88:91], a[96:99], a[216:219], 0
    v_cvt_pk_bf16_f32 v63, v206, v207
    v_cvt_pk_bf16_f32 v108, v240, v241
    v_mfma_f32_16x16x32_bf16 v[88:91], a[100:103], a[220:223], v[88:91]
    v_cvt_pk_bf16_f32 v109, v242, v243
    v_cvt_pk_bf16_f32 v50, v124, v125
    v_mfma_f32_16x16x32_bf16 v[120:123], a[144:147], a[216:219], 0
    v_cvt_pk_bf16_f32 v188, v248, v249
    v_cvt_pk_bf16_f32 v189, v250, v251
    v_mfma_f32_16x16x32_bf16 v[120:123], a[148:151], a[220:223], v[120:123]
    ds_read_b128 a[200:203], v1 offset:32768
    s_waitcnt lgkmcnt(5)
    v_mfma_f32_16x16x32_bf16 v[56:59], a[8:11], a[224:227], v[56:59]
    buffer_load_dwordx4 v16, s[4:7], 0 offen offset:576 lds
    v_mfma_f32_16x16x32_bf16 v[56:59], a[12:15], a[228:231], v[56:59]
    ds_read_b128 a[236:239], v1 offset:33792
    s_add_u32 m0, s66, 9600
    v_mfma_f32_16x16x32_bf16 v[68:71], a[56:59], a[224:227], v[68:71]
    ds_write_b64 v13, v[188:189] offset:13312
    v_mfma_f32_16x16x32_bf16 v[68:71], a[60:63], a[228:231], v[68:71]
    v_cvt_pk_bf16_f32 v51, v126, v127
    v_mul_f32 v252, v252, v99
    v_mfma_f32_16x16x32_bf16 v[88:91], a[104:107], a[224:227], v[88:91]
    v_mul_f32 v253, v253, v99
    v_mul_f32 v254, v254, v99
    v_mfma_f32_16x16x32_bf16 v[88:91], a[108:111], a[228:231], v[88:91]
    buffer_load_dwordx4 v16, s[4:7], 0 offen offset:640 lds
    v_mfma_f32_16x16x32_bf16 v[120:123], a[152:155], a[224:227], v[120:123]
    s_add_u32 m0, s66, 10560
    v_mul_f32 v255, v255, v99
    v_mfma_f32_16x16x32_bf16 v[120:123], a[156:159], a[228:231], v[120:123]
    ds_read_b128 a[240:243], v1 offset:34816
    s_waitcnt lgkmcnt(6)
    v_mfma_f32_16x16x32_bf16 v[56:59], a[16:19], a[232:235], v[56:59]
    ds_read_b128 a[248:251], v1 offset:35840
    v_mul_f32 v212, v212, v99
    v_mfma_f32_16x16x32_bf16 v[56:59], a[20:23], a[244:247], v[56:59]
    v_cvt_pk_bf16_f32 v196, v252, v253
    v_cvt_pk_bf16_f32 v197, v254, v255
    v_mfma_f32_16x16x32_bf16 v[68:71], a[64:67], a[232:235], v[68:71]
    buffer_load_dwordx4 v16, s[4:7], 0 offen offset:704 lds
    v_mfma_f32_16x16x32_bf16 v[68:71], a[68:71], a[244:247], v[68:71]
    v_cvt_pk_bf16_f32 v198, v212, 0
    v_mov_b32 v199, 0
    v_mfma_f32_16x16x32_bf16 v[88:91], a[112:115], a[232:235], v[88:91]
    v_max3_f32 v142, v142, v76, v77
    v_max3_f32 v96, v96, v78, v79
    v_mfma_f32_16x16x32_bf16 v[88:91], a[116:119], a[244:247], v[88:91]
    v_max3_f32 v96, v96, v142, v216
    v_mov_b32 v142, v96
    v_mfma_f32_16x16x32_bf16 v[120:123], a[160:163], a[232:235], v[120:123]
    s_nop 0
    v_permlane16_swap_b32 v96, v142
    v_max_f32 v96, v96, v142
    v_mfma_f32_16x16x32_bf16 v[120:123], a[164:167], a[244:247], v[120:123]
    v_mov_b32 v142, v96
    s_waitcnt lgkmcnt(5)
    v_mfma_f32_16x16x32_bf16 v[56:59], a[24:27], a[192:195], v[56:59]
    s_waitcnt vmcnt(18) lgkmcnt(2)
    s_barrier
    v_mfma_f32_16x16x32_bf16 v[56:59], a[28:31], a[196:199], v[56:59]
    s_add_u32 m0, s17, 0
    v_permlane32_swap_b32 v96, v142
    v_mfma_f32_16x16x32_bf16 v[68:71], a[72:75], a[192:195], v[68:71]
    global_load_lds_dwordx4 v4, s[34:35] offset:-3072 sc1
    v_mfma_f32_16x16x32_bf16 v[68:71], a[76:79], a[196:199], v[68:71]
    ds_read_b128 a[204:207], v1 offset:36864
    ds_read_b128 a[208:211], v1 offset:37888
    v_mfma_f32_16x16x32_bf16 v[88:91], a[120:123], a[192:195], v[88:91]
    ds_read_b64 v[182:183], v3 offset:30728
    v_max_f32 v96, v96, v142
    v_mfma_f32_16x16x32_bf16 v[88:91], a[124:127], a[196:199], v[88:91]
    v_mul_f32 v96, s19, v96
    v_fma_f32 v132, v132, s19, -v96
    v_mfma_f32_16x16x32_bf16 v[120:123], a[168:171], a[192:195], v[120:123]
    ds_read_b64 v[110:111], v3 offset:31752
    v_fma_f32 v133, v133, s19, -v96
    v_mfma_f32_16x16x32_bf16 v[120:123], a[172:175], a[196:199], v[120:123]
    v_fma_f32 v134, v134, s19, -v96
    v_mfma_f32_16x16x32_bf16 v[56:59], a[32:35], a[200:203], v[56:59]
    global_load_lds_dwordx4 v4, s[34:35] offset:-2048 sc1
    v_mfma_f32_16x16x32_bf16 v[56:59], a[36:39], a[236:239], v[56:59]
    v_exp_f32 v132, v132
    v_mfma_f32_16x16x32_bf16 v[68:71], a[80:83], a[200:203], v[68:71]
    v_exp_f32 v133, v133
    v_mfma_f32_16x16x32_bf16 v[68:71], a[84:87], a[236:239], v[68:71]
    ds_read_b128 a[212:215], v1 offset:38912
    ds_read_b128 a[216:219], v1 offset:39936
    v_mfma_f32_16x16x32_bf16 v[88:91], a[128:131], a[200:203], v[88:91]
    v_exp_f32 v134, v134
    v_mfma_f32_16x16x32_bf16 v[88:91], a[132:135], a[236:239], v[88:91]
    global_load_lds_dwordx4 v4, s[34:35] offset:-1024 sc1
    v_mfma_f32_16x16x32_bf16 v[120:123], a[176:179], a[200:203], v[120:123]
    v_fma_f32 v135, v135, s19, -v96
    v_fma_f32 v160, v160, s19, -v96
    v_mfma_f32_16x16x32_bf16 v[120:123], a[180:183], a[236:239], v[120:123]
    v_fma_f32 v161, v161, s19, -v96
    s_waitcnt lgkmcnt(6)
    v_mfma_f32_16x16x32_bf16 v[56:59], a[40:43], a[240:243], v[56:59]
    v_exp_f32 v135, v135
    v_mfma_f32_16x16x32_bf16 v[56:59], a[44:47], a[248:251], v[56:59]
    v_exp_f32 v160, v160
    v_mfma_f32_16x16x32_bf16 v[68:71], a[88:91], a[240:243], v[68:71]
    v_exp_f32 v161, v161
    v_mfma_f32_16x16x32_bf16 v[68:71], a[92:95], a[248:251], v[68:71]
    ds_read_b128 a[220:223], v1 offset:40960
    ds_read_b128 a[252:255], v1 offset:41984
    v_mfma_f32_16x16x32_bf16 v[88:91], a[136:139], a[240:243], v[88:91]
    global_load_lds_dwordx4 v4, s[34:35] sc1
    v_mfma_f32_16x16x32_bf16 v[88:91], a[140:143], a[248:251], v[88:91]
    v_fma_f32 v162, v162, s19, -v96
    v_fma_f32 v163, v163, s19, -v96
    v_mfma_f32_16x16x32_bf16 v[120:123], a[184:187], a[240:243], v[120:123]
    v_exp_f32 v162, v162
    v_mfma_f32_16x16x32_bf16 v[120:123], a[188:191], a[248:251], v[120:123]
    v_fma_f32 v76, v76, s19, -v96
    s_waitcnt lgkmcnt(4)
    v_mfma_f32_16x16x32_bf16 v[208:211], v[168:171], v[48:51], 0
    v_cvt_pk_bf16_f32 v232, v56, v57
    v_cvt_pk_bf16_f32 v233, v58, v59
    v_mfma_f32_16x16x32_bf16 v[208:211], v[180:183], v[196:199], v[208:211]
    global_load_lds_dwordx4 v4, s[34:35] offset:1024 sc1
    v_mfma_f32_16x16x32_bf16 v[36:39], v[60:63], v[48:51], 0
    v_cvt_pk_bf16_f32 v234, v68, v69
    v_cvt_pk_bf16_f32 v235, v70, v71
    v_mfma_f32_16x16x32_bf16 v[36:39], v[108:111], v[196:199], v[36:39]
    ds_read_b128 a[192:195], v1 offset:43008
    v_mfma_f32_16x16x32_bf16 v[128:131], a[0:3], a[204:207], 0
    ds_read_b128 a[196:199], v1 offset:44032
    v_cvt_pk_bf16_f32 v152, v88, v89
    v_mfma_f32_16x16x32_bf16 v[128:131], a[4:7], a[208:211], v[128:131]
    v_cvt_pk_bf16_f32 v153, v90, v91
    v_fma_f32 v77, v77, s19, -v96
    v_mfma_f32_16x16x32_bf16 v[220:223], a[48:51], a[204:207], 0
    v_cvt_pk_bf16_f32 v142, v120, v121
    v_cvt_pk_bf16_f32 v143, v122, v123
    v_mfma_f32_16x16x32_bf16 v[220:223], a[52:55], a[208:211], v[220:223]
    ds_write_b64 v13, v[142:143]
    v_mfma_f32_16x16x32_bf16 v[224:227], a[96:99], a[204:207], 0
    v_cvt_pk_bf16_f32 v24, v208, v209
    v_cvt_pk_bf16_f32 v25, v210, v211
    v_mfma_f32_16x16x32_bf16 v[224:227], a[100:103], a[208:211], v[224:227]
    global_load_lds_dwordx4 v4, s[34:35] offset:2048 sc1
    v_mfma_f32_16x16x32_bf16 v[72:75], a[144:147], a[204:207], 0
    v_cvt_pk_bf16_f32 v26, v36, v37
    v_cvt_pk_bf16_f32 v27, v38, v39
    v_mfma_f32_16x16x32_bf16 v[72:75], a[148:151], a[208:211], v[72:75]
    ds_read_b128 a[200:203], v1 offset:45056
    s_waitcnt lgkmcnt(6)
    v_mfma_f32_16x16x32_bf16 v[128:131], a[8:11], a[212:215], v[128:131]
    ds_read_b128 a[224:227], v1 offset:46080
    v_add_u32 v4, 24576, v4
    v_mfma_f32_16x16x32_bf16 v[128:131], a[12:15], a[216:219], v[128:131]
    v_exp_f32 v163, v163
    v_mfma_f32_16x16x32_bf16 v[220:223], a[56:59], a[212:215], v[220:223]
    buffer_store_dwordx4 v[24:27], v6, s[8:11], 0 offen nt
    v_mfma_f32_16x16x32_bf16 v[220:223], a[60:63], a[216:219], v[220:223]
    v_exp_f32 v76, v76
    v_mfma_f32_16x16x32_bf16 v[224:227], a[104:107], a[212:215], v[224:227]
    v_exp_f32 v77, v77
    v_mfma_f32_16x16x32_bf16 v[224:227], a[108:111], a[216:219], v[224:227]
    v_fma_f32 v78, v78, s19, -v96
    v_fma_f32 v79, v79, s19, -v96
    v_mfma_f32_16x16x32_bf16 v[72:75], a[152:155], a[212:215], v[72:75]
    v_exp_f32 v78, v78
    v_mfma_f32_16x16x32_bf16 v[72:75], a[156:159], a[216:219], v[72:75]
    ds_read_b128 a[228:231], v1 offset:47104
    s_waitcnt lgkmcnt(6)
    v_mfma_f32_16x16x32_bf16 v[128:131], a[16:19], a[220:223], v[128:131]
    ds_read_b128 a[232:235], v1 offset:48128
    v_fma_f32 v216, v216, s19, -v96
    v_mfma_f32_16x16x32_bf16 v[128:131], a[20:23], a[252:255], v[128:131]
    v_exp_f32 v79, v79
    v_mfma_f32_16x16x32_bf16 v[220:223], a[64:67], a[220:223], v[220:223]
    v_exp_f32 v216, v216
    v_mfma_f32_16x16x32_bf16 v[220:223], a[68:71], a[252:255], v[220:223]
    v_add_f32 v99, v132, v133
    v_add_f32 v96, v134, v135
    v_mfma_f32_16x16x32_bf16 v[224:227], a[112:115], a[220:223], v[224:227]
    v_add_f32 v99, v99, v160
    v_add_f32 v96, v96, v161
    v_mfma_f32_16x16x32_bf16 v[224:227], a[116:119], a[252:255], v[224:227]
    v_add_f32 v99, v99, v162
    v_add_f32 v96, v96, v163
    v_mfma_f32_16x16x32_bf16 v[72:75], a[160:163], a[220:223], v[72:75]
    v_add_f32 v99, v99, v76
    v_add_f32 v96, v96, v77
    v_mfma_f32_16x16x32_bf16 v[72:75], a[164:167], a[252:255], v[72:75]
    ds_read_b128 a[244:247], v1 offset:49152
    s_waitcnt lgkmcnt(6)
    v_mfma_f32_16x16x32_bf16 v[128:131], a[24:27], a[192:195], v[128:131]
    ds_read_b128 a[204:207], v1 offset:50176
    v_add_f32 v99, v99, v78
    v_mfma_f32_16x16x32_bf16 v[128:131], a[28:31], a[196:199], v[128:131]
    v_add_f32 v96, v96, v79
    v_add_f32 v99, v99, v216
    v_mfma_f32_16x16x32_bf16 v[220:223], a[72:75], a[192:195], v[220:223]
    v_add_f32 v99, v99, v96
    v_mov_b32 v96, v99
    v_mfma_f32_16x16x32_bf16 v[220:223], a[76:79], a[196:199], v[220:223]
    s_nop 0
    v_permlane16_swap_b32 v99, v96
    v_add_f32 v99, v99, v96
    v_mfma_f32_16x16x32_bf16 v[224:227], a[120:123], a[192:195], v[224:227]
    v_mov_b32 v96, v99
    v_mov_b32 v151, 0
    v_mfma_f32_16x16x32_bf16 v[224:227], a[124:127], a[196:199], v[224:227]
    v_permlane32_swap_b32 v99, v96
    v_add_f32 v99, v99, v96
    v_mfma_f32_16x16x32_bf16 v[72:75], a[168:171], a[192:195], v[72:75]
    v_rcp_f32 v99, v99
    v_mfma_f32_16x16x32_bf16 v[72:75], a[172:175], a[196:199], v[72:75]
    v_mul_f32 v132, v132, v99
    s_waitcnt lgkmcnt(4)
    v_mfma_f32_16x16x32_bf16 v[128:131], a[32:35], a[200:203], v[128:131]
    v_mul_f32 v133, v133, v99
    v_mul_f32 v134, v134, v99
    v_mfma_f32_16x16x32_bf16 v[128:131], a[36:39], a[224:227], v[128:131]
    v_mul_f32 v135, v135, v99
    v_mul_f32 v160, v160, v99
    v_mfma_f32_16x16x32_bf16 v[220:223], a[80:83], a[200:203], v[220:223]
    v_mul_f32 v161, v161, v99
    v_mul_f32 v162, v162, v99
    v_mfma_f32_16x16x32_bf16 v[220:223], a[84:87], a[224:227], v[220:223]
    ds_read_b128 a[208:211], v1 offset:51200
    ds_read_b128 a[236:239], v1 offset:52224
    v_mfma_f32_16x16x32_bf16 v[224:227], a[128:131], a[200:203], v[224:227]
    v_mul_f32 v163, v163, v99
    v_cvt_pk_bf16_f32 v184, v132, v133
    v_mfma_f32_16x16x32_bf16 v[224:227], a[132:135], a[224:227], v[224:227]
    v_cvt_pk_bf16_f32 v185, v134, v135
    v_cvt_pk_bf16_f32 v186, v160, v161
    v_mfma_f32_16x16x32_bf16 v[72:75], a[176:179], a[200:203], v[72:75]
    v_cvt_pk_bf16_f32 v187, v162, v163
    v_mul_f32 v76, v76, v99
    v_mfma_f32_16x16x32_bf16 v[72:75], a[180:183], a[224:227], v[72:75]
    v_mul_f32 v77, v77, v99
    s_waitcnt lgkmcnt(4)
    v_mfma_f32_16x16x32_bf16 v[128:131], a[40:43], a[228:231], v[128:131]
    v_mul_f32 v78, v78, v99
    v_mul_f32 v79, v79, v99
    v_mfma_f32_16x16x32_bf16 v[128:131], a[44:47], a[232:235], v[128:131]
    v_mul_f32 v216, v216, v99
    v_cvt_pk_bf16_f32 v148, v76, v77
    v_mfma_f32_16x16x32_bf16 v[220:223], a[88:91], a[228:231], v[220:223]
    v_cvt_pk_bf16_f32 v149, v78, v79
    v_cvt_pk_bf16_f32 v150, v216, 0
    v_mfma_f32_16x16x32_bf16 v[220:223], a[92:95], a[232:235], v[220:223]
    ds_read_b128 a[240:243], v1 offset:53248
    ds_read_b128 a[248:251], v1 offset:54272
    v_mfma_f32_16x16x32_bf16 v[224:227], a[136:139], a[228:231], v[224:227]
    ds_read_b128 v[192:195], v3 offset:20480
    ds_read_b128 v[200:203], v3 offset:21504
    v_mfma_f32_16x16x32_bf16 v[224:227], a[140:143], a[232:235], v[224:227]
    ds_read_b128 v[44:47], v3 offset:22528
    v_cndmask_b32 v104, v15, v104, s[64:65]
    v_mfma_f32_16x16x32_bf16 v[72:75], a[184:187], a[228:231], v[72:75]
    v_cndmask_b32 v106, v15, v106, s[60:61]
    v_max3_f32 v96, v167, v176, v177
    v_mfma_f32_16x16x32_bf16 v[72:75], a[188:191], a[232:235], v[72:75]
    v_max3_f32 v140, v140, v178, v179
    s_waitcnt lgkmcnt(7)
    v_mfma_f32_16x16x32_bf16 v[136:139], a[0:3], a[244:247], 0
    v_cvt_pk_bf16_f32 v144, v128, v129
    v_cvt_pk_bf16_f32 v145, v130, v131
    v_mfma_f32_16x16x32_bf16 v[136:139], a[4:7], a[204:207], v[136:139]
    v_max3_f32 v96, v96, v116, v117
    v_max3_f32 v140, v140, v118, v119
    v_mfma_f32_16x16x32_bf16 v[80:83], a[48:51], a[244:247], 0
    v_cvt_pk_bf16_f32 v146, v220, v221
    v_cvt_pk_bf16_f32 v147, v222, v223
    v_mfma_f32_16x16x32_bf16 v[80:83], a[52:55], a[204:207], v[80:83]
    ds_read_b128 a[192:195], v1 offset:55296
    ds_read_b128 a[196:199], v1 offset:56320
    v_mfma_f32_16x16x32_bf16 v[84:87], a[96:99], a[244:247], 0
    v_cvt_pk_bf16_f32 v92, v224, v225
    v_cvt_pk_bf16_f32 v93, v226, v227
    v_mfma_f32_16x16x32_bf16 v[84:87], a[100:103], a[204:207], v[84:87]
    v_max3_f32 v140, v140, v96, v20
    v_mov_b32 v96, v140
    v_mfma_f32_16x16x32_bf16 v[156:159], a[144:147], a[244:247], 0
    v_cvt_pk_bf16_f32 v142, v72, v73
    v_cvt_pk_bf16_f32 v143, v74, v75
    v_mfma_f32_16x16x32_bf16 v[156:159], a[148:151], a[204:207], v[156:159]
    s_waitcnt lgkmcnt(4)
    v_cndmask_b32 v40, v192, v40, s[62:63]
    v_mfma_f32_16x16x32_bf16 v[244:247], v[168:171], v[184:187], 0
    ds_write_b64 v13, v[142:143] offset:1024
    v_mfma_f32_16x16x32_bf16 v[244:247], v[180:183], v[148:151], v[244:247]
    v_cndmask_b32 v41, v193, v41, s[62:63]
    v_cndmask_b32 v42, v194, v42, s[62:63]
    v_mfma_f32_16x16x32_bf16 v[28:31], v[60:63], v[184:187], 0
    v_cndmask_b32 v43, v195, v43, s[62:63]
    s_waitcnt lgkmcnt(4)
    v_cndmask_b32 v52, v200, v52, s[62:63]
    v_mfma_f32_16x16x32_bf16 v[28:31], v[108:111], v[148:151], v[28:31]
    ds_read_b128 a[212:215], v1 offset:57344
    v_mfma_f32_16x16x32_bf16 v[136:139], a[8:11], a[208:211], v[136:139]
    ds_read_b128 a[216:219], v1 offset:58368
    v_cndmask_b32 v53, v201, v53, s[62:63]
    v_mfma_f32_16x16x32_bf16 v[136:139], a[12:15], a[236:239], v[136:139]
    v_cndmask_b32 v54, v202, v54, s[62:63]
    v_cndmask_b32 v55, v203, v55, s[62:63]
    v_mfma_f32_16x16x32_bf16 v[80:83], a[56:59], a[208:211], v[80:83]
    s_waitcnt lgkmcnt(5)
    v_cndmask_b32 v100, v44, v100, s[62:63]
    v_cndmask_b32 v101, v45, v101, s[62:63]
    v_mfma_f32_16x16x32_bf16 v[80:83], a[60:63], a[236:239], v[80:83]
    v_cndmask_b32 v102, v46, v102, s[62:63]
    v_cndmask_b32 v103, v47, v103, s[62:63]
    v_mfma_f32_16x16x32_bf16 v[84:87], a[104:107], a[208:211], v[84:87]
    v_cvt_pk_bf16_f32 v112, v244, v245
    v_cvt_pk_bf16_f32 v113, v246, v247
    v_mfma_f32_16x16x32_bf16 v[84:87], a[108:111], a[236:239], v[84:87]
    v_max3_f32 v99, v40, v41, v42
    v_max3_f32 v141, v43, v52, v53
    v_mfma_f32_16x16x32_bf16 v[156:159], a[152:155], a[208:211], v[156:159]
    v_cvt_pk_bf16_f32 v114, v28, v29
    v_cvt_pk_bf16_f32 v115, v30, v31
    v_mfma_f32_16x16x32_bf16 v[156:159], a[156:159], a[236:239], v[156:159]
    ds_read_b128 a[220:223], v1 offset:59392
    v_mfma_f32_16x16x32_bf16 v[136:139], a[16:19], a[240:243], v[136:139]
    ds_read_b128 a[252:255], v1 offset:60416
    v_max3_f32 v99, v99, v54, v55
    v_mfma_f32_16x16x32_bf16 v[136:139], a[20:23], a[248:251], v[136:139]
    buffer_store_dwordx4 v[112:115], v7, s[8:11], 0 offen nt
    v_mfma_f32_16x16x32_bf16 v[80:83], a[64:67], a[240:243], v[80:83]
    v_max3_f32 v141, v141, v100, v101
    v_max3_f32 v99, v99, v102, v103
    v_mfma_f32_16x16x32_bf16 v[80:83], a[68:71], a[248:251], v[80:83]
    v_max_f32 v141, v141, v106
    v_max3_f32 v99, v99, v141, v104
    v_mfma_f32_16x16x32_bf16 v[84:87], a[112:115], a[240:243], v[84:87]
    v_mov_b32 v141, v99
    v_permlane16_swap_b32 v140, v96
    v_mfma_f32_16x16x32_bf16 v[84:87], a[116:119], a[248:251], v[84:87]
    v_permlane16_swap_b32 v99, v141
    v_max_f32 v99, v99, v141
    v_mfma_f32_16x16x32_bf16 v[156:159], a[160:163], a[240:243], v[156:159]
    v_mov_b32 v141, v99
    v_max_f32 v140, v140, v96
    v_mfma_f32_16x16x32_bf16 v[156:159], a[164:167], a[248:251], v[156:159]
    v_permlane32_swap_b32 v99, v141
    s_waitcnt lgkmcnt(5)
    v_mfma_f32_16x16x32_bf16 v[136:139], a[24:27], a[192:195], v[136:139]
    v_max_f32 v99, v99, v141
    v_mul_f32 v99, s19, v99
    v_mfma_f32_16x16x32_bf16 v[136:139], a[28:31], a[196:199], v[136:139]
    v_fma_f32 v40, v40, s19, -v99
    v_fma_f32 v41, v41, s19, -v99
    v_mfma_f32_16x16x32_bf16 v[80:83], a[72:75], a[192:195], v[80:83]
    v_exp_f32 v40, v40
    v_mfma_f32_16x16x32_bf16 v[80:83], a[76:79], a[196:199], v[80:83]
    ds_read_b128 a[200:203], v1 offset:61440
    ds_read_b128 a[204:207], v1 offset:62464
    v_mfma_f32_16x16x32_bf16 v[84:87], a[120:123], a[192:195], v[84:87]
    v_exp_f32 v41, v41
    v_mfma_f32_16x16x32_bf16 v[84:87], a[124:127], a[196:199], v[84:87]
    v_fma_f32 v42, v42, s19, -v99
    v_fma_f32 v43, v43, s19, -v99
    v_mfma_f32_16x16x32_bf16 v[156:159], a[168:171], a[192:195], v[156:159]
    v_exp_f32 v42, v42
    v_mfma_f32_16x16x32_bf16 v[156:159], a[172:175], a[196:199], v[156:159]
    v_fma_f32 v52, v52, s19, -v99
    s_waitcnt lgkmcnt(4)
    v_mfma_f32_16x16x32_bf16 v[136:139], a[32:35], a[212:215], v[136:139]
    s_waitcnt vmcnt(8)
    s_barrier
    v_mfma_f32_16x16x32_bf16 v[136:139], a[36:39], a[216:219], v[136:139]
    ds_read_b64 v[154:155], v3 offset:18440
    s_nop 0
    v_mfma_f32_16x16x32_bf16 v[80:83], a[80:83], a[212:215], v[80:83]
    ds_read_b64 v[94:95], v3 offset:19464
    s_add_u32 m0, s17, 24576
    v_mfma_f32_16x16x32_bf16 v[80:83], a[84:87], a[216:219], v[80:83]
    ds_read_b128 a[224:227], v1 offset:63488
    ds_read_b128 a[228:231], v1 offset:64512
    v_mfma_f32_16x16x32_bf16 v[84:87], a[128:131], a[212:215], v[84:87]
    global_load_lds_dwordx4 v4, s[34:35] offset:-3072 sc1
    v_mfma_f32_16x16x32_bf16 v[84:87], a[132:135], a[216:219], v[84:87]
    v_exp_f32 v43, v43
    v_mfma_f32_16x16x32_bf16 v[156:159], a[176:179], a[212:215], v[156:159]
    v_exp_f32 v52, v52
    v_mfma_f32_16x16x32_bf16 v[156:159], a[180:183], a[216:219], v[156:159]
    v_fma_f32 v53, v53, s19, -v99
    s_waitcnt lgkmcnt(6)
    v_mfma_f32_16x16x32_bf16 v[136:139], a[40:43], a[220:223], v[136:139]
    v_exp_f32 v53, v53
    v_mfma_f32_16x16x32_bf16 v[136:139], a[44:47], a[252:255], v[136:139]
    global_load_lds_dwordx4 v4, s[34:35] offset:-2048 sc1
    v_mfma_f32_16x16x32_bf16 v[80:83], a[88:91], a[220:223], v[80:83]
    v_fma_f32 v54, v54, s19, -v99
    v_fma_f32 v55, v55, s19, -v99
    v_mfma_f32_16x16x32_bf16 v[80:83], a[92:95], a[252:255], v[80:83]
    v_exp_f32 v54, v54
    v_mfma_f32_16x16x32_bf16 v[84:87], a[136:139], a[220:223], v[84:87]
    v_exp_f32 v55, v55
    v_mfma_f32_16x16x32_bf16 v[84:87], a[140:143], a[252:255], v[84:87]
    v_fma_f32 v100, v100, s19, -v99
    v_fma_f32 v101, v101, s19, -v99
    v_mfma_f32_16x16x32_bf16 v[156:159], a[184:187], a[220:223], v[156:159]
    global_load_lds_dwordx4 v4, s[34:35] offset:-1024 sc1
    v_mfma_f32_16x16x32_bf16 v[156:159], a[188:191], a[252:255], v[156:159]
    ds_read_b128 a[232:235], v2
    s_waitcnt lgkmcnt(3)
    v_mfma_f32_16x16x32_bf16 v[124:127], v[232:235], v[48:51], 0
    ds_read_b128 a[244:247], v2 offset:1024
    v_cvt_pk_bf16_f32 v172, v136, v137
    v_mfma_f32_16x16x32_bf16 v[124:127], v[152:155], v[196:199], v[124:127]
    v_cvt_pk_bf16_f32 v173, v138, v139
    v_fma_f32 v102, v102, s19, -v99
    v_mfma_f32_16x16x32_bf16 v[188:191], v[144:147], v[48:51], 0
    v_cvt_pk_bf16_f32 v174, v80, v81
    v_cvt_pk_bf16_f32 v175, v82, v83
    v_mfma_f32_16x16x32_bf16 v[188:191], v[92:95], v[196:199], v[188:191]
    v_fma_f32 v103, v103, s19, -v99
    v_mfma_f32_16x16x32_bf16 v[204:207], a[0:3], a[200:203], 0
    v_cvt_pk_bf16_f32 v240, v84, v85
    v_cvt_pk_bf16_f32 v241, v86, v87
    v_mfma_f32_16x16x32_bf16 v[204:207], a[4:7], a[204:207], v[204:207]
    global_load_lds_dwordx4 v4, s[34:35] sc1
    v_mfma_f32_16x16x32_bf16 v[248:251], a[48:51], a[200:203], 0
    v_cvt_pk_bf16_f32 v142, v156, v157
    v_cvt_pk_bf16_f32 v143, v158, v159
    v_mfma_f32_16x16x32_bf16 v[248:251], a[52:55], a[204:207], v[248:251]
    ds_read_b128 a[192:195], v2 offset:2048
    ds_read_b128 a[196:199], v2 offset:3072
    v_mfma_f32_16x16x32_bf16 v[212:215], a[96:99], a[200:203], 0
    ds_write_b64 v13, v[142:143] offset:4096
    v_mfma_f32_16x16x32_bf16 v[212:215], a[100:103], a[204:207], v[212:215]
    v_cvt_pk_bf16_f32 v252, v124, v125
    v_cvt_pk_bf16_f32 v253, v126, v127
    v_mfma_f32_16x16x32_bf16 v[24:27], a[144:147], a[200:203], 0
    v_cvt_pk_bf16_f32 v254, v188, v189
    v_cvt_pk_bf16_f32 v255, v190, v191
    v_mfma_f32_16x16x32_bf16 v[24:27], a[148:151], a[204:207], v[24:27]
    v_fma_f32 v104, v104, s19, -v99
    s_waitcnt lgkmcnt(5)
    v_mfma_f32_16x16x32_bf16 v[204:207], a[8:11], a[224:227], v[204:207]
    buffer_store_dwordx4 v[252:255], v6, s[8:11], 0 offen offset:64 nt
    v_mfma_f32_16x16x32_bf16 v[204:207], a[12:15], a[228:231], v[204:207]
    v_exp_f32 v100, v100
    v_mfma_f32_16x16x32_bf16 v[248:251], a[56:59], a[224:227], v[248:251]
    v_exp_f32 v101, v101
    v_mfma_f32_16x16x32_bf16 v[248:251], a[60:63], a[228:231], v[248:251]
    ds_read_b128 a[208:211], v2 offset:4096
    ds_read_b128 a[236:239], v2 offset:5120
    v_mfma_f32_16x16x32_bf16 v[212:215], a[104:107], a[224:227], v[212:215]
    v_exp_f32 v102, v102
    v_mfma_f32_16x16x32_bf16 v[212:215], a[108:111], a[228:231], v[212:215]
    v_exp_f32 v103, v103
    v_mfma_f32_16x16x32_bf16 v[24:27], a[152:155], a[224:227], v[24:27]
    v_exp_f32 v104, v104
    v_mfma_f32_16x16x32_bf16 v[24:27], a[156:159], a[228:231], v[24:27]
    v_fma_f32 v106, v106, s19, -v99
    v_mfma_f32_16x16x32_bf16 v[36:39], v[232:235], v[184:187], 0
    v_exp_f32 v106, v106
    v_mfma_f32_16x16x32_bf16 v[36:39], v[152:155], v[148:151], v[36:39]
    global_load_lds_dwordx4 v4, s[34:35] offset:1024 sc1
    v_mfma_f32_16x16x32_bf16 v[56:59], v[144:147], v[184:187], 0
    v_add_f32 v97, v40, v41
    v_add_f32 v99, v42, v43
    v_mfma_f32_16x16x32_bf16 v[56:59], v[92:95], v[148:151], v[56:59]
    v_add_f32 v97, v97, v52
    s_waitcnt lgkmcnt(5)
    v_mfma_f32_16x16x32_bf16 v[204:207], a[16:19], a[232:235], v[204:207]
    v_add_f32 v99, v99, v53
    v_add_f32 v97, v97, v54
    v_mfma_f32_16x16x32_bf16 v[204:207], a[20:23], a[244:247], v[204:207]
    v_add_f32 v99, v99, v55
    v_add_f32 v97, v97, v100
    v_mfma_f32_16x16x32_bf16 v[248:251], a[64:67], a[232:235], v[248:251]
    v_add_f32 v99, v99, v101
    v_add_f32 v97, v97, v102
    v_mfma_f32_16x16x32_bf16 v[248:251], a[68:71], a[244:247], v[248:251]
    ds_read_b64_tr_b16 a[240:241], v18 offset:12288
    ds_read_b64_tr_b16 a[242:243], v18 offset:24576
    v_mfma_f32_16x16x32_bf16 v[212:215], a[112:115], a[232:235], v[212:215]
    v_add_f32 v99, v99, v103
    v_add_f32 v97, v97, v104
    v_mfma_f32_16x16x32_bf16 v[212:215], a[116:119], a[244:247], v[212:215]
    v_add_f32 v99, v99, v106
    v_add_f32 v97, v97, v99
    v_mfma_f32_16x16x32_bf16 v[24:27], a[160:163], a[232:235], v[24:27]
    ds_read_b64_tr_b16 a[248:249], v18 offset:36864
    v_mov_b32 v99, v97
    v_mfma_f32_16x16x32_bf16 v[24:27], a[164:167], a[244:247], v[24:27]
    ds_read_b64_tr_b16 a[250:251], v18
    s_waitcnt lgkmcnt(7)
    v_mfma_f32_16x16x32_bf16 v[204:207], a[24:27], a[192:195], v[204:207]
    v_permlane16_swap_b32 v97, v99
    v_add_f32 v97, v97, v99
    v_mfma_f32_16x16x32_bf16 v[204:207], a[28:31], a[196:199], v[204:207]
    ds_read_b64_tr_b16 a[212:213], v18 offset:12296
    v_mov_b32 v99, v97
    v_mfma_f32_16x16x32_bf16 v[248:251], a[72:75], a[192:195], v[248:251]
    ds_read_b64_tr_b16 a[214:215], v18 offset:24584
L_st5:
    s_cbranch_execz L_st8
    v_permlane32_swap_b32 v97, v99
    v_mfma_f32_16x16x32_bf16 v[248:251], a[76:79], a[196:199], v[248:251]
    ds_read_b64_tr_b16 a[216:217], v18 offset:36872
    v_add_f32 v97, v97, v99
    v_mfma_f32_16x16x32_bf16 v[212:215], a[120:123], a[192:195], v[212:215]
    v_rcp_f32 v97, v97
    v_mfma_f32_16x16x32_bf16 v[212:215], a[124:127], a[196:199], v[212:215]
    ds_read_b64_tr_b16 a[218:219], v18 offset:8
    v_cvt_pk_bf16_f32 v68, v36, v37
    v_mfma_f32_16x16x32_bf16 v[24:27], a[168:171], a[192:195], v[24:27]
    v_cvt_pk_bf16_f32 v69, v38, v39
    v_cvt_pk_bf16_f32 v70, v56, v57
    v_mfma_f32_16x16x32_bf16 v[24:27], a[172:175], a[196:199], v[24:27]
    v_cvt_pk_bf16_f32 v71, v58, v59
    s_waitcnt lgkmcnt(8)
    v_mfma_f32_16x16x32_bf16 v[204:207], a[32:35], a[208:211], v[204:207]
    ds_read_b128 a[220:223], v2 offset:6144
    v_mul_f32 v40, v40, v97
    v_mfma_f32_16x16x32_bf16 v[204:207], a[36:39], a[236:239], v[204:207]
    global_load_lds_dwordx4 v4, s[34:35] offset:2048 sc1
    v_mfma_f32_16x16x32_bf16 v[248:251], a[80:83], a[208:211], v[248:251]
    v_add_u32 v4, 24576, v4
    v_mul_f32 v41, v41, v97
    v_mfma_f32_16x16x32_bf16 v[248:251], a[84:87], a[236:239], v[248:251]
    v_mul_f32 v42, v42, v97
    v_mul_f32 v43, v43, v97
    v_mfma_f32_16x16x32_bf16 v[212:215], a[128:131], a[208:211], v[212:215]
    v_mul_f32 v52, v52, v97
    v_mul_f32 v53, v53, v97
    v_mfma_f32_16x16x32_bf16 v[212:215], a[132:135], a[236:239], v[212:215]
    v_mul_f32 v54, v54, v97
    v_mul_f32 v55, v55, v97
    v_cvt_pk_bf16_f32 v88, v40, v41
    v_cvt_pk_bf16_f32 v89, v42, v43
    v_cvt_pk_bf16_f32 v90, v52, v53
    v_cvt_pk_bf16_f32 v91, v54, v55
    v_mfma_f32_16x16x32_bf16 v[24:27], a[176:179], a[208:211], v[24:27]
    ds_read_b128 a[252:255], v2 offset:7168
    v_mul_f32 v100, v100, v97
    v_mul_f32 v101, v101, v97
    v_mul_f32 v102, v102, v97
    v_mul_f32 v103, v103, v97
    v_mul_f32 v104, v104, v97
    v_mul_f32 v106, v106, v97
    v_cvt_pk_bf16_f32 v120, v100, v101
    v_cvt_pk_bf16_f32 v121, v102, v103
    v_cvt_pk_bf16_f32 v122, v104, 0
    v_cvt_pk_bf16_f32 v123, v106, 0
    v_mfma_f32_16x16x32_bf16 v[24:27], a[180:183], a[236:239], v[24:27]
    ds_read_b128 a[200:203], v2 offset:8192
    v_mfma_f32_16x16x32_bf16 v[208:211], v[168:171], v[88:91], 0
    ds_read_b128 a[204:207], v2 offset:9216
    v_mov_b32 v96, v140
    v_mfma_f32_16x16x32_bf16 v[208:211], v[180:183], v[120:123], v[208:211]
    buffer_store_dwordx4 v[68:71], v7, s[8:11], 0 offen offset:64 nt
    v_mfma_f32_16x16x32_bf16 v[72:75], v[60:63], v[88:91], 0
    v_permlane32_swap_b32 v140, v96
    v_max_f32 v140, v140, v96
    v_mfma_f32_16x16x32_bf16 v[72:75], v[108:111], v[120:123], v[72:75]
    ds_read_b64_tr_b16 a[224:225], v18 offset:13312
    s_waitcnt lgkmcnt(5)
    v_mfma_f32_16x16x32_bf16 v[76:79], a[240:243], v[88:91], 0
    ds_read_b64_tr_b16 a[226:227], v18 offset:25600
    ds_read_b64_tr_b16 a[228:229], v18 offset:37888
    v_mfma_f32_16x16x32_bf16 v[76:79], a[248:251], v[120:123], v[76:79]
    ds_read_b64_tr_b16 a[230:231], v18 offset:1024
    ds_read_b64_tr_b16 a[232:233], v18 offset:13320
    v_mfma_f32_16x16x32_bf16 v[128:131], a[212:215], v[88:91], 0
    ds_read_b64_tr_b16 a[234:235], v18 offset:25608
    ds_read_b64_tr_b16 a[244:245], v18 offset:37896
    v_mfma_f32_16x16x32_bf16 v[128:131], a[216:219], v[120:123], v[128:131]
    ds_read_b64_tr_b16 a[246:247], v18 offset:1032
    s_waitcnt lgkmcnt(10)
    v_mfma_f32_16x16x32_bf16 v[204:207], a[40:43], a[220:223], v[204:207]
    ds_read_b128 a[192:195], v2 offset:10240
    ds_read_b128 a[196:199], v2 offset:11264
    v_mfma_f32_16x16x32_bf16 v[204:207], a[44:47], a[252:255], v[204:207]
    v_cvt_pk_bf16_f32 v132, v208, v209
    v_cvt_pk_bf16_f32 v133, v210, v211
    v_mfma_f32_16x16x32_bf16 v[248:251], a[88:91], a[220:223], v[248:251]
    v_cvt_pk_bf16_f32 v134, v72, v73
    v_cvt_pk_bf16_f32 v135, v74, v75
    v_mfma_f32_16x16x32_bf16 v[248:251], a[92:95], a[252:255], v[248:251]
    buffer_store_dwordx4 v[132:135], v10, s[8:11], 0 offen nt
    v_mfma_f32_16x16x32_bf16 v[212:215], a[136:139], a[220:223], v[212:215]
    v_cvt_pk_bf16_f32 v160, v76, v77
    v_cvt_pk_bf16_f32 v161, v78, v79
    v_mfma_f32_16x16x32_bf16 v[212:215], a[140:143], a[252:255], v[212:215]
    v_mul_f32 v140, s19, v140
    v_fma_f32 v164, v164, s19, -v140
    v_mfma_f32_16x16x32_bf16 v[24:27], a[184:187], a[220:223], v[24:27]
    v_cvt_pk_bf16_f32 v162, v128, v129
    v_cvt_pk_bf16_f32 v163, v130, v131
    v_mfma_f32_16x16x32_bf16 v[24:27], a[188:191], a[252:255], v[24:27]
    ds_read_b128 a[208:211], v2 offset:12288
    s_waitcnt lgkmcnt(11)
    v_mfma_f32_16x16x32_bf16 v[192:195], a[0:3], a[200:203], 0
    ds_read_b128 a[212:215], v2 offset:13312
    v_cvt_pk_bf16_f32 v216, v204, v205
    v_mfma_f32_16x16x32_bf16 v[192:195], a[4:7], a[204:207], v[192:195]
    v_cvt_pk_bf16_f32 v217, v206, v207
    v_fma_f32 v165, v165, s19, -v140
    v_mfma_f32_16x16x32_bf16 v[220:223], a[48:51], a[200:203], 0
    v_cvt_pk_bf16_f32 v218, v248, v249
    v_cvt_pk_bf16_f32 v219, v250, v251
    v_mfma_f32_16x16x32_bf16 v[220:223], a[52:55], a[204:207], v[220:223]
    v_exp_f32 v164, v164
    v_mfma_f32_16x16x32_bf16 v[224:227], a[96:99], a[200:203], 0
    v_cvt_pk_bf16_f32 v28, v212, v213
    v_cvt_pk_bf16_f32 v29, v214, v215
    v_mfma_f32_16x16x32_bf16 v[224:227], a[100:103], a[204:207], v[224:227]
    v_exp_f32 v165, v165
    v_mfma_f32_16x16x32_bf16 v[44:47], a[144:147], a[200:203], 0
    v_cvt_pk_bf16_f32 v142, v24, v25
    v_cvt_pk_bf16_f32 v143, v26, v27
    v_mfma_f32_16x16x32_bf16 v[44:47], a[148:151], a[204:207], v[44:47]
    ds_read_b64_tr_b16 a[236:237], v18 offset:14336
    v_mfma_f32_16x16x32_bf16 v[112:115], v[232:235], v[88:91], 0
    ds_read_b64_tr_b16 a[238:239], v18 offset:26624
    ds_read_b64_tr_b16 a[240:241], v18 offset:38912
    v_mfma_f32_16x16x32_bf16 v[112:115], v[152:155], v[120:123], v[112:115]
    ds_write_b64 v13, v[142:143] offset:5120
    v_mfma_f32_16x16x32_bf16 v[200:203], v[144:147], v[88:91], 0
    ds_read_b64_tr_b16 a[242:243], v18 offset:2048
    ds_read_b64_tr_b16 a[248:249], v18 offset:14344
    v_mfma_f32_16x16x32_bf16 v[200:203], v[92:95], v[120:123], v[200:203]
    ds_read_b64_tr_b16 a[250:251], v18 offset:26632
    s_waitcnt lgkmcnt(11)
    v_mfma_f32_16x16x32_bf16 v[244:247], a[224:227], v[88:91], 0
    ds_read_b64_tr_b16 a[200:201], v18 offset:38920
    ds_read_b64_tr_b16 a[202:203], v18 offset:2056
    v_mfma_f32_16x16x32_bf16 v[244:247], a[228:231], v[120:123], v[244:247]
    ds_read_b128 a[204:207], v2 offset:14336
    ds_read_b128 a[216:219], v2 offset:15360
    v_mfma_f32_16x16x32_bf16 v[80:83], a[232:235], v[88:91], 0
    v_fma_f32 v166, v166, s19, -v140
    v_fma_f32 v167, v167, s19, -v140
    v_mfma_f32_16x16x32_bf16 v[80:83], a[244:247], v[120:123], v[80:83]
    v_fma_f32 v176, v176, s19, -v140
    s_waitcnt lgkmcnt(13)
    v_mfma_f32_16x16x32_bf16 v[192:195], a[8:11], a[192:195], v[192:195]
    v_cvt_pk_bf16_f32 v84, v112, v113
    v_cvt_pk_bf16_f32 v85, v114, v115
    v_mfma_f32_16x16x32_bf16 v[192:195], a[12:15], a[196:199], v[192:195]
    v_exp_f32 v166, v166
    v_mfma_f32_16x16x32_bf16 v[220:223], a[56:59], a[192:195], v[220:223]
    v_cvt_pk_bf16_f32 v86, v200, v201
    v_cvt_pk_bf16_f32 v87, v202, v203
    v_mfma_f32_16x16x32_bf16 v[220:223], a[60:63], a[196:199], v[220:223]
    ds_read_b128 a[220:223], v2 offset:16384
    ds_read_b128 a[224:227], v2 offset:17408
    v_mfma_f32_16x16x32_bf16 v[224:227], a[104:107], a[192:195], v[224:227]
    v_cvt_pk_bf16_f32 v124, v244, v245
    v_cvt_pk_bf16_f32 v125, v246, v247
    v_mfma_f32_16x16x32_bf16 v[224:227], a[108:111], a[196:199], v[224:227]
    buffer_store_dwordx4 v[84:87], v10, s[8:11], 0 offen offset:64 nt
    v_mfma_f32_16x16x32_bf16 v[44:47], a[152:155], a[192:195], v[44:47]
    v_cvt_pk_bf16_f32 v126, v80, v81
    v_cvt_pk_bf16_f32 v127, v82, v83
    v_mfma_f32_16x16x32_bf16 v[44:47], a[156:159], a[196:199], v[44:47]
    v_fma_f32 v177, v177, s19, -v140
    s_waitcnt lgkmcnt(13)
    v_mfma_f32_16x16x32_bf16 v[192:195], a[16:19], a[208:211], v[192:195]
    v_exp_f32 v167, v167
    v_mfma_f32_16x16x32_bf16 v[192:195], a[20:23], a[212:215], v[192:195]
    v_exp_f32 v176, v176
    v_mfma_f32_16x16x32_bf16 v[220:223], a[64:67], a[208:211], v[220:223]
    v_exp_f32 v177, v177
    v_mfma_f32_16x16x32_bf16 v[220:223], a[68:71], a[212:215], v[220:223]
    ds_read_b128 a[228:231], v2 offset:18432
    ds_read_b128 a[232:235], v2 offset:19456
    v_mfma_f32_16x16x32_bf16 v[224:227], a[112:115], a[208:211], v[224:227]
    v_fma_f32 v178, v178, s19, -v140
    v_fma_f32 v179, v179, s19, -v140
    v_mfma_f32_16x16x32_bf16 v[224:227], a[116:119], a[212:215], v[224:227]
    v_exp_f32 v178, v178
    v_mfma_f32_16x16x32_bf16 v[44:47], a[160:163], a[208:211], v[44:47]
    v_exp_f32 v179, v179
    v_mfma_f32_16x16x32_bf16 v[44:47], a[164:167], a[212:215], v[44:47]
    v_fma_f32 v116, v116, s19, -v140
    s_waitcnt lgkmcnt(6)
    v_mfma_f32_16x16x32_bf16 v[136:139], a[236:239], v[88:91], 0
    v_exp_f32 v116, v116
    v_mfma_f32_16x16x32_bf16 v[136:139], a[240:243], v[120:123], v[136:139]
    v_fma_f32 v117, v117, s19, -v140
    v_fma_f32 v118, v118, s19, -v140
    v_mfma_f32_16x16x32_bf16 v[156:159], a[248:251], v[88:91], 0
    v_exp_f32 v117, v117
    v_mfma_f32_16x16x32_bf16 v[156:159], a[200:203], v[120:123], v[156:159]
    v_fma_f32 v119, v119, s19, -v140
    s_waitcnt lgkmcnt(4)
    v_mfma_f32_16x16x32_bf16 v[192:195], a[24:27], a[204:207], v[192:195]
    v_exp_f32 v118, v118
    v_mfma_f32_16x16x32_bf16 v[192:195], a[28:31], a[216:219], v[192:195]
    v_exp_f32 v119, v119
    v_mfma_f32_16x16x32_bf16 v[220:223], a[72:75], a[204:207], v[220:223]
    v_fma_f32 v20, v20, s19, -v140
    v_add_f32 v141, v164, v165
    v_mfma_f32_16x16x32_bf16 v[220:223], a[76:79], a[216:219], v[220:223]
    ds_read_b128 a[252:255], v2 offset:20480
    ds_read_b128 a[192:195], v2 offset:21504
    v_mfma_f32_16x16x32_bf16 v[224:227], a[120:123], a[204:207], v[224:227]
    v_cvt_pk_bf16_f32 v188, v136, v137
    v_cvt_pk_bf16_f32 v189, v138, v139
    v_mfma_f32_16x16x32_bf16 v[224:227], a[124:127], a[216:219], v[224:227]
    v_exp_f32 v20, v20
    v_mfma_f32_16x16x32_bf16 v[44:47], a[168:171], a[204:207], v[44:47]
    v_cvt_pk_bf16_f32 v190, v156, v157
    v_cvt_pk_bf16_f32 v191, v158, v159
    v_mfma_f32_16x16x32_bf16 v[44:47], a[172:175], a[216:219], v[44:47]
    v_add_f32 v96, v166, v167
    s_waitcnt lgkmcnt(4)
    v_mfma_f32_16x16x32_bf16 v[192:195], a[32:35], a[220:223], v[192:195]
    s_waitcnt vmcnt(12)
    s_barrier
    v_mfma_f32_16x16x32_bf16 v[192:195], a[36:39], a[224:227], v[192:195]
    ds_read_b64 v[242:243], v3 offset:22536
    ds_read_b64 v[30:31], v3 offset:23560
    v_mfma_f32_16x16x32_bf16 v[220:223], a[80:83], a[220:223], v[220:223]
    s_add_u32 m0, s17, 49152
    v_add_f32 v141, v141, v176
    v_mfma_f32_16x16x32_bf16 v[220:223], a[84:87], a[224:227], v[220:223]
    global_load_lds_dwordx4 v4, s[34:35] offset:-3072 sc1
    v_mfma_f32_16x16x32_bf16 v[224:227], a[128:131], a[220:223], v[224:227]
    v_add_f32 v96, v96, v177
    v_add_f32 v141, v141, v178
    v_mfma_f32_16x16x32_bf16 v[224:227], a[132:135], a[224:227], v[224:227]
    v_add_f32 v96, v96, v179
    v_add_f32 v141, v141, v116
    v_mfma_f32_16x16x32_bf16 v[44:47], a[176:179], a[220:223], v[44:47]
    v_add_f32 v96, v96, v117
    v_add_f32 v141, v141, v118
    v_mfma_f32_16x16x32_bf16 v[44:47], a[180:183], a[224:227], v[44:47]
    ds_read_b128 a[196:199], v2 offset:22528
    s_waitcnt lgkmcnt(5)
    v_mfma_f32_16x16x32_bf16 v[192:195], a[40:43], a[228:231], v[192:195]
    ds_read_b128 a[200:203], v2 offset:23552
    v_add_f32 v96, v96, v119
    v_mfma_f32_16x16x32_bf16 v[192:195], a[44:47], a[232:235], v[192:195]
    global_load_lds_dwordx4 v4, s[34:35] offset:-2048 sc1
    v_mfma_f32_16x16x32_bf16 v[220:223], a[88:91], a[228:231], v[220:223]
    v_add_f32 v141, v141, v20
    v_add_f32 v141, v141, v96
    v_mfma_f32_16x16x32_bf16 v[220:223], a[92:95], a[232:235], v[220:223]
    v_mov_b32 v96, v141
    v_max3_f32 v97, v67, v228, v229
    v_mfma_f32_16x16x32_bf16 v[224:227], a[136:139], a[228:231], v[224:227]
    v_permlane16_swap_b32 v141, v96
    v_add_f32 v141, v141, v96
    v_mfma_f32_16x16x32_bf16 v[224:227], a[140:143], a[232:235], v[224:227]
    v_mov_b32 v96, v141
    v_max3_f32 v98, v98, v230, v231
    v_mfma_f32_16x16x32_bf16 v[44:47], a[184:187], a[228:231], v[44:47]
    global_load_lds_dwordx4 v4, s[34:35] offset:-1024 sc1
    v_mfma_f32_16x16x32_bf16 v[44:47], a[188:191], a[232:235], v[44:47]
    v_permlane32_swap_b32 v141, v96
    s_waitcnt lgkmcnt(2)
    v_mfma_f32_16x16x32_bf16 v[252:255], v[172:175], v[48:51], 0
    v_cvt_pk_bf16_f32 v36, v192, v193
    v_cvt_pk_bf16_f32 v37, v194, v195
    v_mfma_f32_16x16x32_bf16 v[252:255], v[240:243], v[196:199], v[252:255]
    v_add_f32 v141, v141, v96
    v_max3_f32 v97, v97, v236, v237
    v_mfma_f32_16x16x32_bf16 v[40:43], v[216:219], v[48:51], 0
    v_cvt_pk_bf16_f32 v38, v220, v221
    v_cvt_pk_bf16_f32 v39, v222, v223
    v_mfma_f32_16x16x32_bf16 v[40:43], v[28:31], v[196:199], v[40:43]
    ds_read_b128 a[208:211], v2 offset:24576
    v_mfma_f32_16x16x32_bf16 v[52:55], a[0:3], a[252:255], 0
    ds_read_b128 a[212:215], v2 offset:25600
    v_cvt_pk_bf16_f32 v56, v224, v225
    v_mfma_f32_16x16x32_bf16 v[52:55], a[4:7], a[192:195], v[52:55]
    v_cvt_pk_bf16_f32 v57, v226, v227
    v_mov_b32 v71, 0
    v_mfma_f32_16x16x32_bf16 v[100:103], a[48:51], a[252:255], 0
    v_cvt_pk_bf16_f32 v142, v44, v45
    v_cvt_pk_bf16_f32 v143, v46, v47
    v_mfma_f32_16x16x32_bf16 v[100:103], a[52:55], a[192:195], v[100:103]
    ds_write_b64 v13, v[142:143] offset:8192
    v_mfma_f32_16x16x32_bf16 v[104:107], a[96:99], a[252:255], 0
    v_cvt_pk_bf16_f32 v24, v252, v253
    v_cvt_pk_bf16_f32 v25, v254, v255
    v_mfma_f32_16x16x32_bf16 v[104:107], a[100:103], a[192:195], v[104:107]
    global_load_lds_dwordx4 v4, s[34:35] sc1
    v_mfma_f32_16x16x32_bf16 v[72:75], a[144:147], a[252:255], 0
    v_cvt_pk_bf16_f32 v26, v40, v41
    v_cvt_pk_bf16_f32 v27, v42, v43
    v_mfma_f32_16x16x32_bf16 v[72:75], a[148:151], a[192:195], v[72:75]
    ds_read_b128 a[236:239], v2 offset:26624
    v_mfma_f32_16x16x32_bf16 v[76:79], v[172:175], v[88:91], 0
    ds_read_b128 a[240:243], v2 offset:27648
    v_max3_f32 v98, v98, v238, v239
    v_mfma_f32_16x16x32_bf16 v[76:79], v[240:243], v[120:123], v[76:79]
    v_rcp_f32 v141, v141
    v_mfma_f32_16x16x32_bf16 v[128:131], v[216:219], v[88:91], 0
    buffer_store_dwordx4 v[24:27], v6, s[8:11], 0 offen offset:128 nt
    v_mfma_f32_16x16x32_bf16 v[128:131], v[28:31], v[120:123], v[128:131]
    v_mul_f32 v164, v164, v141
    s_waitcnt lgkmcnt(5)
    v_mfma_f32_16x16x32_bf16 v[52:55], a[8:11], a[196:199], v[52:55]
    v_mul_f32 v165, v165, v141
    v_mul_f32 v166, v166, v141
    v_mfma_f32_16x16x32_bf16 v[52:55], a[12:15], a[200:203], v[52:55]
    v_mul_f32 v167, v167, v141
    v_mul_f32 v176, v176, v141
    v_mfma_f32_16x16x32_bf16 v[100:103], a[56:59], a[196:199], v[100:103]
    v_mul_f32 v177, v177, v141
    v_mul_f32 v178, v178, v141
    v_mfma_f32_16x16x32_bf16 v[100:103], a[60:63], a[200:203], v[100:103]
    v_mul_f32 v179, v179, v141
    v_cvt_pk_bf16_f32 v132, v164, v165
    v_mfma_f32_16x16x32_bf16 v[104:107], a[104:107], a[196:199], v[104:107]
    v_cvt_pk_bf16_f32 v204, v76, v77
    v_cvt_pk_bf16_f32 v205, v78, v79
    v_mfma_f32_16x16x32_bf16 v[104:107], a[108:111], a[200:203], v[104:107]
    v_cvt_pk_bf16_f32 v133, v166, v167
    v_cvt_pk_bf16_f32 v134, v176, v177
    v_mfma_f32_16x16x32_bf16 v[72:75], a[152:155], a[196:199], v[72:75]
    v_cvt_pk_bf16_f32 v206, v128, v129
    v_cvt_pk_bf16_f32 v207, v130, v131
    v_mfma_f32_16x16x32_bf16 v[72:75], a[156:159], a[200:203], v[72:75]
    ds_read_b128 a[244:247], v2 offset:28672
    v_mfma_f32_16x16x32_bf16 v[208:211], v[172:175], v[184:187], 0
    ds_read_b128 a[248:251], v2 offset:29696
    v_cvt_pk_bf16_f32 v135, v178, v179
    v_mfma_f32_16x16x32_bf16 v[208:211], v[240:243], v[148:151], v[208:211]
    global_load_lds_dwordx4 v4, s[34:35] offset:1024 sc1
    v_mfma_f32_16x16x32_bf16 v[212:215], v[216:219], v[184:187], 0
    v_mul_f32 v116, v116, v141
    v_mul_f32 v117, v117, v141
    v_mfma_f32_16x16x32_bf16 v[212:215], v[28:31], v[148:151], v[212:215]
    v_mul_f32 v118, v118, v141
    s_waitcnt lgkmcnt(5)
    v_mfma_f32_16x16x32_bf16 v[52:55], a[16:19], a[208:211], v[52:55]
    v_mul_f32 v119, v119, v141
    v_mul_f32 v20, v20, v141
    v_mfma_f32_16x16x32_bf16 v[52:55], a[20:23], a[212:215], v[52:55]
    v_cvt_pk_bf16_f32 v68, v116, v117
    v_cvt_pk_bf16_f32 v69, v118, v119
    v_mfma_f32_16x16x32_bf16 v[100:103], a[64:67], a[208:211], v[100:103]
    v_cvt_pk_bf16_f32 v70, v20, 0
    v_max3_f32 v98, v98, v97, v33
    v_mfma_f32_16x16x32_bf16 v[100:103], a[68:71], a[212:215], v[100:103]
    ds_read_b128 a[204:207], v2 offset:30720
    ds_read_b128 a[216:219], v2 offset:31744
    v_mfma_f32_16x16x32_bf16 v[104:107], a[112:115], a[208:211], v[104:107]
    global_load_lds_dwordx4 v4, s[34:35] offset:2048 sc1
    v_mfma_f32_16x16x32_bf16 v[104:107], a[116:119], a[212:215], v[104:107]
    v_add_u32 v4, 24576, v4
    v_cvt_pk_bf16_f32 v248, v208, v209
    v_mfma_f32_16x16x32_bf16 v[72:75], a[160:163], a[208:211], v[72:75]
    v_cvt_pk_bf16_f32 v249, v210, v211
    v_cvt_pk_bf16_f32 v250, v212, v213
    v_mfma_f32_16x16x32_bf16 v[72:75], a[164:167], a[212:215], v[72:75]
    v_cvt_pk_bf16_f32 v251, v214, v215
    s_waitcnt lgkmcnt(4)
    v_mfma_f32_16x16x32_bf16 v[52:55], a[24:27], a[236:239], v[52:55]
    v_mov_b32 v97, v98
    v_mfma_f32_16x16x32_bf16 v[52:55], a[28:31], a[240:243], v[52:55]
    buffer_store_dwordx4 v[204:207], v10, s[8:11], 0 offen offset:128 nt
    v_mfma_f32_16x16x32_bf16 v[100:103], a[72:75], a[236:239], v[100:103]
    v_permlane16_swap_b32 v98, v97
    v_max_f32 v98, v98, v97
    v_mfma_f32_16x16x32_bf16 v[100:103], a[76:79], a[240:243], v[100:103]
    ds_read_b128 a[220:223], v1
    ds_read_b128 a[224:227], v1 offset:1024
    v_mfma_f32_16x16x32_bf16 v[104:107], a[120:123], a[236:239], v[104:107]
    v_mov_b32 v97, v98
    v_mfma_f32_16x16x32_bf16 v[104:107], a[124:127], a[240:243], v[104:107]
    s_nop 0
    v_permlane32_swap_b32 v98, v97
    v_max_f32 v98, v98, v97
    v_mfma_f32_16x16x32_bf16 v[72:75], a[168:171], a[236:239], v[72:75]
    v_mul_f32 v98, s19, v98
    v_fma_f32 v64, v64, s19, -v98
    v_mfma_f32_16x16x32_bf16 v[72:75], a[172:175], a[240:243], v[72:75]
    v_fma_f32 v65, v65, s19, -v98
    v_mfma_f32_16x16x32_bf16 v[80:83], v[168:171], v[132:135], 0
    v_exp_f32 v64, v64
    v_mfma_f32_16x16x32_bf16 v[80:83], v[180:183], v[68:71], v[80:83]
    v_exp_f32 v65, v65
    v_mfma_f32_16x16x32_bf16 v[84:87], v[60:63], v[132:135], 0
    buffer_store_dwordx4 v[248:251], v7, s[8:11], 0 offen offset:128 nt
    v_mfma_f32_16x16x32_bf16 v[84:87], v[108:111], v[68:71], v[84:87]
    v_fma_f32 v66, v66, s19, -v98
    s_waitcnt lgkmcnt(4)
    v_mfma_f32_16x16x32_bf16 v[52:55], a[32:35], a[244:247], v[52:55]
    v_exp_f32 v66, v66
    v_mfma_f32_16x16x32_bf16 v[52:55], a[36:39], a[248:251], v[52:55]
    v_fma_f32 v67, v67, s19, -v98
    v_fma_f32 v228, v228, s19, -v98
    v_mfma_f32_16x16x32_bf16 v[100:103], a[80:83], a[244:247], v[100:103]
    v_exp_f32 v67, v67
    v_mfma_f32_16x16x32_bf16 v[100:103], a[84:87], a[248:251], v[100:103]
    ds_read_b128 a[228:231], v1 offset:2048
    ds_read_b128 a[232:235], v1 offset:3072
    v_mfma_f32_16x16x32_bf16 v[104:107], a[128:131], a[244:247], v[104:107]
    v_cvt_pk_bf16_f32 v112, v80, v81
    v_cvt_pk_bf16_f32 v113, v82, v83
    v_mfma_f32_16x16x32_bf16 v[104:107], a[132:135], a[248:251], v[104:107]
    v_exp_f32 v228, v228
    v_mfma_f32_16x16x32_bf16 v[72:75], a[176:179], a[244:247], v[72:75]
    v_cvt_pk_bf16_f32 v114, v84, v85
    v_cvt_pk_bf16_f32 v115, v86, v87
    v_mfma_f32_16x16x32_bf16 v[72:75], a[180:183], a[248:251], v[72:75]
    v_fma_f32 v229, v229, s19, -v98
    s_waitcnt lgkmcnt(4)
    v_mfma_f32_16x16x32_bf16 v[52:55], a[40:43], a[204:207], v[52:55]
    buffer_store_dwordx4 v[112:115], v8, s[8:11], 0 offen nt
    v_mfma_f32_16x16x32_bf16 v[52:55], a[44:47], a[216:219], v[52:55]
    v_exp_f32 v229, v229
    v_mfma_f32_16x16x32_bf16 v[100:103], a[88:91], a[204:207], v[100:103]
    v_fma_f32 v230, v230, s19, -v98
    v_fma_f32 v231, v231, s19, -v98
    v_mfma_f32_16x16x32_bf16 v[100:103], a[92:95], a[216:219], v[100:103]
    ds_read_b128 a[192:195], v1 offset:4096
    ds_read_b128 a[196:199], v1 offset:5120
    v_mfma_f32_16x16x32_bf16 v[104:107], a[136:139], a[204:207], v[104:107]
    v_exp_f32 v230, v230
    v_mfma_f32_16x16x32_bf16 v[104:107], a[140:143], a[216:219], v[104:107]
    v_exp_f32 v231, v231
    v_mfma_f32_16x16x32_bf16 v[72:75], a[184:187], a[204:207], v[72:75]
    v_fma_f32 v236, v236, s19, -v98
    v_fma_f32 v237, v237, s19, -v98
    v_mfma_f32_16x16x32_bf16 v[72:75], a[188:191], a[216:219], v[72:75]
    v_fma_f32 v238, v238, s19, -v98
    s_waitcnt lgkmcnt(4)
    v_mfma_f32_16x16x32_bf16 v[200:203], a[0:3], a[220:223], 0
    v_cvt_pk_bf16_f32 v244, v52, v53
    v_cvt_pk_bf16_f32 v245, v54, v55
    v_mfma_f32_16x16x32_bf16 v[200:203], a[4:7], a[224:227], v[200:203]
    v_exp_f32 v236, v236
    v_mfma_f32_16x16x32_bf16 v[136:139], a[48:51], a[220:223], 0
    v_cvt_pk_bf16_f32 v246, v100, v101
    v_cvt_pk_bf16_f32 v247, v102, v103
    v_mfma_f32_16x16x32_bf16 v[136:139], a[52:55], a[224:227], v[136:139]
    v_exp_f32 v237, v237
    v_mfma_f32_16x16x32_bf16 v[156:159], a[96:99], a[220:223], 0
    v_cvt_pk_bf16_f32 v192, v104, v105
    v_cvt_pk_bf16_f32 v193, v106, v107
    v_mfma_f32_16x16x32_bf16 v[156:159], a[100:103], a[224:227], v[156:159]
    v_exp_f32 v238, v238
    v_mfma_f32_16x16x32_bf16 v[220:223], a[144:147], a[220:223], 0
    v_cvt_pk_bf16_f32 v96, v72, v73
    v_cvt_pk_bf16_f32 v97, v74, v75
    v_mfma_f32_16x16x32_bf16 v[220:223], a[148:151], a[224:227], v[220:223]
    ds_read_b128 a[200:203], v1 offset:6144
    v_mfma_f32_16x16x32_bf16 v[24:27], v[232:235], v[132:135], 0
    ds_read_b128 a[252:255], v1 offset:7168
    v_fma_f32 v239, v239, s19, -v98
    v_mfma_f32_16x16x32_bf16 v[24:27], v[152:155], v[68:71], v[24:27]
    ds_write_b64 v13, v[96:97] offset:9216
    v_mfma_f32_16x16x32_bf16 v[40:43], v[144:147], v[132:135], 0
    v_exp_f32 v239, v239
    v_mfma_f32_16x16x32_bf16 v[40:43], v[92:95], v[68:71], v[40:43]
    v_fma_f32 v33, v33, s19, -v98
    s_waitcnt lgkmcnt(5)
    v_mfma_f32_16x16x32_bf16 v[200:203], a[8:11], a[228:231], v[200:203]
    v_exp_f32 v33, v33
    v_mfma_f32_16x16x32_bf16 v[200:203], a[12:15], a[232:235], v[200:203]
    v_add_f32 v99, v64, v65
    v_add_f32 v96, v66, v67
    v_mfma_f32_16x16x32_bf16 v[136:139], a[56:59], a[228:231], v[136:139]
    v_add_f32 v99, v99, v228
    v_add_f32 v96, v96, v229
    v_mfma_f32_16x16x32_bf16 v[136:139], a[60:63], a[232:235], v[136:139]
    ds_read_b128 a[208:211], v1 offset:8192
    ds_read_b128 a[212:215], v1 offset:9216
    v_mfma_f32_16x16x32_bf16 v[156:159], a[104:107], a[228:231], v[156:159]
    v_cvt_pk_bf16_f32 v44, v24, v25
    v_cvt_pk_bf16_f32 v45, v26, v27
    v_mfma_f32_16x16x32_bf16 v[156:159], a[108:111], a[232:235], v[156:159]
    v_add_f32 v99, v99, v230
    v_add_f32 v96, v96, v231
    v_mfma_f32_16x16x32_bf16 v[220:223], a[152:155], a[228:231], v[220:223]
    v_cvt_pk_bf16_f32 v46, v40, v41
    v_cvt_pk_bf16_f32 v47, v42, v43
    v_mfma_f32_16x16x32_bf16 v[220:223], a[156:159], a[232:235], v[220:223]
    v_add_f32 v99, v99, v236
    s_waitcnt lgkmcnt(5)
    v_mfma_f32_16x16x32_bf16 v[200:203], a[16:19], a[192:195], v[200:203]
    v_add_f32 v96, v96, v237
    v_add_f32 v99, v99, v238
    v_mfma_f32_16x16x32_bf16 v[200:203], a[20:23], a[196:199], v[200:203]
    v_add_f32 v96, v96, v239
    v_add_f32 v99, v99, v33
    v_mfma_f32_16x16x32_bf16 v[136:139], a[64:67], a[192:195], v[136:139]
    v_add_f32 v99, v99, v96
    v_mov_b32 v96, v99
    v_mfma_f32_16x16x32_bf16 v[136:139], a[68:71], a[196:199], v[136:139]
    s_nop 0
    v_permlane16_swap_b32 v99, v96
    v_add_f32 v99, v99, v96
    v_mfma_f32_16x16x32_bf16 v[156:159], a[112:115], a[192:195], v[156:159]
    v_mov_b32 v96, v99
    v_mov_b32 v79, 0
    v_mfma_f32_16x16x32_bf16 v[156:159], a[116:119], a[196:199], v[156:159]
    v_permlane32_swap_b32 v99, v96
    v_add_f32 v99, v99, v96
    v_mfma_f32_16x16x32_bf16 v[220:223], a[160:163], a[192:195], v[220:223]
    v_rcp_f32 v99, v99
    v_mfma_f32_16x16x32_bf16 v[220:223], a[164:167], a[196:199], v[220:223]
    ds_read_b128 a[236:239], v3 offset:28672
    v_mfma_f32_16x16x32_bf16 v[128:131], v[172:175], v[132:135], 0
    ds_read_b128 a[240:243], v3 offset:30720
    ds_read_b128 a[244:247], v1 offset:10240
    v_mfma_f32_16x16x32_bf16 v[128:131], v[240:243], v[68:71], v[128:131]
    ds_read_b128 a[204:207], v3 offset:29696
    ds_read_b128 a[216:219], v1 offset:11264
    v_mfma_f32_16x16x32_bf16 v[140:143], v[216:219], v[132:135], 0
    ds_read_b128 a[220:223], v3 offset:31744
    v_mul_f32 v64, v64, v99
    v_mfma_f32_16x16x32_bf16 v[140:143], v[28:31], v[68:71], v[140:143]
    v_mul_f32 v65, v65, v99
    s_waitcnt lgkmcnt(9)
    v_mfma_f32_16x16x32_bf16 v[200:203], a[24:27], a[200:203], v[200:203]
    v_mul_f32 v66, v66, v99
    v_mul_f32 v67, v67, v99
    v_mfma_f32_16x16x32_bf16 v[200:203], a[28:31], a[252:255], v[200:203]
    v_mul_f32 v228, v228, v99
    v_mul_f32 v229, v229, v99
    v_mfma_f32_16x16x32_bf16 v[136:139], a[72:75], a[200:203], v[136:139]
    v_mul_f32 v230, v230, v99
    v_mul_f32 v231, v231, v99
    v_mfma_f32_16x16x32_bf16 v[136:139], a[76:79], a[252:255], v[136:139]
    v_cvt_pk_bf16_f32 v164, v64, v65
    v_cvt_pk_bf16_f32 v165, v66, v67
    v_mfma_f32_16x16x32_bf16 v[156:159], a[120:123], a[200:203], v[156:159]
    v_cvt_pk_bf16_f32 v166, v228, v229
    v_cvt_pk_bf16_f32 v167, v230, v231
    v_mfma_f32_16x16x32_bf16 v[156:159], a[124:127], a[252:255], v[156:159]
    v_mul_f32 v236, v236, v99
    v_mul_f32 v237, v237, v99
    v_mfma_f32_16x16x32_bf16 v[220:223], a[168:171], a[200:203], v[220:223]
    v_mul_f32 v238, v238, v99
    v_mul_f32 v239, v239, v99
    v_mfma_f32_16x16x32_bf16 v[220:223], a[172:175], a[252:255], v[220:223]
    v_mul_f32 v33, v33, v99
    s_waitcnt lgkmcnt(6)
    v_mfma_f32_16x16x32_bf16 v[200:203], a[32:35], a[208:211], v[200:203]
    v_cvt_pk_bf16_f32 v76, v236, v237
    v_cvt_pk_bf16_f32 v77, v238, v239
    v_mfma_f32_16x16x32_bf16 v[200:203], a[36:39], a[212:215], v[200:203]
    ds_read_b128 a[224:227], v1 offset:12288
    v_cvt_pk_bf16_f32 v78, 0, v33
    v_mfma_f32_16x16x32_bf16 v[136:139], a[80:83], a[208:211], v[136:139]
    buffer_store_dwordx4 v[44:47], v8, s[8:11], 0 offen offset:64 nt
    v_mfma_f32_16x16x32_bf16 v[136:139], a[84:87], a[212:215], v[136:139]
    ds_read_b128 a[248:251], v1 offset:13312
    v_cvt_pk_bf16_f32 v176, v128, v129
    v_mfma_f32_16x16x32_bf16 v[156:159], a[128:131], a[208:211], v[156:159]
    ds_write_b128 v19, v[160:163]
    v_mfma_f32_16x16x32_bf16 v[156:159], a[132:135], a[212:215], v[156:159]
    ds_write_b128 v19, v[124:127] offset:4096
    v_mfma_f32_16x16x32_bf16 v[220:223], a[176:179], a[208:211], v[220:223]
    ds_write_b128 v19, v[188:191] offset:8192
    v_mfma_f32_16x16x32_bf16 v[220:223], a[180:183], a[212:215], v[220:223]
    v_cvt_pk_bf16_f32 v177, v130, v131
    s_waitcnt lgkmcnt(5)
    v_mfma_f32_16x16x32_bf16 v[224:227], a[236:239], v[164:167], 0
    v_cvt_pk_bf16_f32 v178, v140, v141
    v_cvt_pk_bf16_f32 v179, v142, v143
    v_mfma_f32_16x16x32_bf16 v[224:227], a[240:243], v[76:79], v[224:227]
    ds_read_b128 a[192:195], v1 offset:14336
    ds_read_b128 a[196:199], v1 offset:15360
    v_mfma_f32_16x16x32_bf16 v[252:255], a[204:207], v[164:167], 0
    v_mfma_f32_16x16x32_bf16 v[252:255], a[220:223], v[76:79], v[252:255]
    v_mfma_f32_16x16x32_bf16 v[200:203], a[40:43], a[244:247], v[200:203]
    buffer_store_dwordx4 v[176:179], v8, s[8:11], 0 offen offset:128 nt
    v_mfma_f32_16x16x32_bf16 v[200:203], a[44:47], a[216:219], v[200:203]
    v_mfma_f32_16x16x32_bf16 v[136:139], a[88:91], a[244:247], v[136:139]
    s_waitcnt vmcnt(15) lgkmcnt(2)
    s_barrier
    v_mfma_f32_16x16x32_bf16 v[136:139], a[92:95], a[216:219], v[136:139]
    ds_read_b64 v[58:59], v3 offset:26632
    ds_read_b64 v[194:195], v3 offset:27656
    v_mfma_f32_16x16x32_bf16 v[156:159], a[136:139], a[244:247], v[156:159]
    s_add_u32 m0, s17, 73728
    v_cvt_pk_bf16_f32 v20, v224, v225
    v_mfma_f32_16x16x32_bf16 v[156:159], a[140:143], a[216:219], v[156:159]
    v_cvt_pk_bf16_f32 v21, v226, v227
    v_mfma_f32_16x16x32_bf16 v[220:223], a[184:187], a[244:247], v[220:223]
    v_cvt_pk_bf16_f32 v22, v252, v253
    v_cvt_pk_bf16_f32 v23, v254, v255
    v_mfma_f32_16x16x32_bf16 v[220:223], a[188:191], a[216:219], v[220:223]
    ds_read_b128 a[200:203], v3 offset:16384
L_st6:
    s_cbranch_execz L_st9
    v_mfma_f32_16x16x32_bf16 v[60:63], a[0:3], a[224:227], 0
    ds_read_b128 a[228:231], v3 offset:18432
    ds_read_b128 a[232:235], v1 offset:16384
    v_mfma_f32_16x16x32_bf16 v[60:63], a[4:7], a[248:251], v[60:63]
    global_load_lds_dwordx4 v4, s[34:35] offset:-3072 sc1
    v_mfma_f32_16x16x32_bf16 v[80:83], a[48:51], a[224:227], 0
    ds_read_b128 a[252:255], v3 offset:17408
    ds_read_b128 a[204:207], v3 offset:19456
    v_mfma_f32_16x16x32_bf16 v[80:83], a[52:55], a[248:251], v[80:83]
    ds_read_b128 a[208:211], v1 offset:17408
    v_cvt_pk_bf16_f32 v84, v200, v201
    v_mfma_f32_16x16x32_bf16 v[108:111], a[96:99], a[224:227], 0
    v_cvt_pk_bf16_f32 v85, v202, v203
    v_cvt_pk_bf16_f32 v86, v136, v137
    v_mfma_f32_16x16x32_bf16 v[108:111], a[100:103], a[248:251], v[108:111]
    v_cvt_pk_bf16_f32 v87, v138, v139
    v_cvt_pk_bf16_f32 v116, v156, v157
    v_mfma_f32_16x16x32_bf16 v[168:171], a[144:147], a[224:227], 0
    v_cvt_pk_bf16_f32 v180, v220, v221
    v_cvt_pk_bf16_f32 v181, v222, v223
    v_mfma_f32_16x16x32_bf16 v[168:171], a[148:151], a[248:251], v[168:171]
    ds_read_b128 a[212:215], v1 offset:18432
    s_waitcnt lgkmcnt(7)
    v_mfma_f32_16x16x32_bf16 v[204:207], v[36:39], v[88:91], 0
    global_load_lds_dwordx4 v4, s[34:35] offset:-2048 sc1
    v_mfma_f32_16x16x32_bf16 v[204:207], v[56:59], v[120:123], v[204:207]
    ds_read_b128 a[216:219], v1 offset:19456
    v_cvt_pk_bf16_f32 v117, v158, v159
    v_mfma_f32_16x16x32_bf16 v[208:211], v[244:247], v[88:91], 0
    ds_write_b64 v13, v[180:181] offset:12288
    v_mfma_f32_16x16x32_bf16 v[208:211], v[192:195], v[120:123], v[208:211]
    ds_read_b128 a[220:223], v2 offset:45056
    v_mfma_f32_16x16x32_bf16 v[60:63], a[8:11], a[192:195], v[60:63]
    ds_read_b128 a[224:227], v2 offset:49152
    v_mfma_f32_16x16x32_bf16 v[60:63], a[12:15], a[196:199], v[60:63]
    global_load_lds_dwordx4 v4, s[34:35] offset:-1024 sc1
    v_mfma_f32_16x16x32_bf16 v[80:83], a[56:59], a[192:195], v[80:83]
    ds_read_b128 a[236:239], v2 offset:53248
    ds_read_b128 a[240:243], v2 offset:46080
    v_mfma_f32_16x16x32_bf16 v[80:83], a[60:63], a[196:199], v[80:83]
    v_mfma_f32_16x16x32_bf16 v[108:111], a[104:107], a[192:195], v[108:111]
    v_cvt_pk_bf16_f32 v212, v204, v205
    v_cvt_pk_bf16_f32 v213, v206, v207
    v_mfma_f32_16x16x32_bf16 v[108:111], a[108:111], a[196:199], v[108:111]
    v_mfma_f32_16x16x32_bf16 v[168:171], a[152:155], a[192:195], v[168:171]
    buffer_store_dwordx4 v[20:23], v11, s[8:11], 0 offen nt
    v_mfma_f32_16x16x32_bf16 v[168:171], a[156:159], a[196:199], v[168:171]
    ds_read_b128 a[244:247], v3 offset:20480
    s_waitcnt lgkmcnt(9)
    v_mfma_f32_16x16x32_bf16 v[248:251], a[200:203], v[164:167], 0
    ds_read_b128 a[248:251], v3 offset:22528
    v_cvt_pk_bf16_f32 v214, v208, v209
    v_mfma_f32_16x16x32_bf16 v[248:251], a[228:231], v[76:79], v[248:251]
    ds_read_b128 a[192:195], v3 offset:21504
    v_cvt_pk_bf16_f32 v215, v210, v211
    v_mfma_f32_16x16x32_bf16 v[24:27], a[252:255], v[164:167], 0
    ds_read_b128 a[196:199], v3 offset:23552
    ds_read_b128 a[200:203], v1 offset:20480
    v_mfma_f32_16x16x32_bf16 v[24:27], a[204:207], v[76:79], v[24:27]
    ds_read_b128 a[228:231], v1 offset:21504
    s_waitcnt lgkmcnt(13)
    v_mfma_f32_16x16x32_bf16 v[60:63], a[16:19], a[232:235], v[60:63]
    ds_read_b128 v[52:55], v2 offset:50176
    ds_read_b128 a[252:255], v2 offset:54272
    v_mfma_f32_16x16x32_bf16 v[60:63], a[20:23], a[208:211], v[60:63]
    ds_read_b128 v[72:75], v2 offset:47104
    v_mfma_f32_16x16x32_bf16 v[80:83], a[64:67], a[232:235], v[80:83]
    ds_read_b128 a[204:207], v2 offset:51200
    v_mfma_f32_16x16x32_bf16 v[80:83], a[68:71], a[208:211], v[80:83]
    global_load_lds_dwordx4 v4, s[34:35] sc1
    v_mfma_f32_16x16x32_bf16 v[108:111], a[112:115], a[232:235], v[108:111]
    ds_read_b128 v[92:95], v1 offset:22528
    ds_read_b128 v[100:103], v1 offset:23552
    v_mfma_f32_16x16x32_bf16 v[108:111], a[116:119], a[208:211], v[108:111]
    v_cvt_pk_bf16_f32 v104, v248, v249
    v_cvt_pk_bf16_f32 v105, v250, v251
    v_mfma_f32_16x16x32_bf16 v[168:171], a[160:163], a[232:235], v[168:171]
    v_cvt_pk_bf16_f32 v106, v24, v25
    v_cvt_pk_bf16_f32 v107, v26, v27
    v_mfma_f32_16x16x32_bf16 v[168:171], a[164:167], a[208:211], v[168:171]
    s_waitcnt lgkmcnt(15)
    v_mfma_f32_16x16x32_bf16 v[60:63], a[24:27], a[212:215], v[60:63]
    global_load_lds_dwordx4 v4, s[34:35] offset:1024 sc1
    v_mfma_f32_16x16x32_bf16 v[60:63], a[28:31], a[216:219], v[60:63]
    v_mfma_f32_16x16x32_bf16 v[80:83], a[72:75], a[212:215], v[80:83]
    v_mfma_f32_16x16x32_bf16 v[80:83], a[76:79], a[216:219], v[80:83]
    ds_read_b128 a[232:235], v1 offset:24576
    ds_read_b128 a[208:211], v1 offset:25600
    v_mfma_f32_16x16x32_bf16 v[108:111], a[120:123], a[212:215], v[108:111]
    v_mfma_f32_16x16x32_bf16 v[108:111], a[124:127], a[216:219], v[108:111]
    global_load_lds_dwordx4 v4, s[34:35] offset:2048 sc1
    v_mfma_f32_16x16x32_bf16 v[168:171], a[168:171], a[212:215], v[168:171]
    v_add_u32 v4, 24576, v4
    v_mfma_f32_16x16x32_bf16 v[168:171], a[172:175], a[216:219], v[168:171]
    ds_read_b128 v[112:115], v2 offset:55296
    s_waitcnt lgkmcnt(11)
    v_mfma_f32_16x16x32_bf16 v[144:147], a[244:247], v[164:167], 0
    ds_read_b128 v[152:155], v2 offset:48128
    v_mfma_f32_16x16x32_bf16 v[144:147], a[248:251], v[76:79], v[144:147]
    ds_read_b128 a[212:215], v2 offset:52224
    v_mfma_f32_16x16x32_bf16 v[232:235], a[192:195], v[164:167], 0
    buffer_store_dwordx4 v[212:215], v10, s[8:11], 0 offen offset:192 nt
    v_mfma_f32_16x16x32_bf16 v[232:235], a[196:199], v[76:79], v[232:235]
    ds_read_b128 a[216:219], v2 offset:56320
    s_waitcnt lgkmcnt(12)
    v_mfma_f32_16x16x32_bf16 v[60:63], a[32:35], a[200:203], v[60:63]
    v_mfma_f32_16x16x32_bf16 v[60:63], a[36:39], a[228:231], v[60:63]
    v_mfma_f32_16x16x32_bf16 v[80:83], a[80:83], a[200:203], v[80:83]
    v_mfma_f32_16x16x32_bf16 v[80:83], a[84:87], a[228:231], v[80:83]
    v_mfma_f32_16x16x32_bf16 v[108:111], a[128:131], a[200:203], v[108:111]
    v_cvt_pk_bf16_f32 v28, v144, v145
    v_cvt_pk_bf16_f32 v29, v146, v147
    v_mfma_f32_16x16x32_bf16 v[108:111], a[132:135], a[228:231], v[108:111]
    v_mfma_f32_16x16x32_bf16 v[168:171], a[176:179], a[200:203], v[168:171]
    v_cvt_pk_bf16_f32 v30, v232, v233
    v_cvt_pk_bf16_f32 v31, v234, v235
    v_mfma_f32_16x16x32_bf16 v[168:171], a[180:183], a[228:231], v[168:171]
    ds_read_b128 a[192:195], v5
    s_waitcnt lgkmcnt(7)
    v_mfma_f32_16x16x32_bf16 v[60:63], a[40:43], v[92:95], v[60:63]
    buffer_store_dwordx4 v[104:107], v11, s[8:11], 0 offen offset:64 nt
    v_mfma_f32_16x16x32_bf16 v[60:63], a[44:47], v[100:103], v[60:63]
    ds_read_b128 a[196:199], v5 offset:1024
    ds_read_b128 a[200:203], v5 offset:2048
    v_mfma_f32_16x16x32_bf16 v[80:83], a[88:91], v[92:95], v[80:83]
    ds_read_b128 a[228:231], v5 offset:3072
    ds_read_b128 a[244:247], v1 offset:26624
    v_mfma_f32_16x16x32_bf16 v[80:83], a[92:95], v[100:103], v[80:83]
    ds_read_b128 a[248:251], v1 offset:27648
    v_mfma_f32_16x16x32_bf16 v[108:111], a[136:139], v[92:95], v[108:111]
    v_mfma_f32_16x16x32_bf16 v[108:111], a[140:143], v[100:103], v[108:111]
    v_mfma_f32_16x16x32_bf16 v[168:171], a[184:187], v[92:95], v[168:171]
    v_mfma_f32_16x16x32_bf16 v[168:171], a[188:191], v[100:103], v[168:171]
    s_waitcnt lgkmcnt(10)
    v_mfma_f32_16x16x32_bf16 v[40:43], a[0:3], a[232:235], 0
    v_cvt_pk_bf16_f32 v64, v60, v61
    v_cvt_pk_bf16_f32 v65, v62, v63
    v_mfma_f32_16x16x32_bf16 v[40:43], a[4:7], a[208:211], v[40:43]
    buffer_store_dwordx4 v[28:31], v11, s[8:11], 0 offen offset:128 nt
    v_mfma_f32_16x16x32_bf16 v[96:99], a[48:51], a[232:235], 0
    v_cvt_pk_bf16_f32 v66, v80, v81
    v_cvt_pk_bf16_f32 v67, v82, v83
    v_mfma_f32_16x16x32_bf16 v[96:99], a[52:55], a[208:211], v[96:99]
    ds_read_b128 v[172:175], v5 offset:4096
    ds_read_b128 v[216:219], v1 offset:28672
    v_mfma_f32_16x16x32_bf16 v[228:231], a[96:99], a[232:235], 0
    ds_read_b128 v[240:243], v5 offset:5120
    ds_read_b128 v[32:35], v1 offset:29696
    v_mfma_f32_16x16x32_bf16 v[228:231], a[100:103], a[208:211], v[228:231]
    ds_read_b128 v[44:47], v5 offset:6144
    v_cvt_pk_bf16_f32 v124, v108, v109
    v_mfma_f32_16x16x32_bf16 v[128:131], a[144:147], a[232:235], 0
    v_cvt_pk_bf16_f32 v182, v168, v169
    v_cvt_pk_bf16_f32 v183, v170, v171
    v_mfma_f32_16x16x32_bf16 v[128:131], a[148:151], a[208:211], v[128:131]
    ds_read_b128 v[136:139], v5 offset:7168
    v_mfma_f32_16x16x32_bf16 v[140:143], v[36:39], v[48:51], 0
    ds_write_b64 v13, v[182:183] offset:13312
    v_mfma_f32_16x16x32_bf16 v[140:143], v[56:59], v[196:199], v[140:143]
    v_cvt_pk_bf16_f32 v125, v110, v111
    v_mfma_f32_16x16x32_bf16 v[160:163], v[244:247], v[48:51], 0
    v_mfma_f32_16x16x32_bf16 v[160:163], v[192:195], v[196:199], v[160:163]
    s_waitcnt lgkmcnt(9)
    v_mfma_f32_16x16x32_bf16 v[176:179], a[192:195], a[220:223], 0
    v_mfma_f32_16x16x32_bf16 v[176:179], a[196:199], a[224:227], v[176:179]
    v_mfma_f32_16x16x32_bf16 v[176:179], a[200:203], a[236:239], v[176:179]
    v_mfma_f32_16x16x32_bf16 v[176:179], a[228:231], a[240:243], v[176:179]
    s_waitcnt lgkmcnt(7)
    v_mfma_f32_16x16x32_bf16 v[40:43], a[8:11], a[244:247], v[40:43]
    v_cvt_pk_bf16_f32 v188, v140, v141
    v_cvt_pk_bf16_f32 v189, v142, v143
    v_mfma_f32_16x16x32_bf16 v[40:43], a[12:15], a[248:251], v[40:43]
    v_mfma_f32_16x16x32_bf16 v[96:99], a[56:59], a[244:247], v[96:99]
    v_cvt_pk_bf16_f32 v190, v160, v161
    v_cvt_pk_bf16_f32 v191, v162, v163
    v_mfma_f32_16x16x32_bf16 v[96:99], a[60:63], a[248:251], v[96:99]
    ds_read_b128 a[208:211], v5 offset:8192
    ds_read_b128 a[232:235], v1 offset:30720
    v_mfma_f32_16x16x32_bf16 v[228:231], a[104:107], a[244:247], v[228:231]
    ds_read_b128 a[192:195], v5 offset:9216
    ds_read_b128 a[196:199], v1 offset:31744
    v_mfma_f32_16x16x32_bf16 v[228:231], a[108:111], a[248:251], v[228:231]
    ds_read_b128 a[200:203], v5 offset:10240
    v_mfma_f32_16x16x32_bf16 v[128:131], a[152:155], a[244:247], v[128:131]
    ds_read_b128 a[228:231], v5 offset:11264
    v_mfma_f32_16x16x32_bf16 v[128:131], a[156:159], a[248:251], v[128:131]
    s_waitcnt lgkmcnt(7)
    v_mfma_f32_16x16x32_bf16 v[176:179], v[172:175], v[52:55], v[176:179]
    buffer_store_dwordx4 v[188:191], v6, s[8:11], 0 offen offset:192 nt
    v_mfma_f32_16x16x32_bf16 v[176:179], v[240:243], a[252:255], v[176:179]
    v_mfma_f32_16x16x32_bf16 v[176:179], v[44:47], v[72:75], v[176:179]
    v_mfma_f32_16x16x32_bf16 v[176:179], v[136:139], a[204:207], v[176:179]
    ds_read_b128 a[244:247], v1 offset:32768
    v_mfma_f32_16x16x32_bf16 v[40:43], a[16:19], v[216:219], v[40:43]
    ds_read_b128 a[248:251], v1 offset:33792
    v_mfma_f32_16x16x32_bf16 v[40:43], a[20:23], v[32:35], v[40:43]
    v_mfma_f32_16x16x32_bf16 v[96:99], a[64:67], v[216:219], v[96:99]
    v_mfma_f32_16x16x32_bf16 v[96:99], a[68:71], v[32:35], v[96:99]
    v_mfma_f32_16x16x32_bf16 v[228:231], a[112:115], v[216:219], v[228:231]
    v_mfma_f32_16x16x32_bf16 v[228:231], a[116:119], v[32:35], v[228:231]
    v_mfma_f32_16x16x32_bf16 v[128:131], a[160:163], v[216:219], v[128:131]
    v_mfma_f32_16x16x32_bf16 v[128:131], a[164:167], v[32:35], v[128:131]
    v_mfma_f32_16x16x32_bf16 v[200:203], v[36:39], v[184:187], 0
    v_mfma_f32_16x16x32_bf16 v[200:203], v[56:59], v[148:151], v[200:203]
    v_mfma_f32_16x16x32_bf16 v[224:227], v[244:247], v[184:187], 0
    v_mfma_f32_16x16x32_bf16 v[224:227], v[192:195], v[148:151], v[224:227]
    ds_read_b128 v[236:239], v1 offset:34816
    s_waitcnt lgkmcnt(3)
    v_mfma_f32_16x16x32_bf16 v[176:179], a[208:211], v[112:115], v[176:179]
    ds_read_b128 v[252:255], v1 offset:35840
    v_mfma_f32_16x16x32_bf16 v[176:179], a[192:195], v[152:155], v[176:179]
    v_mfma_f32_16x16x32_bf16 v[176:179], a[200:203], a[212:215], v[176:179]
    v_mfma_f32_16x16x32_bf16 v[176:179], a[228:231], a[216:219], v[176:179]
    v_mfma_f32_16x16x32_bf16 v[40:43], a[24:27], a[232:235], v[40:43]
    v_cvt_pk_bf16_f32 v20, v200, v201
    v_cvt_pk_bf16_f32 v21, v202, v203
    v_mfma_f32_16x16x32_bf16 v[40:43], a[28:31], a[196:199], v[40:43]
    v_mfma_f32_16x16x32_bf16 v[96:99], a[72:75], a[232:235], v[96:99]
    v_cvt_pk_bf16_f32 v22, v224, v225
    v_cvt_pk_bf16_f32 v23, v226, v227
    v_mfma_f32_16x16x32_bf16 v[96:99], a[76:79], a[196:199], v[96:99]
    ds_read_b128 a[192:195], v1 offset:36864
    ds_read_b128 a[200:203], v1 offset:37888
    v_mfma_f32_16x16x32_bf16 v[228:231], a[120:123], a[232:235], v[228:231]
    buffer_store_dwordx4 v[20:23], v7, s[8:11], 0 offen offset:192 nt
    v_mfma_f32_16x16x32_bf16 v[228:231], a[124:127], a[196:199], v[228:231]
    v_mfma_f32_16x16x32_bf16 v[128:131], a[168:171], a[232:235], v[128:131]
    v_cvt_pk_bf16_f32 v24, v176, v177
    v_cvt_pk_bf16_f32 v25, v178, v179
    v_mfma_f32_16x16x32_bf16 v[128:131], a[172:175], a[196:199], v[128:131]
    s_waitcnt lgkmcnt(4)
    v_mfma_f32_16x16x32_bf16 v[40:43], a[32:35], a[244:247], v[40:43]
    s_waitcnt vmcnt(17)
    s_barrier
    v_mfma_f32_16x16x32_bf16 v[40:43], a[36:39], a[248:251], v[40:43]
    s_add_u32 m0, s17, 0
    v_mfma_f32_16x16x32_bf16 v[96:99], a[80:83], a[244:247], v[96:99]
    v_mfma_f32_16x16x32_bf16 v[96:99], a[84:87], a[248:251], v[96:99]
    v_mfma_f32_16x16x32_bf16 v[228:231], a[128:131], a[244:247], v[228:231]
    v_mfma_f32_16x16x32_bf16 v[228:231], a[132:135], a[248:251], v[228:231]
    buffer_store_dwordx2 v[24:25], v17, s[8:11], 0 offen offset:256 nt
    v_mfma_f32_16x16x32_bf16 v[128:131], a[176:179], a[244:247], v[128:131]
    v_mfma_f32_16x16x32_bf16 v[128:131], a[180:183], a[248:251], v[128:131]
    ds_read_b128 a[208:211], v1 offset:38912
    v_mfma_f32_16x16x32_bf16 v[156:159], v[36:39], v[132:135], 0
    ds_read_b64 v[118:119], v3 offset:30728
    ds_read_b128 a[228:231], v1 offset:39936
    v_mfma_f32_16x16x32_bf16 v[156:159], v[56:59], v[68:71], v[156:159]
    v_mfma_f32_16x16x32_bf16 v[204:207], v[244:247], v[132:135], 0
    ds_read_b64 v[126:127], v3 offset:31752
    v_mfma_f32_16x16x32_bf16 v[204:207], v[192:195], v[68:71], v[204:207]
    s_waitcnt lgkmcnt(6)
    v_mfma_f32_16x16x32_bf16 v[40:43], a[40:43], v[236:239], v[40:43]
    v_mfma_f32_16x16x32_bf16 v[40:43], a[44:47], v[252:255], v[40:43]
    v_mfma_f32_16x16x32_bf16 v[96:99], a[88:91], v[236:239], v[96:99]
    global_load_lds_dwordx4 v4, s[34:35] offset:-3072 sc1
    v_mfma_f32_16x16x32_bf16 v[96:99], a[92:95], v[252:255], v[96:99]
    v_mfma_f32_16x16x32_bf16 v[228:231], a[136:139], v[236:239], v[228:231]
    v_cvt_pk_bf16_f32 v208, v156, v157
    v_cvt_pk_bf16_f32 v209, v158, v159
    v_mfma_f32_16x16x32_bf16 v[228:231], a[140:143], v[252:255], v[228:231]
    v_mfma_f32_16x16x32_bf16 v[128:131], a[184:187], v[236:239], v[128:131]
    v_cvt_pk_bf16_f32 v210, v204, v205
    v_cvt_pk_bf16_f32 v211, v206, v207
    v_mfma_f32_16x16x32_bf16 v[128:131], a[188:191], v[252:255], v[128:131]
    ds_read_b128 a[196:199], v3 offset:24576
    s_waitcnt lgkmcnt(5)
    v_mfma_f32_16x16x32_bf16 v[220:223], a[0:3], a[192:195], 0
    ds_read_b128 a[232:235], v3 offset:26624
    ds_read_b128 a[244:247], v1 offset:40960
    v_mfma_f32_16x16x32_bf16 v[220:223], a[4:7], a[200:203], v[220:223]
    ds_read_b128 a[248:251], v3 offset:25600
    ds_read_b128 v[248:251], v1 offset:41984
    v_mfma_f32_16x16x32_bf16 v[28:31], a[48:51], a[192:195], 0
    ds_read_b128 v[60:63], v3 offset:27648
    v_cvt_pk_bf16_f32 v80, v40, v41
    v_mfma_f32_16x16x32_bf16 v[28:31], a[52:55], a[200:203], v[28:31]
    global_load_lds_dwordx4 v4, s[34:35] offset:-2048 sc1
    v_mfma_f32_16x16x32_bf16 v[92:95], a[96:99], a[192:195], 0
    v_cvt_pk_bf16_f32 v81, v42, v43
    v_cvt_pk_bf16_f32 v82, v96, v97
    v_mfma_f32_16x16x32_bf16 v[92:95], a[100:103], a[200:203], v[92:95]
    v_cvt_pk_bf16_f32 v83, v98, v99
    v_cvt_pk_bf16_f32 v100, v228, v229
    v_mfma_f32_16x16x32_bf16 v[104:107], a[144:147], a[192:195], 0
    v_cvt_pk_bf16_f32 v26, v128, v129
    v_cvt_pk_bf16_f32 v27, v130, v131
    v_mfma_f32_16x16x32_bf16 v[104:107], a[148:151], a[200:203], v[104:107]
    ds_read_b128 v[144:147], v1 offset:43008
    s_waitcnt lgkmcnt(7)
    v_mfma_f32_16x16x32_bf16 v[168:171], v[84:87], v[88:91], 0
    ds_read_b128 v[212:215], v1 offset:44032
    v_cvt_pk_bf16_f32 v101, v230, v231
    v_mfma_f32_16x16x32_bf16 v[168:171], v[116:119], v[120:123], v[168:171]
    ds_write_b64 v13, v[26:27]
    v_mfma_f32_16x16x32_bf16 v[232:235], v[64:67], v[88:91], 0
    global_load_lds_dwordx4 v4, s[34:35] offset:-1024 sc1
    v_mfma_f32_16x16x32_bf16 v[232:235], v[124:127], v[120:123], v[232:235]
    v_mfma_f32_16x16x32_bf16 v[220:223], a[8:11], a[208:211], v[220:223]
    v_mfma_f32_16x16x32_bf16 v[220:223], a[12:15], a[228:231], v[220:223]
    v_mfma_f32_16x16x32_bf16 v[28:31], a[56:59], a[208:211], v[28:31]
    v_mfma_f32_16x16x32_bf16 v[28:31], a[60:63], a[228:231], v[28:31]
    buffer_store_dwordx4 v[208:211], v8, s[8:11], 0 offen offset:192 nt
    v_mfma_f32_16x16x32_bf16 v[92:95], a[104:107], a[208:211], v[92:95]
    v_cvt_pk_bf16_f32 v32, v168, v169
    v_cvt_pk_bf16_f32 v33, v170, v171
    v_mfma_f32_16x16x32_bf16 v[92:95], a[108:111], a[228:231], v[92:95]
    v_mfma_f32_16x16x32_bf16 v[104:107], a[152:155], a[208:211], v[104:107]
    v_cvt_pk_bf16_f32 v34, v232, v233
    v_cvt_pk_bf16_f32 v35, v234, v235
    v_mfma_f32_16x16x32_bf16 v[104:107], a[156:159], a[228:231], v[104:107]
    ds_read_b128 a[192:195], v1 offset:45056
    s_waitcnt lgkmcnt(4)
    v_mfma_f32_16x16x32_bf16 v[44:47], a[196:199], v[164:167], 0
    ds_read_b128 a[200:203], v1 offset:46080
    v_mfma_f32_16x16x32_bf16 v[44:47], a[232:235], v[76:79], v[44:47]
    v_mfma_f32_16x16x32_bf16 v[108:111], a[248:251], v[164:167], 0
    v_mfma_f32_16x16x32_bf16 v[108:111], v[60:63], v[76:79], v[108:111]
    v_mfma_f32_16x16x32_bf16 v[220:223], a[16:19], a[244:247], v[220:223]
    global_load_lds_dwordx4 v4, s[34:35] sc1
    v_mfma_f32_16x16x32_bf16 v[220:223], a[20:23], v[248:251], v[220:223]
    v_mfma_f32_16x16x32_bf16 v[28:31], a[64:67], a[244:247], v[28:31]
    v_mfma_f32_16x16x32_bf16 v[28:31], a[68:71], v[248:251], v[28:31]
    ds_read_b128 a[196:199], v1 offset:47104
    ds_read_b128 a[208:211], v1 offset:48128
    v_mfma_f32_16x16x32_bf16 v[92:95], a[112:115], a[244:247], v[92:95]
    v_cvt_pk_bf16_f32 v136, v44, v45
    v_cvt_pk_bf16_f32 v137, v46, v47
    v_mfma_f32_16x16x32_bf16 v[92:95], a[116:119], v[248:251], v[92:95]
    global_load_lds_dwordx4 v4, s[34:35] offset:1024 sc1
    v_mfma_f32_16x16x32_bf16 v[104:107], a[160:163], a[244:247], v[104:107]
    v_cvt_pk_bf16_f32 v138, v108, v109
    v_cvt_pk_bf16_f32 v139, v110, v111
    v_mfma_f32_16x16x32_bf16 v[104:107], a[164:167], v[248:251], v[104:107]
    s_waitcnt lgkmcnt(5)
    v_mfma_f32_16x16x32_bf16 v[220:223], a[24:27], v[144:147], v[220:223]
    v_mfma_f32_16x16x32_bf16 v[220:223], a[28:31], v[212:215], v[220:223]
    v_mfma_f32_16x16x32_bf16 v[28:31], a[72:75], v[144:147], v[28:31]
    global_load_lds_dwordx4 v4, s[34:35] offset:2048 sc1
    v_mfma_f32_16x16x32_bf16 v[28:31], a[76:79], v[212:215], v[28:31]
    ds_read_b128 a[228:231], v1 offset:49152
    v_add_u32 v4, 24576, v4
    v_mfma_f32_16x16x32_bf16 v[92:95], a[120:123], v[144:147], v[92:95]
    ds_read_b128 a[232:235], v1 offset:50176
    v_mfma_f32_16x16x32_bf16 v[92:95], a[124:127], v[212:215], v[92:95]
    v_mfma_f32_16x16x32_bf16 v[104:107], a[168:171], v[144:147], v[104:107]
    v_mfma_f32_16x16x32_bf16 v[104:107], a[172:175], v[212:215], v[104:107]
    v_mfma_f32_16x16x32_bf16 v[140:143], v[84:87], v[48:51], 0
    buffer_store_dwordx4 v[32:35], v10, s[8:11], 0 offen offset:256 nt
    v_mfma_f32_16x16x32_bf16 v[140:143], v[116:119], v[196:199], v[140:143]
    v_mfma_f32_16x16x32_bf16 v[160:163], v[64:67], v[48:51], 0
    v_mfma_f32_16x16x32_bf16 v[160:163], v[124:127], v[196:199], v[160:163]
    s_waitcnt lgkmcnt(4)
    v_mfma_f32_16x16x32_bf16 v[220:223], a[32:35], a[192:195], v[220:223]
    v_mfma_f32_16x16x32_bf16 v[220:223], a[36:39], a[200:203], v[220:223]
    v_mfma_f32_16x16x32_bf16 v[28:31], a[80:83], a[192:195], v[28:31]
    v_mfma_f32_16x16x32_bf16 v[28:31], a[84:87], a[200:203], v[28:31]
    ds_read_b128 a[244:247], v1 offset:51200
    ds_read_b128 a[248:251], v1 offset:52224
    v_mfma_f32_16x16x32_bf16 v[92:95], a[128:131], a[192:195], v[92:95]
    v_cvt_pk_bf16_f32 v172, v140, v141
    v_cvt_pk_bf16_f32 v173, v142, v143
    v_mfma_f32_16x16x32_bf16 v[92:95], a[132:135], a[200:203], v[92:95]
    buffer_store_dwordx4 v[136:139], v11, s[8:11], 0 offen offset:192 nt
    v_mfma_f32_16x16x32_bf16 v[104:107], a[176:179], a[192:195], v[104:107]
    v_cvt_pk_bf16_f32 v174, v160, v161
    v_cvt_pk_bf16_f32 v175, v162, v163
    v_mfma_f32_16x16x32_bf16 v[104:107], a[180:183], a[200:203], v[104:107]
    s_waitcnt lgkmcnt(4)
    v_mfma_f32_16x16x32_bf16 v[220:223], a[40:43], a[196:199], v[220:223]
    v_mfma_f32_16x16x32_bf16 v[220:223], a[44:47], a[208:211], v[220:223]
    v_mfma_f32_16x16x32_bf16 v[28:31], a[88:91], a[196:199], v[28:31]
    v_mfma_f32_16x16x32_bf16 v[28:31], a[92:95], a[208:211], v[28:31]
    ds_read_b128 a[192:195], v1 offset:53248
    ds_read_b128 v[180:183], v1 offset:54272
    v_mfma_f32_16x16x32_bf16 v[92:95], a[136:139], a[196:199], v[92:95]
    v_mfma_f32_16x16x32_bf16 v[92:95], a[140:143], a[208:211], v[92:95]
    v_mfma_f32_16x16x32_bf16 v[104:107], a[184:187], a[196:199], v[104:107]
    buffer_store_dwordx4 v[172:175], v6, s[8:11], 0 offen offset:256 nt
    v_mfma_f32_16x16x32_bf16 v[104:107], a[188:191], a[208:211], v[104:107]
    s_waitcnt lgkmcnt(4)
    v_mfma_f32_16x16x32_bf16 v[188:191], a[0:3], a[228:231], 0
    v_cvt_pk_bf16_f32 v200, v220, v221
    v_cvt_pk_bf16_f32 v201, v222, v223
    v_mfma_f32_16x16x32_bf16 v[188:191], a[4:7], a[232:235], v[188:191]
    v_mfma_f32_16x16x32_bf16 v[216:219], a[48:51], a[228:231], 0
    v_cvt_pk_bf16_f32 v202, v28, v29
    v_cvt_pk_bf16_f32 v203, v30, v31
    v_mfma_f32_16x16x32_bf16 v[216:219], a[52:55], a[232:235], v[216:219]
    v_mfma_f32_16x16x32_bf16 v[224:227], a[96:99], a[228:231], 0
    v_cvt_pk_bf16_f32 v240, v92, v93
    v_cvt_pk_bf16_f32 v241, v94, v95
    v_mfma_f32_16x16x32_bf16 v[224:227], a[100:103], a[232:235], v[224:227]
    v_mfma_f32_16x16x32_bf16 v[20:23], a[144:147], a[228:231], 0
    v_cvt_pk_bf16_f32 v24, v104, v105
    v_cvt_pk_bf16_f32 v25, v106, v107
    v_mfma_f32_16x16x32_bf16 v[20:23], a[148:151], a[232:235], v[20:23]
    ds_read_b128 a[196:199], v1 offset:55296
    v_mfma_f32_16x16x32_bf16 v[36:39], v[84:87], v[184:187], 0
    ds_read_b128 a[200:203], v1 offset:56320
    v_mfma_f32_16x16x32_bf16 v[36:39], v[116:119], v[148:151], v[36:39]
    ds_write_b64 v13, v[24:25] offset:1024
    v_mfma_f32_16x16x32_bf16 v[40:43], v[64:67], v[184:187], 0
    v_mfma_f32_16x16x32_bf16 v[40:43], v[124:127], v[148:151], v[40:43]
    s_waitcnt lgkmcnt(5)
    v_mfma_f32_16x16x32_bf16 v[188:191], a[8:11], a[244:247], v[188:191]
    v_mfma_f32_16x16x32_bf16 v[188:191], a[12:15], a[248:251], v[188:191]
    v_mfma_f32_16x16x32_bf16 v[216:219], a[56:59], a[244:247], v[216:219]
    v_mfma_f32_16x16x32_bf16 v[216:219], a[60:63], a[248:251], v[216:219]
    ds_read_b128 a[208:211], v1 offset:57344
    ds_read_b128 a[228:231], v1 offset:58368
    v_mfma_f32_16x16x32_bf16 v[224:227], a[104:107], a[244:247], v[224:227]
    v_cvt_pk_bf16_f32 v56, v36, v37
    v_cvt_pk_bf16_f32 v57, v38, v39
    v_mfma_f32_16x16x32_bf16 v[224:227], a[108:111], a[248:251], v[224:227]
    v_mfma_f32_16x16x32_bf16 v[20:23], a[152:155], a[244:247], v[20:23]
    v_cvt_pk_bf16_f32 v58, v40, v41
    v_cvt_pk_bf16_f32 v59, v42, v43
    v_mfma_f32_16x16x32_bf16 v[20:23], a[156:159], a[248:251], v[20:23]
    s_waitcnt lgkmcnt(5)
    v_mfma_f32_16x16x32_bf16 v[188:191], a[16:19], a[192:195], v[188:191]
    buffer_store_dwordx4 v[56:59], v7, s[8:11], 0 offen offset:256 nt
    v_mfma_f32_16x16x32_bf16 v[188:191], a[20:23], v[180:183], v[188:191]
    v_mfma_f32_16x16x32_bf16 v[216:219], a[64:67], a[192:195], v[216:219]
    v_mfma_f32_16x16x32_bf16 v[216:219], a[68:71], v[180:183], v[216:219]
    ds_read_b128 a[232:235], v1 offset:59392
    ds_read_b128 a[244:247], v1 offset:60416
    v_mfma_f32_16x16x32_bf16 v[224:227], a[112:115], a[192:195], v[224:227]
    v_mfma_f32_16x16x32_bf16 v[224:227], a[116:119], v[180:183], v[224:227]
    v_mfma_f32_16x16x32_bf16 v[20:23], a[160:163], a[192:195], v[20:23]
    v_mfma_f32_16x16x32_bf16 v[20:23], a[164:167], v[180:183], v[20:23]
    v_mfma_f32_16x16x32_bf16 v[96:99], v[84:87], v[132:135], 0
    v_mfma_f32_16x16x32_bf16 v[96:99], v[116:119], v[68:71], v[96:99]
    v_mfma_f32_16x16x32_bf16 v[128:131], v[64:67], v[132:135], 0
    v_mfma_f32_16x16x32_bf16 v[128:131], v[124:127], v[68:71], v[128:131]
    s_waitcnt lgkmcnt(5)
    v_mfma_f32_16x16x32_bf16 v[188:191], a[24:27], a[196:199], v[188:191]
    v_mfma_f32_16x16x32_bf16 v[188:191], a[28:31], a[200:203], v[188:191]
    v_mfma_f32_16x16x32_bf16 v[216:219], a[72:75], a[196:199], v[216:219]
    v_mfma_f32_16x16x32_bf16 v[216:219], a[76:79], a[200:203], v[216:219]
    ds_read_b128 a[248:251], v3 offset:28672
    ds_read_b128 a[192:195], v1 offset:61440
    v_mfma_f32_16x16x32_bf16 v[224:227], a[120:123], a[196:199], v[224:227]
    ds_read_b128 v[156:159], v3 offset:30720
    ds_read_b128 v[176:179], v1 offset:62464
    v_mfma_f32_16x16x32_bf16 v[224:227], a[124:127], a[200:203], v[224:227]
    ds_read_b128 v[192:195], v3 offset:29696
    v_cvt_pk_bf16_f32 v204, v96, v97
    v_mfma_f32_16x16x32_bf16 v[20:23], a[168:171], a[196:199], v[20:23]
    ds_read_b128 v[236:239], v3 offset:31744
    v_cvt_pk_bf16_f32 v205, v98, v99
    v_mfma_f32_16x16x32_bf16 v[20:23], a[172:175], a[200:203], v[20:23]
    v_cvt_pk_bf16_f32 v206, v128, v129
    s_waitcnt lgkmcnt(8)
    v_mfma_f32_16x16x32_bf16 v[188:191], a[32:35], a[208:211], v[188:191]
    v_cvt_pk_bf16_f32 v207, v130, v131
    v_mfma_f32_16x16x32_bf16 v[188:191], a[36:39], a[228:231], v[188:191]
    s_waitcnt vmcnt(17)
    s_barrier
    v_mfma_f32_16x16x32_bf16 v[216:219], a[80:83], a[208:211], v[216:219]
    s_add_u32 m0, s17, 24576
    v_mfma_f32_16x16x32_bf16 v[216:219], a[84:87], a[228:231], v[216:219]
    buffer_store_dwordx4 v[204:207], v8, s[8:11], 0 offen offset:256 nt
    v_mfma_f32_16x16x32_bf16 v[224:227], a[128:131], a[208:211], v[224:227]
    v_mfma_f32_16x16x32_bf16 v[224:227], a[132:135], a[228:231], v[224:227]
    v_mfma_f32_16x16x32_bf16 v[20:23], a[176:179], a[208:211], v[20:23]
    v_mfma_f32_16x16x32_bf16 v[20:23], a[180:183], a[228:231], v[20:23]
    ds_read_b128 a[196:199], v1 offset:63488
    s_waitcnt lgkmcnt(7)
    v_mfma_f32_16x16x32_bf16 v[188:191], a[40:43], a[232:235], v[188:191]
    ds_read_b64 v[102:103], v3 offset:18440
    ds_read_b128 a[200:203], v1 offset:64512
    v_mfma_f32_16x16x32_bf16 v[188:191], a[44:47], a[244:247], v[188:191]
    v_mfma_f32_16x16x32_bf16 v[216:219], a[88:91], a[232:235], v[216:219]
    ds_read_b64 v[242:243], v3 offset:19464
    v_mfma_f32_16x16x32_bf16 v[216:219], a[92:95], a[244:247], v[216:219]
    v_mfma_f32_16x16x32_bf16 v[224:227], a[136:139], a[232:235], v[224:227]
    global_load_lds_dwordx4 v4, s[34:35] offset:-3072 sc1
    v_mfma_f32_16x16x32_bf16 v[224:227], a[140:143], a[244:247], v[224:227]
    v_mfma_f32_16x16x32_bf16 v[20:23], a[184:187], a[232:235], v[20:23]
    v_mfma_f32_16x16x32_bf16 v[20:23], a[188:191], a[244:247], v[20:23]
    s_waitcnt lgkmcnt(4)
    v_mfma_f32_16x16x32_bf16 v[244:247], a[248:251], v[164:167], 0
    v_cvt_pk_bf16_f32 v252, v188, v189
    v_cvt_pk_bf16_f32 v253, v190, v191
    v_mfma_f32_16x16x32_bf16 v[244:247], v[156:159], v[76:79], v[244:247]
    global_load_lds_dwordx4 v4, s[34:35] offset:-2048 sc1
    v_mfma_f32_16x16x32_bf16 v[32:35], v[192:195], v[164:167], 0
    v_cvt_pk_bf16_f32 v254, v216, v217
    v_cvt_pk_bf16_f32 v255, v218, v219
    v_mfma_f32_16x16x32_bf16 v[32:35], v[236:239], v[76:79], v[32:35]
    ds_read_b128 a[208:211], v2
    v_mfma_f32_16x16x32_bf16 v[44:47], a[0:3], a[192:195], 0
    ds_read_b128 a[228:231], v2 offset:1024
    v_cvt_pk_bf16_f32 v60, v224, v225
    v_mfma_f32_16x16x32_bf16 v[44:47], a[4:7], v[176:179], v[44:47]
    v_cvt_pk_bf16_f32 v61, v226, v227
    v_mfma_f32_16x16x32_bf16 v[108:111], a[48:51], a[192:195], 0
    v_cvt_pk_bf16_f32 v26, v20, v21
    v_cvt_pk_bf16_f32 v27, v22, v23
    v_mfma_f32_16x16x32_bf16 v[108:111], a[52:55], v[176:179], v[108:111]
    ds_write_b64 v13, v[26:27] offset:4096
    v_mfma_f32_16x16x32_bf16 v[144:147], a[96:99], a[192:195], 0
    v_cvt_pk_bf16_f32 v168, v244, v245
    v_cvt_pk_bf16_f32 v169, v246, v247
    v_mfma_f32_16x16x32_bf16 v[144:147], a[100:103], v[176:179], v[144:147]
    global_load_lds_dwordx4 v4, s[34:35] offset:-1024 sc1
    v_mfma_f32_16x16x32_bf16 v[208:211], a[144:147], a[192:195], 0
    v_cvt_pk_bf16_f32 v170, v32, v33
    v_cvt_pk_bf16_f32 v171, v34, v35
    v_mfma_f32_16x16x32_bf16 v[208:211], a[148:151], v[176:179], v[208:211]
    ds_read_b128 a[232:235], v2 offset:2048
    s_waitcnt lgkmcnt(4)
    v_mfma_f32_16x16x32_bf16 v[212:215], v[80:83], v[88:91], 0
    ds_read_b128 a[244:247], v2 offset:3072
    v_mfma_f32_16x16x32_bf16 v[212:215], v[100:103], v[120:123], v[212:215]
    v_mfma_f32_16x16x32_bf16 v[228:231], v[200:203], v[88:91], 0
    global_load_lds_dwordx4 v4, s[34:35] sc1
    v_mfma_f32_16x16x32_bf16 v[228:231], v[240:243], v[120:123], v[228:231]
    v_mfma_f32_16x16x32_bf16 v[44:47], a[8:11], a[196:199], v[44:47]
    v_mfma_f32_16x16x32_bf16 v[44:47], a[12:15], a[200:203], v[44:47]
    v_mfma_f32_16x16x32_bf16 v[108:111], a[56:59], a[196:199], v[108:111]
    v_mfma_f32_16x16x32_bf16 v[108:111], a[60:63], a[200:203], v[108:111]
    buffer_store_dwordx4 v[168:171], v11, s[8:11], 0 offen offset:256 nt
    v_mfma_f32_16x16x32_bf16 v[144:147], a[104:107], a[196:199], v[144:147]
    v_cvt_pk_bf16_f32 v232, v212, v213
    v_cvt_pk_bf16_f32 v233, v214, v215
    v_mfma_f32_16x16x32_bf16 v[144:147], a[108:111], a[200:203], v[144:147]
L_st7:
    s_cbranch_execz L_stdone
    v_mfma_f32_16x16x32_bf16 v[208:211], a[152:155], a[196:199], v[208:211]
    v_cvt_pk_bf16_f32 v234, v228, v229
    v_cvt_pk_bf16_f32 v235, v230, v231
    v_mfma_f32_16x16x32_bf16 v[208:211], a[156:159], a[200:203], v[208:211]
    ds_read_b128 a[248:251], v2 offset:4096
    v_mfma_f32_16x16x32_bf16 v[248:251], v[80:83], v[48:51], 0
    ds_read_b128 a[192:195], v2 offset:5120
    v_mfma_f32_16x16x32_bf16 v[248:251], v[100:103], v[196:199], v[248:251]
    v_add_u32 v24, 49152, v5
    v_mfma_f32_16x16x32_bf16 v[28:31], v[200:203], v[48:51], 0
    v_mfma_f32_16x16x32_bf16 v[28:31], v[240:243], v[196:199], v[28:31]
    s_waitcnt lgkmcnt(5)
    v_mfma_f32_16x16x32_bf16 v[44:47], a[16:19], a[208:211], v[44:47]
    global_load_lds_dwordx4 v4, s[34:35] offset:1024 sc1
    v_mfma_f32_16x16x32_bf16 v[44:47], a[20:23], a[228:231], v[44:47]
    v_mfma_f32_16x16x32_bf16 v[108:111], a[64:67], a[208:211], v[108:111]
    v_mfma_f32_16x16x32_bf16 v[108:111], a[68:71], a[228:231], v[108:111]
    ds_read_b128 a[196:199], v2 offset:6144
    ds_read_b128 a[200:203], v2 offset:7168
    v_mfma_f32_16x16x32_bf16 v[144:147], a[112:115], a[208:211], v[144:147]
    v_cvt_pk_bf16_f32 v36, v248, v249
    v_cvt_pk_bf16_f32 v37, v250, v251
    v_mfma_f32_16x16x32_bf16 v[144:147], a[116:119], a[228:231], v[144:147]
    global_load_lds_dwordx4 v4, s[34:35] offset:2048 sc1
    v_mfma_f32_16x16x32_bf16 v[208:211], a[160:163], a[208:211], v[208:211]
    v_add_u32 v4, 24576, v4
    v_cvt_pk_bf16_f32 v38, v28, v29
    v_mfma_f32_16x16x32_bf16 v[208:211], a[164:167], a[228:231], v[208:211]
    v_cvt_pk_bf16_f32 v39, v30, v31
    s_waitcnt lgkmcnt(4)
    v_mfma_f32_16x16x32_bf16 v[44:47], a[24:27], a[232:235], v[44:47]
    v_mfma_f32_16x16x32_bf16 v[44:47], a[28:31], a[244:247], v[44:47]
    v_mfma_f32_16x16x32_bf16 v[108:111], a[72:75], a[232:235], v[108:111]
    buffer_store_dwordx4 v[232:235], v10, s[8:11], 0 offen offset:320 nt
    v_mfma_f32_16x16x32_bf16 v[108:111], a[76:79], a[244:247], v[108:111]
    ds_read_b128 a[208:211], v2 offset:8192
    ds_read_b128 a[228:231], v2 offset:9216
    v_mfma_f32_16x16x32_bf16 v[144:147], a[120:123], a[232:235], v[144:147]
    v_mfma_f32_16x16x32_bf16 v[144:147], a[124:127], a[244:247], v[144:147]
    v_mfma_f32_16x16x32_bf16 v[208:211], a[168:171], a[232:235], v[208:211]
    v_mfma_f32_16x16x32_bf16 v[208:211], a[172:175], a[244:247], v[208:211]
    v_mfma_f32_16x16x32_bf16 v[40:43], v[80:83], v[184:187], 0
    v_mfma_f32_16x16x32_bf16 v[40:43], v[100:103], v[148:151], v[40:43]
    v_mfma_f32_16x16x32_bf16 v[56:59], v[200:203], v[184:187], 0
    v_mfma_f32_16x16x32_bf16 v[56:59], v[240:243], v[148:151], v[56:59]
    s_waitcnt lgkmcnt(4)
    v_mfma_f32_16x16x32_bf16 v[44:47], a[32:35], a[248:251], v[44:47]
    buffer_store_dwordx4 v[36:39], v6, s[8:11], 0 offen offset:320 nt
    v_mfma_f32_16x16x32_bf16 v[44:47], a[36:39], a[192:195], v[44:47]
    v_mfma_f32_16x16x32_bf16 v[108:111], a[80:83], a[248:251], v[108:111]
    v_mfma_f32_16x16x32_bf16 v[108:111], a[84:87], a[192:195], v[108:111]
    v_mfma_f32_16x16x32_bf16 v[144:147], a[128:131], a[248:251], v[144:147]
    v_cvt_pk_bf16_f32 v92, v40, v41
    v_cvt_pk_bf16_f32 v93, v42, v43
    v_mfma_f32_16x16x32_bf16 v[144:147], a[132:135], a[192:195], v[144:147]
    v_mfma_f32_16x16x32_bf16 v[208:211], a[176:179], a[248:251], v[208:211]
    v_cvt_pk_bf16_f32 v94, v56, v57
    v_cvt_pk_bf16_f32 v95, v58, v59
    v_mfma_f32_16x16x32_bf16 v[208:211], a[180:183], a[192:195], v[208:211]
    ds_read_b128 a[232:235], v24
    s_waitcnt lgkmcnt(3)
    v_mfma_f32_16x16x32_bf16 v[44:47], a[40:43], a[196:199], v[44:47]
    ds_read_b128 a[244:247], v24 offset:1024
    ds_read_b128 a[248:251], v2 offset:10240
    v_mfma_f32_16x16x32_bf16 v[44:47], a[44:47], a[200:203], v[44:47]
    ds_read_b128 v[104:107], v24 offset:2048
    ds_read_b128 a[192:195], v2 offset:11264
    v_mfma_f32_16x16x32_bf16 v[108:111], a[88:91], a[196:199], v[108:111]
    ds_read_b128 v[136:139], v24 offset:3072
    v_mfma_f32_16x16x32_bf16 v[108:111], a[92:95], a[200:203], v[108:111]
    buffer_store_dwordx4 v[92:95], v7, s[8:11], 0 offen offset:320 nt
    v_mfma_f32_16x16x32_bf16 v[144:147], a[136:139], a[196:199], v[144:147]
    v_mfma_f32_16x16x32_bf16 v[144:147], a[140:143], a[200:203], v[144:147]
    v_mfma_f32_16x16x32_bf16 v[208:211], a[184:187], a[196:199], v[208:211]
    v_mfma_f32_16x16x32_bf16 v[208:211], a[188:191], a[200:203], v[208:211]
    s_waitcnt lgkmcnt(6)
    v_mfma_f32_16x16x32_bf16 v[140:143], a[0:3], a[208:211], 0
    v_cvt_pk_bf16_f32 v160, v44, v45
    v_cvt_pk_bf16_f32 v161, v46, v47
    v_mfma_f32_16x16x32_bf16 v[140:143], a[4:7], a[228:231], v[140:143]
    v_mfma_f32_16x16x32_bf16 v[172:175], a[48:51], a[208:211], 0
    v_cvt_pk_bf16_f32 v162, v108, v109
    v_cvt_pk_bf16_f32 v163, v110, v111
    v_mfma_f32_16x16x32_bf16 v[172:175], a[52:55], a[228:231], v[172:175]
    ds_read_b128 a[196:199], v24 offset:4096
    ds_read_b128 a[200:203], v2 offset:12288
    v_mfma_f32_16x16x32_bf16 v[220:223], a[96:99], a[208:211], 0
    ds_read_b128 v[64:67], v24 offset:5120
    ds_read_b128 v[84:87], v2 offset:13312
    v_mfma_f32_16x16x32_bf16 v[220:223], a[100:103], a[228:231], v[220:223]
    ds_read_b128 v[96:99], v24 offset:6144
    v_cvt_pk_bf16_f32 v116, v144, v145
    v_mfma_f32_16x16x32_bf16 v[124:127], a[144:147], a[208:211], 0
    v_cvt_pk_bf16_f32 v26, v208, v209
    v_cvt_pk_bf16_f32 v27, v210, v211
    v_mfma_f32_16x16x32_bf16 v[124:127], a[148:151], a[228:231], v[124:127]
    ds_read_b128 v[128:131], v24 offset:7168
    v_mfma_f32_16x16x32_bf16 v[156:159], v[80:83], v[132:135], 0
    ds_write_b64 v13, v[26:27] offset:5120
    v_mfma_f32_16x16x32_bf16 v[156:159], v[100:103], v[68:71], v[156:159]
    v_cvt_pk_bf16_f32 v117, v146, v147
    v_mfma_f32_16x16x32_bf16 v[180:183], v[200:203], v[132:135], 0
    v_mfma_f32_16x16x32_bf16 v[180:183], v[240:243], v[68:71], v[180:183]
    s_waitcnt lgkmcnt(7)
    v_mfma_f32_16x16x32_bf16 v[188:191], a[232:235], a[220:223], 0
    v_mfma_f32_16x16x32_bf16 v[188:191], a[244:247], a[224:227], v[188:191]
    v_mfma_f32_16x16x32_bf16 v[188:191], v[104:107], a[236:239], v[188:191]
    v_mfma_f32_16x16x32_bf16 v[188:191], v[136:139], a[240:243], v[188:191]
    ds_read_b128 a[208:211], v3 offset:16384
    v_mfma_f32_16x16x32_bf16 v[140:143], a[8:11], a[248:251], v[140:143]
    ds_read_b128 a[228:231], v3 offset:18432
    v_cvt_pk_bf16_f32 v192, v156, v157
    v_mfma_f32_16x16x32_bf16 v[140:143], a[12:15], a[192:195], v[140:143]
    ds_read_b128 a[232:235], v3 offset:17408
    v_cvt_pk_bf16_f32 v193, v158, v159
    v_mfma_f32_16x16x32_bf16 v[172:175], a[56:59], a[248:251], v[172:175]
    ds_read_b128 a[244:247], v3 offset:19456
    v_cvt_pk_bf16_f32 v194, v180, v181
    v_mfma_f32_16x16x32_bf16 v[172:175], a[60:63], a[192:195], v[172:175]
    ds_read_b128 v[204:207], v24 offset:8192
    v_cvt_pk_bf16_f32 v195, v182, v183
    v_mfma_f32_16x16x32_bf16 v[220:223], a[104:107], a[248:251], v[220:223]
    ds_read_b128 v[216:219], v24 offset:9216
    ds_read_b128 v[236:239], v2 offset:14336
    v_mfma_f32_16x16x32_bf16 v[220:223], a[108:111], a[192:195], v[220:223]
    ds_read_b128 v[20:23], v24 offset:10240
    ds_read_b128 v[28:31], v2 offset:15360
    v_mfma_f32_16x16x32_bf16 v[124:127], a[152:155], a[248:251], v[124:127]
    ds_read_b128 v[32:35], v24 offset:11264
    v_mfma_f32_16x16x32_bf16 v[124:127], a[156:159], a[192:195], v[124:127]
    s_waitcnt lgkmcnt(11)
    v_mfma_f32_16x16x32_bf16 v[188:191], a[196:199], v[52:55], v[188:191]
    buffer_store_dwordx4 v[192:195], v8, s[8:11], 0 offen offset:320 nt
    v_mfma_f32_16x16x32_bf16 v[188:191], v[64:67], a[252:255], v[188:191]
    v_mfma_f32_16x16x32_bf16 v[188:191], v[96:99], v[72:75], v[188:191]
    v_mfma_f32_16x16x32_bf16 v[188:191], v[128:131], a[204:207], v[188:191]
    ds_read_b128 a[248:251], v2 offset:16384
    v_mfma_f32_16x16x32_bf16 v[140:143], a[16:19], a[200:203], v[140:143]
    ds_read_b128 a[192:195], v2 offset:17408
    v_mfma_f32_16x16x32_bf16 v[140:143], a[20:23], v[84:87], v[140:143]
    v_mfma_f32_16x16x32_bf16 v[172:175], a[64:67], a[200:203], v[172:175]
    v_mfma_f32_16x16x32_bf16 v[172:175], a[68:71], v[84:87], v[172:175]
    v_mfma_f32_16x16x32_bf16 v[220:223], a[112:115], a[200:203], v[220:223]
    v_mfma_f32_16x16x32_bf16 v[220:223], a[116:119], v[84:87], v[220:223]
    v_mfma_f32_16x16x32_bf16 v[124:127], a[160:163], a[200:203], v[124:127]
    v_mfma_f32_16x16x32_bf16 v[124:127], a[164:167], v[84:87], v[124:127]
    ds_read_b128 a[196:199], v2 offset:18432
    s_waitcnt lgkmcnt(9)
    v_mfma_f32_16x16x32_bf16 v[168:171], a[208:211], v[164:167], 0
    ds_read_b128 v[176:179], v2 offset:19456
    v_mfma_f32_16x16x32_bf16 v[168:171], a[228:231], v[76:79], v[168:171]
    v_mfma_f32_16x16x32_bf16 v[212:215], a[232:235], v[164:167], 0
    v_mfma_f32_16x16x32_bf16 v[212:215], a[244:247], v[76:79], v[212:215]
    s_waitcnt lgkmcnt(4)
    v_mfma_f32_16x16x32_bf16 v[188:191], v[204:207], v[112:115], v[188:191]
    v_mfma_f32_16x16x32_bf16 v[188:191], v[216:219], v[152:155], v[188:191]
    v_mfma_f32_16x16x32_bf16 v[188:191], v[20:23], a[212:215], v[188:191]
    v_mfma_f32_16x16x32_bf16 v[188:191], v[32:35], a[216:219], v[188:191]
    v_mfma_f32_16x16x32_bf16 v[140:143], a[24:27], v[236:239], v[140:143]
    v_cvt_pk_bf16_f32 v224, v168, v169
    v_cvt_pk_bf16_f32 v225, v170, v171
    v_mfma_f32_16x16x32_bf16 v[140:143], a[28:31], v[28:31], v[140:143]
    v_mfma_f32_16x16x32_bf16 v[172:175], a[72:75], v[236:239], v[172:175]
    v_cvt_pk_bf16_f32 v226, v212, v213
    v_cvt_pk_bf16_f32 v227, v214, v215
    v_mfma_f32_16x16x32_bf16 v[172:175], a[76:79], v[28:31], v[172:175]
    ds_read_b128 a[200:203], v2 offset:20480
    ds_read_b128 a[208:211], v2 offset:21504
    v_mfma_f32_16x16x32_bf16 v[220:223], a[120:123], v[236:239], v[220:223]
    buffer_store_dwordx4 v[224:227], v11, s[8:11], 0 offen offset:320 nt
    v_mfma_f32_16x16x32_bf16 v[220:223], a[124:127], v[28:31], v[220:223]
    v_mfma_f32_16x16x32_bf16 v[124:127], a[168:171], v[236:239], v[124:127]
    v_cvt_pk_bf16_f32 v228, v188, v189
    v_cvt_pk_bf16_f32 v229, v190, v191
    v_mfma_f32_16x16x32_bf16 v[124:127], a[172:175], v[28:31], v[124:127]
    s_waitcnt lgkmcnt(4)
    v_mfma_f32_16x16x32_bf16 v[140:143], a[32:35], a[248:251], v[140:143]
    s_waitcnt vmcnt(17)
    s_barrier
    v_mfma_f32_16x16x32_bf16 v[140:143], a[36:39], a[192:195], v[140:143]
    ds_read_b64 v[62:63], v3 offset:22536
    ds_read_b64 v[118:119], v3 offset:23560
    v_mfma_f32_16x16x32_bf16 v[172:175], a[80:83], a[248:251], v[172:175]
    s_add_u32 m0, s17, 49152
    v_mfma_f32_16x16x32_bf16 v[172:175], a[84:87], a[192:195], v[172:175]
    v_mfma_f32_16x16x32_bf16 v[220:223], a[128:131], a[248:251], v[220:223]
    v_mfma_f32_16x16x32_bf16 v[220:223], a[132:135], a[192:195], v[220:223]
    buffer_store_dwordx2 v[228:229], v17, s[8:11], 0 offen offset:384 nt
    v_mfma_f32_16x16x32_bf16 v[124:127], a[176:179], a[248:251], v[124:127]
    v_mfma_f32_16x16x32_bf16 v[124:127], a[180:183], a[192:195], v[124:127]
    ds_read_b128 a[228:231], v2 offset:22528
    s_waitcnt lgkmcnt(5)
    v_mfma_f32_16x16x32_bf16 v[140:143], a[40:43], a[196:199], v[140:143]
    ds_read_b128 a[232:235], v2 offset:23552
    v_mfma_f32_16x16x32_bf16 v[140:143], a[44:47], v[176:179], v[140:143]
    v_mfma_f32_16x16x32_bf16 v[172:175], a[88:91], a[196:199], v[172:175]
    v_mfma_f32_16x16x32_bf16 v[172:175], a[92:95], v[176:179], v[172:175]
    v_mfma_f32_16x16x32_bf16 v[220:223], a[136:139], a[196:199], v[220:223]
    v_mfma_f32_16x16x32_bf16 v[220:223], a[140:143], v[176:179], v[220:223]
    v_mfma_f32_16x16x32_bf16 v[124:127], a[184:187], a[196:199], v[124:127]
    global_load_lds_dwordx4 v4, s[34:35] offset:-3072 sc1
    v_mfma_f32_16x16x32_bf16 v[124:127], a[188:191], v[176:179], v[124:127]
    s_waitcnt lgkmcnt(2)
    v_mfma_f32_16x16x32_bf16 v[232:235], v[252:255], v[48:51], 0
    v_cvt_pk_bf16_f32 v244, v140, v141
    v_cvt_pk_bf16_f32 v245, v142, v143
    v_mfma_f32_16x16x32_bf16 v[232:235], v[60:63], v[196:199], v[232:235]
    v_mfma_f32_16x16x32_bf16 v[248:251], v[160:163], v[48:51], 0
    v_cvt_pk_bf16_f32 v246, v172, v173
    v_cvt_pk_bf16_f32 v247, v174, v175
    v_mfma_f32_16x16x32_bf16 v[248:251], v[116:119], v[196:199], v[248:251]
    ds_read_b128 a[244:247], v2 offset:24576
    v_mfma_f32_16x16x32_bf16 v[36:39], a[0:3], a[200:203], 0
    ds_read_b128 a[192:195], v2 offset:25600
    v_cvt_pk_bf16_f32 v40, v220, v221
    v_mfma_f32_16x16x32_bf16 v[36:39], a[4:7], a[208:211], v[36:39]
    global_load_lds_dwordx4 v4, s[34:35] offset:-2048 sc1
    v_mfma_f32_16x16x32_bf16 v[44:47], a[48:51], a[200:203], 0
    v_cvt_pk_bf16_f32 v230, v124, v125
    v_cvt_pk_bf16_f32 v231, v126, v127
    v_mfma_f32_16x16x32_bf16 v[44:47], a[52:55], a[208:211], v[44:47]
    ds_write_b64 v13, v[230:231] offset:8192
    v_mfma_f32_16x16x32_bf16 v[56:59], a[96:99], a[200:203], 0
    v_cvt_pk_bf16_f32 v80, v232, v233
    v_cvt_pk_bf16_f32 v81, v234, v235
    v_mfma_f32_16x16x32_bf16 v[56:59], a[100:103], a[208:211], v[56:59]
    v_cvt_pk_bf16_f32 v41, v222, v223
    v_mfma_f32_16x16x32_bf16 v[92:95], a[144:147], a[200:203], 0
    v_cvt_pk_bf16_f32 v82, v248, v249
    v_cvt_pk_bf16_f32 v83, v250, v251
    v_mfma_f32_16x16x32_bf16 v[92:95], a[148:151], a[208:211], v[92:95]
    ds_read_b128 a[196:199], v2 offset:26624
    v_mfma_f32_16x16x32_bf16 v[100:103], v[252:255], v[88:91], 0
    ds_read_b128 a[248:251], v2 offset:27648
    v_mfma_f32_16x16x32_bf16 v[100:103], v[60:63], v[120:123], v[100:103]
    global_load_lds_dwordx4 v4, s[34:35] offset:-1024 sc1
    v_mfma_f32_16x16x32_bf16 v[108:111], v[160:163], v[88:91], 0
    v_mfma_f32_16x16x32_bf16 v[108:111], v[116:119], v[120:123], v[108:111]
    s_waitcnt lgkmcnt(5)
    v_mfma_f32_16x16x32_bf16 v[36:39], a[8:11], a[228:231], v[36:39]
    v_mfma_f32_16x16x32_bf16 v[36:39], a[12:15], a[232:235], v[36:39]
    v_mfma_f32_16x16x32_bf16 v[44:47], a[56:59], a[228:231], v[44:47]
    global_load_lds_dwordx4 v4, s[34:35] sc1
    v_mfma_f32_16x16x32_bf16 v[44:47], a[60:63], a[232:235], v[44:47]
    v_mfma_f32_16x16x32_bf16 v[56:59], a[104:107], a[228:231], v[56:59]
    v_cvt_pk_bf16_f32 v144, v100, v101
    v_cvt_pk_bf16_f32 v145, v102, v103
    v_mfma_f32_16x16x32_bf16 v[56:59], a[108:111], a[232:235], v[56:59]
    v_mfma_f32_16x16x32_bf16 v[92:95], a[152:155], a[228:231], v[92:95]
    v_cvt_pk_bf16_f32 v146, v108, v109
    v_cvt_pk_bf16_f32 v147, v110, v111
    v_mfma_f32_16x16x32_bf16 v[92:95], a[156:159], a[232:235], v[92:95]
    ds_read_b128 a[200:203], v2 offset:28672
    v_mfma_f32_16x16x32_bf16 v[200:203], v[252:255], v[184:187], 0
    ds_read_b128 a[208:211], v2 offset:29696
    v_mfma_f32_16x16x32_bf16 v[200:203], v[60:63], v[148:151], v[200:203]
    buffer_store_dwordx4 v[80:83], v6, s[8:11], 0 offen offset:384 nt
    v_mfma_f32_16x16x32_bf16 v[208:211], v[160:163], v[184:187], 0
    v_mfma_f32_16x16x32_bf16 v[208:211], v[116:119], v[148:151], v[208:211]
    s_waitcnt lgkmcnt(5)
    v_mfma_f32_16x16x32_bf16 v[36:39], a[16:19], a[244:247], v[36:39]
    v_mfma_f32_16x16x32_bf16 v[36:39], a[20:23], a[192:195], v[36:39]
    v_mfma_f32_16x16x32_bf16 v[44:47], a[64:67], a[244:247], v[44:47]
    v_mfma_f32_16x16x32_bf16 v[44:47], a[68:71], a[192:195], v[44:47]
    ds_read_b128 a[228:231], v2 offset:30720
    ds_read_b128 a[232:235], v2 offset:31744
    v_mfma_f32_16x16x32_bf16 v[56:59], a[112:115], a[244:247], v[56:59]
    v_cvt_pk_bf16_f32 v20, v200, v201
    v_cvt_pk_bf16_f32 v21, v202, v203
    v_mfma_f32_16x16x32_bf16 v[56:59], a[116:119], a[192:195], v[56:59]
    v_mfma_f32_16x16x32_bf16 v[92:95], a[160:163], a[244:247], v[92:95]
    global_load_lds_dwordx4 v4, s[34:35] offset:1024 sc1
    v_mfma_f32_16x16x32_bf16 v[92:95], a[164:167], a[192:195], v[92:95]
    v_cvt_pk_bf16_f32 v22, v208, v209
    s_waitcnt lgkmcnt(4)
    v_mfma_f32_16x16x32_bf16 v[36:39], a[24:27], a[196:199], v[36:39]
    v_cvt_pk_bf16_f32 v23, v210, v211
    v_mfma_f32_16x16x32_bf16 v[36:39], a[28:31], a[248:251], v[36:39]
    v_mfma_f32_16x16x32_bf16 v[44:47], a[72:75], a[196:199], v[44:47]
    v_mfma_f32_16x16x32_bf16 v[44:47], a[76:79], a[248:251], v[44:47]
    global_load_lds_dwordx4 v4, s[34:35] offset:2048 sc1
    v_mfma_f32_16x16x32_bf16 v[56:59], a[120:123], a[196:199], v[56:59]
    ds_read_b128 a[192:195], v1
    v_add_u32 v4, 24576, v4
    v_mfma_f32_16x16x32_bf16 v[56:59], a[124:127], a[248:251], v[56:59]
    ds_read_b128 a[244:247], v1 offset:1024
    v_mfma_f32_16x16x32_bf16 v[92:95], a[168:171], a[196:199], v[92:95]
    v_mfma_f32_16x16x32_bf16 v[92:95], a[172:175], a[248:251], v[92:95]
    v_mfma_f32_16x16x32_bf16 v[24:27], v[252:255], v[132:135], 0
    buffer_store_dwordx4 v[144:147], v10, s[8:11], 0 offen offset:384 nt
    v_mfma_f32_16x16x32_bf16 v[24:27], v[60:63], v[68:71], v[24:27]
    v_mfma_f32_16x16x32_bf16 v[32:35], v[160:163], v[132:135], 0
    v_mfma_f32_16x16x32_bf16 v[32:35], v[116:119], v[68:71], v[32:35]
    s_waitcnt lgkmcnt(4)
    v_mfma_f32_16x16x32_bf16 v[36:39], a[32:35], a[200:203], v[36:39]
    v_mfma_f32_16x16x32_bf16 v[36:39], a[36:39], a[208:211], v[36:39]
    v_mfma_f32_16x16x32_bf16 v[44:47], a[80:83], a[200:203], v[44:47]
    v_mfma_f32_16x16x32_bf16 v[44:47], a[84:87], a[208:211], v[44:47]
    ds_read_b128 a[196:199], v3 offset:20480
    ds_read_b128 a[248:251], v1 offset:2048
    v_mfma_f32_16x16x32_bf16 v[56:59], a[128:131], a[200:203], v[56:59]
    ds_read_b128 v[64:67], v3 offset:22528
    ds_read_b128 v[84:87], v1 offset:3072
    v_mfma_f32_16x16x32_bf16 v[56:59], a[132:135], a[208:211], v[56:59]
    buffer_store_dwordx4 v[20:23], v7, s[8:11], 0 offen offset:384 nt
    v_mfma_f32_16x16x32_bf16 v[92:95], a[176:179], a[200:203], v[92:95]
    ds_read_b128 v[96:99], v3 offset:21504
    ds_read_b128 v[104:107], v3 offset:23552
    v_mfma_f32_16x16x32_bf16 v[92:95], a[180:183], a[208:211], v[92:95]
    v_cvt_pk_bf16_f32 v128, v24, v25
    s_waitcnt lgkmcnt(8)
    v_mfma_f32_16x16x32_bf16 v[36:39], a[40:43], a[228:231], v[36:39]
    v_cvt_pk_bf16_f32 v129, v26, v27
    v_cvt_pk_bf16_f32 v130, v32, v33
    v_mfma_f32_16x16x32_bf16 v[36:39], a[44:47], a[232:235], v[36:39]
    v_cvt_pk_bf16_f32 v131, v34, v35
    v_mfma_f32_16x16x32_bf16 v[44:47], a[88:91], a[228:231], v[44:47]
    v_mfma_f32_16x16x32_bf16 v[44:47], a[92:95], a[232:235], v[44:47]
    ds_read_b128 a[200:203], v1 offset:4096
    ds_read_b128 a[208:211], v1 offset:5120
    v_mfma_f32_16x16x32_bf16 v[56:59], a[136:139], a[228:231], v[56:59]
    v_mfma_f32_16x16x32_bf16 v[56:59], a[140:143], a[232:235], v[56:59]
    v_mfma_f32_16x16x32_bf16 v[92:95], a[184:187], a[228:231], v[92:95]
    buffer_store_dwordx4 v[128:131], v8, s[8:11], 0 offen offset:384 nt
    v_mfma_f32_16x16x32_bf16 v[92:95], a[188:191], a[232:235], v[92:95]
    s_waitcnt lgkmcnt(8)
    v_mfma_f32_16x16x32_bf16 v[136:139], a[0:3], a[192:195], 0
    v_cvt_pk_bf16_f32 v156, v36, v37
    v_cvt_pk_bf16_f32 v157, v38, v39
    v_mfma_f32_16x16x32_bf16 v[136:139], a[4:7], a[244:247], v[136:139]
    v_mfma_f32_16x16x32_bf16 v[168:171], a[48:51], a[192:195], 0
    v_cvt_pk_bf16_f32 v158, v44, v45
    v_cvt_pk_bf16_f32 v159, v46, v47
    v_mfma_f32_16x16x32_bf16 v[168:171], a[52:55], a[244:247], v[168:171]
    ds_read_b128 a[228:231], v1 offset:6144
    ds_read_b128 a[232:235], v1 offset:7168
    v_mfma_f32_16x16x32_bf16 v[180:183], a[96:99], a[192:195], 0
    v_cvt_pk_bf16_f32 v192, v56, v57
    v_cvt_pk_bf16_f32 v193, v58, v59
    v_mfma_f32_16x16x32_bf16 v[180:183], a[100:103], a[244:247], v[180:183]
    v_mfma_f32_16x16x32_bf16 v[204:207], a[144:147], a[192:195], 0
    v_cvt_pk_bf16_f32 v212, v92, v93
    v_cvt_pk_bf16_f32 v213, v94, v95
    v_mfma_f32_16x16x32_bf16 v[204:207], a[148:151], a[244:247], v[204:207]
    s_waitcnt lgkmcnt(4)
    v_mfma_f32_16x16x32_bf16 v[216:219], a[196:199], v[164:167], 0
    ds_write_b64 v13, v[212:213] offset:9216
    v_mfma_f32_16x16x32_bf16 v[216:219], v[64:67], v[76:79], v[216:219]
    v_mfma_f32_16x16x32_bf16 v[224:227], v[96:99], v[164:167], 0
    v_mfma_f32_16x16x32_bf16 v[224:227], v[104:107], v[76:79], v[224:227]
    ds_read_b128 a[192:195], v1 offset:8192
    v_mfma_f32_16x16x32_bf16 v[136:139], a[8:11], a[248:251], v[136:139]
    ds_read_b128 a[196:199], v1 offset:9216
    v_mfma_f32_16x16x32_bf16 v[136:139], a[12:15], v[84:87], v[136:139]
    v_mfma_f32_16x16x32_bf16 v[168:171], a[56:59], a[248:251], v[168:171]
    v_mfma_f32_16x16x32_bf16 v[168:171], a[60:63], v[84:87], v[168:171]
    v_mfma_f32_16x16x32_bf16 v[180:183], a[104:107], a[248:251], v[180:183]
    v_cvt_pk_bf16_f32 v240, v216, v217
    v_cvt_pk_bf16_f32 v241, v218, v219
    v_mfma_f32_16x16x32_bf16 v[180:183], a[108:111], v[84:87], v[180:183]
    v_mfma_f32_16x16x32_bf16 v[204:207], a[152:155], a[248:251], v[204:207]
    v_cvt_pk_bf16_f32 v242, v224, v225
    v_cvt_pk_bf16_f32 v243, v226, v227
    v_mfma_f32_16x16x32_bf16 v[204:207], a[156:159], v[84:87], v[204:207]
    ds_read_b128 a[244:247], v1 offset:10240
    s_waitcnt lgkmcnt(6)
    v_mfma_f32_16x16x32_bf16 v[136:139], a[16:19], a[200:203], v[136:139]
    ds_read_b128 v[28:31], v1 offset:11264
    v_mfma_f32_16x16x32_bf16 v[136:139], a[20:23], a[208:211], v[136:139]
    buffer_store_dwordx4 v[240:243], v11, s[8:11], 0 offen offset:384 nt
    v_mfma_f32_16x16x32_bf16 v[168:171], a[64:67], a[200:203], v[168:171]
    v_mfma_f32_16x16x32_bf16 v[168:171], a[68:71], a[208:211], v[168:171]
    v_mfma_f32_16x16x32_bf16 v[180:183], a[112:115], a[200:203], v[180:183]
    v_mfma_f32_16x16x32_bf16 v[180:183], a[116:119], a[208:211], v[180:183]
    v_mfma_f32_16x16x32_bf16 v[204:207], a[160:163], a[200:203], v[204:207]
    v_mfma_f32_16x16x32_bf16 v[204:207], a[164:167], a[208:211], v[204:207]
    s_waitcnt lgkmcnt(5)
    v_mfma_f32_16x16x32_bf16 v[136:139], a[24:27], a[228:231], v[136:139]
    v_mfma_f32_16x16x32_bf16 v[136:139], a[28:31], a[232:235], v[136:139]
    v_mfma_f32_16x16x32_bf16 v[168:171], a[72:75], a[228:231], v[168:171]
    v_mfma_f32_16x16x32_bf16 v[168:171], a[76:79], a[232:235], v[168:171]
    ds_read_b128 a[248:251], v1 offset:12288
    ds_read_b128 a[200:203], v1 offset:13312
    v_mfma_f32_16x16x32_bf16 v[180:183], a[120:123], a[228:231], v[180:183]
    v_mfma_f32_16x16x32_bf16 v[180:183], a[124:127], a[232:235], v[180:183]
    v_mfma_f32_16x16x32_bf16 v[204:207], a[168:171], a[228:231], v[204:207]
    v_mfma_f32_16x16x32_bf16 v[204:207], a[172:175], a[232:235], v[204:207]
    s_waitcnt lgkmcnt(4)
    v_mfma_f32_16x16x32_bf16 v[136:139], a[32:35], a[192:195], v[136:139]
    s_waitcnt vmcnt(17)
    s_barrier
    v_mfma_f32_16x16x32_bf16 v[136:139], a[36:39], a[196:199], v[136:139]
    ds_read_b64 v[42:43], v3 offset:26632
    ds_read_b64 v[194:195], v3 offset:27656
    v_mfma_f32_16x16x32_bf16 v[168:171], a[80:83], a[192:195], v[168:171]
    s_add_u32 m0, s17, 73728
    v_mfma_f32_16x16x32_bf16 v[168:171], a[84:87], a[196:199], v[168:171]
    global_load_lds_dwordx4 v4, s[34:35] offset:-3072 sc1
    v_mfma_f32_16x16x32_bf16 v[180:183], a[128:131], a[192:195], v[180:183]
    v_mfma_f32_16x16x32_bf16 v[180:183], a[132:135], a[196:199], v[180:183]
    v_mfma_f32_16x16x32_bf16 v[204:207], a[176:179], a[192:195], v[204:207]
    v_mfma_f32_16x16x32_bf16 v[204:207], a[180:183], a[196:199], v[204:207]
    ds_read_b128 a[208:211], v1 offset:14336
    s_waitcnt lgkmcnt(5)
    v_mfma_f32_16x16x32_bf16 v[136:139], a[40:43], a[244:247], v[136:139]
    ds_read_b128 a[228:231], v1 offset:15360
    v_mfma_f32_16x16x32_bf16 v[136:139], a[44:47], v[28:31], v[136:139]
    global_load_lds_dwordx4 v4, s[34:35] offset:-2048 sc1
    v_mfma_f32_16x16x32_bf16 v[168:171], a[88:91], a[244:247], v[168:171]
    v_mfma_f32_16x16x32_bf16 v[168:171], a[92:95], v[28:31], v[168:171]
    v_mfma_f32_16x16x32_bf16 v[180:183], a[136:139], a[244:247], v[180:183]
    v_mfma_f32_16x16x32_bf16 v[180:183], a[140:143], v[28:31], v[180:183]
    v_mfma_f32_16x16x32_bf16 v[204:207], a[184:187], a[244:247], v[204:207]
    global_load_lds_dwordx4 v4, s[34:35] offset:-1024 sc1
    v_mfma_f32_16x16x32_bf16 v[204:207], a[188:191], v[28:31], v[204:207]
    s_waitcnt lgkmcnt(2)
    v_mfma_f32_16x16x32_bf16 v[124:127], v[244:247], v[48:51], 0
    v_cvt_pk_bf16_f32 v140, v136, v137
    v_cvt_pk_bf16_f32 v141, v138, v139
    v_mfma_f32_16x16x32_bf16 v[124:127], v[40:43], v[196:199], v[124:127]
    v_mfma_f32_16x16x32_bf16 v[172:175], v[156:159], v[48:51], 0
    v_cvt_pk_bf16_f32 v142, v168, v169
    v_cvt_pk_bf16_f32 v143, v170, v171
    v_mfma_f32_16x16x32_bf16 v[172:175], v[192:195], v[196:199], v[172:175]
    ds_read_b128 a[192:195], v1 offset:16384
    v_mfma_f32_16x16x32_bf16 v[176:179], a[0:3], a[248:251], 0
    ds_read_b128 a[196:199], v1 offset:17408
    v_cvt_pk_bf16_f32 v188, v180, v181
    v_mfma_f32_16x16x32_bf16 v[176:179], a[4:7], a[200:203], v[176:179]
    v_cvt_pk_bf16_f32 v189, v182, v183
    v_mfma_f32_16x16x32_bf16 v[220:223], a[48:51], a[248:251], 0
    v_cvt_pk_bf16_f32 v214, v204, v205
    v_cvt_pk_bf16_f32 v215, v206, v207
    v_mfma_f32_16x16x32_bf16 v[220:223], a[52:55], a[200:203], v[220:223]
    ds_write_b64 v13, v[214:215] offset:12288
    v_mfma_f32_16x16x32_bf16 v[228:231], a[96:99], a[248:251], 0
    v_cvt_pk_bf16_f32 v232, v124, v125
    v_cvt_pk_bf16_f32 v233, v126, v127
    v_mfma_f32_16x16x32_bf16 v[228:231], a[100:103], a[200:203], v[228:231]
    global_load_lds_dwordx4 v4, s[34:35] sc1
    v_mfma_f32_16x16x32_bf16 v[236:239], a[144:147], a[248:251], 0
    v_cvt_pk_bf16_f32 v234, v172, v173
    v_cvt_pk_bf16_f32 v235, v174, v175
    v_mfma_f32_16x16x32_bf16 v[236:239], a[148:151], a[200:203], v[236:239]
    ds_read_b128 a[232:235], v1 offset:18432
    v_mfma_f32_16x16x32_bf16 v[248:251], v[244:247], v[88:91], 0
    ds_read_b128 a[244:247], v1 offset:19456
    v_mfma_f32_16x16x32_bf16 v[248:251], v[40:43], v[120:123], v[248:251]
    v_mfma_f32_16x16x32_bf16 v[20:23], v[156:159], v[88:91], 0
    buffer_store_dwordx4 v[232:235], v6, s[8:11], 0 offen offset:448 nt
    v_mfma_f32_16x16x32_bf16 v[20:23], v[192:195], v[120:123], v[20:23]
    s_waitcnt lgkmcnt(5)
    v_mfma_f32_16x16x32_bf16 v[176:179], a[8:11], a[208:211], v[176:179]
    v_mfma_f32_16x16x32_bf16 v[176:179], a[12:15], a[228:231], v[176:179]
    v_mfma_f32_16x16x32_bf16 v[220:223], a[56:59], a[208:211], v[220:223]
    v_mfma_f32_16x16x32_bf16 v[220:223], a[60:63], a[228:231], v[220:223]
    v_mfma_f32_16x16x32_bf16 v[228:231], a[104:107], a[208:211], v[228:231]
    v_cvt_pk_bf16_f32 v60, v248, v249
    v_cvt_pk_bf16_f32 v61, v250, v251
    v_mfma_f32_16x16x32_bf16 v[228:231], a[108:111], a[228:231], v[228:231]
    v_mfma_f32_16x16x32_bf16 v[236:239], a[152:155], a[208:211], v[236:239]
    v_cvt_pk_bf16_f32 v62, v20, v21
    v_cvt_pk_bf16_f32 v63, v22, v23
    v_mfma_f32_16x16x32_bf16 v[236:239], a[156:159], a[228:231], v[236:239]
    v_add_u32 v80, 0, v5
    v_mfma_f32_16x16x32_bf16 v[100:103], v[244:247], v[184:187], 0
    ds_read_b128 a[248:251], v1 offset:20480
    ds_read_b128 a[200:203], v1 offset:21504
    v_mfma_f32_16x16x32_bf16 v[100:103], v[40:43], v[148:151], v[100:103]
    global_load_lds_dwordx4 v4, s[34:35] offset:1024 sc1
    v_mfma_f32_16x16x32_bf16 v[108:111], v[156:159], v[184:187], 0
    v_mfma_f32_16x16x32_bf16 v[108:111], v[192:195], v[148:151], v[108:111]
    s_waitcnt lgkmcnt(5)
    v_mfma_f32_16x16x32_bf16 v[176:179], a[16:19], a[192:195], v[176:179]
    v_mfma_f32_16x16x32_bf16 v[176:179], a[20:23], a[196:199], v[176:179]
    v_mfma_f32_16x16x32_bf16 v[220:223], a[64:67], a[192:195], v[220:223]
    global_load_lds_dwordx4 v4, s[34:35] offset:2048 sc1
    v_mfma_f32_16x16x32_bf16 v[220:223], a[68:71], a[196:199], v[220:223]
    ds_read_b128 a[208:211], v1 offset:22528
    v_add_u32 v4, 24576, v4
    v_mfma_f32_16x16x32_bf16 v[228:231], a[112:115], a[192:195], v[228:231]
    ds_read_b128 a[228:231], v1 offset:23552
    v_cvt_pk_bf16_f32 v116, v100, v101
    v_mfma_f32_16x16x32_bf16 v[228:231], a[116:119], a[196:199], v[228:231]
    v_cvt_pk_bf16_f32 v117, v102, v103
    v_mfma_f32_16x16x32_bf16 v[236:239], a[160:163], a[192:195], v[236:239]
    v_cvt_pk_bf16_f32 v118, v108, v109
    v_cvt_pk_bf16_f32 v119, v110, v111
    v_mfma_f32_16x16x32_bf16 v[236:239], a[164:167], a[196:199], v[236:239]
    s_waitcnt lgkmcnt(4)
    v_mfma_f32_16x16x32_bf16 v[176:179], a[24:27], a[232:235], v[176:179]
    buffer_store_dwordx4 v[60:63], v10, s[8:11], 0 offen offset:448 nt
    v_mfma_f32_16x16x32_bf16 v[176:179], a[28:31], a[244:247], v[176:179]
    v_mfma_f32_16x16x32_bf16 v[220:223], a[72:75], a[232:235], v[220:223]
    v_mfma_f32_16x16x32_bf16 v[220:223], a[76:79], a[244:247], v[220:223]
    ds_read_b128 a[192:195], v1 offset:24576
    ds_read_b128 a[196:199], v1 offset:25600
    v_mfma_f32_16x16x32_bf16 v[228:231], a[120:123], a[232:235], v[228:231]
    v_mfma_f32_16x16x32_bf16 v[228:231], a[124:127], a[244:247], v[228:231]
    v_mfma_f32_16x16x32_bf16 v[236:239], a[168:171], a[232:235], v[236:239]
    v_mfma_f32_16x16x32_bf16 v[236:239], a[172:175], a[244:247], v[236:239]
    v_mfma_f32_16x16x32_bf16 v[144:147], v[244:247], v[132:135], 0
    v_mfma_f32_16x16x32_bf16 v[144:147], v[40:43], v[68:71], v[144:147]
    global_load_dwordx4 v[160:163], v80, s[14:15] offset:-4096 sc1
    v_mfma_f32_16x16x32_bf16 v[200:203], v[156:159], v[132:135], 0
    v_mfma_f32_16x16x32_bf16 v[200:203], v[192:195], v[68:71], v[200:203]
    s_waitcnt lgkmcnt(4)
    v_mfma_f32_16x16x32_bf16 v[176:179], a[32:35], a[248:251], v[176:179]
    v_mfma_f32_16x16x32_bf16 v[176:179], a[36:39], a[200:203], v[176:179]
    v_mfma_f32_16x16x32_bf16 v[220:223], a[80:83], a[248:251], v[220:223]
    buffer_store_dwordx4 v[116:119], v7, s[8:11], 0 offen offset:448 nt
    v_mfma_f32_16x16x32_bf16 v[220:223], a[84:87], a[200:203], v[220:223]
    ds_read_b128 a[232:235], v3 offset:24576
    ds_read_b128 a[244:247], v1 offset:26624
    v_mfma_f32_16x16x32_bf16 v[228:231], a[128:131], a[248:251], v[228:231]
    ds_read_b128 v[208:211], v3 offset:26624
    ds_read_b128 v[252:255], v1 offset:27648
    v_mfma_f32_16x16x32_bf16 v[228:231], a[132:135], a[200:203], v[228:231]
    ds_read_b128 v[24:27], v3 offset:25600
    v_cvt_pk_bf16_f32 v32, v144, v145
    v_mfma_f32_16x16x32_bf16 v[236:239], a[176:179], a[248:251], v[236:239]
    ds_read_b128 v[36:39], v3 offset:27648
    v_cvt_pk_bf16_f32 v33, v146, v147
    v_mfma_f32_16x16x32_bf16 v[236:239], a[180:183], a[200:203], v[236:239]
    v_cvt_pk_bf16_f32 v34, v200, v201
    s_waitcnt lgkmcnt(8)
    v_mfma_f32_16x16x32_bf16 v[176:179], a[40:43], a[208:211], v[176:179]
    v_cvt_pk_bf16_f32 v35, v202, v203
    v_mfma_f32_16x16x32_bf16 v[176:179], a[44:47], a[228:231], v[176:179]
L_st8:
    s_cbranch_execz L_stdone
    v_mfma_f32_16x16x32_bf16 v[220:223], a[88:91], a[208:211], v[220:223]
    v_mfma_f32_16x16x32_bf16 v[220:223], a[92:95], a[228:231], v[220:223]
    global_load_dwordx4 a[200:203], v80, s[14:15] offset:-3072 sc1
    v_mfma_f32_16x16x32_bf16 v[228:231], a[136:139], a[208:211], v[228:231]
    ds_read_b128 a[248:251], v1 offset:28672
    ds_read_b128 v[44:47], v1 offset:29696
    v_mfma_f32_16x16x32_bf16 v[228:231], a[140:143], a[228:231], v[228:231]
    v_mfma_f32_16x16x32_bf16 v[236:239], a[184:187], a[208:211], v[236:239]
    v_mfma_f32_16x16x32_bf16 v[236:239], a[188:191], a[228:231], v[236:239]
    s_waitcnt lgkmcnt(8)
    v_mfma_f32_16x16x32_bf16 v[56:59], a[0:3], a[192:195], 0
    global_load_dwordx4 v[64:67], v80, s[14:15] offset:-2048 sc1
    v_mfma_f32_16x16x32_bf16 v[56:59], a[4:7], a[196:199], v[56:59]
    v_cvt_pk_bf16_f32 v84, v176, v177
    v_cvt_pk_bf16_f32 v85, v178, v179
    v_mfma_f32_16x16x32_bf16 v[92:95], a[48:51], a[192:195], 0
    v_cvt_pk_bf16_f32 v86, v220, v221
    v_cvt_pk_bf16_f32 v87, v222, v223
    v_mfma_f32_16x16x32_bf16 v[92:95], a[52:55], a[196:199], v[92:95]
    ds_read_b128 a[208:211], v1 offset:30720
    ds_read_b128 a[228:231], v1 offset:31744
    v_mfma_f32_16x16x32_bf16 v[96:99], a[96:99], a[192:195], 0
    v_cvt_pk_bf16_f32 v104, v228, v229
    v_cvt_pk_bf16_f32 v105, v230, v231
    v_mfma_f32_16x16x32_bf16 v[96:99], a[100:103], a[196:199], v[96:99]
    buffer_store_dwordx4 v[32:35], v8, s[8:11], 0 offen offset:448 nt
    v_mfma_f32_16x16x32_bf16 v[128:131], a[144:147], a[192:195], 0
    v_cvt_pk_bf16_f32 v82, v236, v237
    v_cvt_pk_bf16_f32 v83, v238, v239
    v_mfma_f32_16x16x32_bf16 v[128:131], a[148:151], a[196:199], v[128:131]
    s_waitcnt lgkmcnt(4)
    v_mfma_f32_16x16x32_bf16 v[216:219], a[232:235], v[164:167], 0
    ds_write_b64 v13, v[82:83] offset:13312
    v_mfma_f32_16x16x32_bf16 v[216:219], v[208:211], v[76:79], v[216:219]
    v_mfma_f32_16x16x32_bf16 v[224:227], v[24:27], v[164:167], 0
    v_mfma_f32_16x16x32_bf16 v[224:227], v[36:39], v[76:79], v[224:227]
    ds_read_b128 a[192:195], v1 offset:32768
    v_mfma_f32_16x16x32_bf16 v[56:59], a[8:11], a[244:247], v[56:59]
    ds_read_b128 a[196:199], v1 offset:33792
    v_mfma_f32_16x16x32_bf16 v[56:59], a[12:15], v[252:255], v[56:59]
    v_mfma_f32_16x16x32_bf16 v[92:95], a[56:59], a[244:247], v[92:95]
    global_load_dwordx4 a[232:235], v80, s[14:15] offset:-1024 sc1
    v_mfma_f32_16x16x32_bf16 v[92:95], a[60:63], v[252:255], v[92:95]
    v_mfma_f32_16x16x32_bf16 v[96:99], a[104:107], a[244:247], v[96:99]
    v_cvt_pk_bf16_f32 v240, v216, v217
    v_cvt_pk_bf16_f32 v241, v218, v219
    v_mfma_f32_16x16x32_bf16 v[96:99], a[108:111], v[252:255], v[96:99]
    v_mfma_f32_16x16x32_bf16 v[128:131], a[152:155], a[244:247], v[128:131]
    v_cvt_pk_bf16_f32 v242, v224, v225
    v_cvt_pk_bf16_f32 v243, v226, v227
    v_mfma_f32_16x16x32_bf16 v[128:131], a[156:159], v[252:255], v[128:131]
    ds_read_b128 v[28:31], v1 offset:34816
    s_waitcnt lgkmcnt(6)
    v_mfma_f32_16x16x32_bf16 v[56:59], a[16:19], a[248:251], v[56:59]
    ds_read_b128 v[124:127], v1 offset:35840
    v_mfma_f32_16x16x32_bf16 v[56:59], a[20:23], v[44:47], v[56:59]
    global_load_dwordx4 a[244:247], v80, s[14:15] sc1
    v_mfma_f32_16x16x32_bf16 v[92:95], a[64:67], a[248:251], v[92:95]
    v_mfma_f32_16x16x32_bf16 v[92:95], a[68:71], v[44:47], v[92:95]
    v_mfma_f32_16x16x32_bf16 v[96:99], a[112:115], a[248:251], v[96:99]
    v_mfma_f32_16x16x32_bf16 v[96:99], a[116:119], v[44:47], v[96:99]
    v_mfma_f32_16x16x32_bf16 v[128:131], a[160:163], a[248:251], v[128:131]
    buffer_store_dwordx4 v[240:243], v11, s[8:11], 0 offen offset:448 nt
    v_mfma_f32_16x16x32_bf16 v[128:131], a[164:167], v[44:47], v[128:131]
    s_waitcnt lgkmcnt(5)
    v_mfma_f32_16x16x32_bf16 v[56:59], a[24:27], a[208:211], v[56:59]
    v_mfma_f32_16x16x32_bf16 v[56:59], a[28:31], a[228:231], v[56:59]
    v_mfma_f32_16x16x32_bf16 v[92:95], a[72:75], a[208:211], v[92:95]
    v_mfma_f32_16x16x32_bf16 v[92:95], a[76:79], a[228:231], v[92:95]
    ds_read_b128 a[248:251], v1 offset:36864
    v_add_u32 v81, 6144, v5
    v_mfma_f32_16x16x32_bf16 v[96:99], a[120:123], a[208:211], v[96:99]
    ds_read_b128 v[136:139], v1 offset:37888
    v_mfma_f32_16x16x32_bf16 v[96:99], a[124:127], a[228:231], v[96:99]
    v_mfma_f32_16x16x32_bf16 v[128:131], a[168:171], a[208:211], v[128:131]
    v_mfma_f32_16x16x32_bf16 v[128:131], a[172:175], a[228:231], v[128:131]
    s_waitcnt lgkmcnt(4)
    v_mfma_f32_16x16x32_bf16 v[56:59], a[32:35], a[192:195], v[56:59]
    s_waitcnt vmcnt(20)
    s_barrier
    v_mfma_f32_16x16x32_bf16 v[56:59], a[36:39], a[196:199], v[56:59]
    ds_read_b64 v[190:191], v3 offset:30728
    ds_read_b64 v[106:107], v3 offset:31752
    v_mfma_f32_16x16x32_bf16 v[92:95], a[80:83], a[192:195], v[92:95]
    global_load_dwordx4 a[208:211], v80, s[14:15] offset:1024 sc1
    v_mfma_f32_16x16x32_bf16 v[92:95], a[84:87], a[196:199], v[92:95]
    v_mfma_f32_16x16x32_bf16 v[96:99], a[128:131], a[192:195], v[96:99]
    v_mfma_f32_16x16x32_bf16 v[96:99], a[132:135], a[196:199], v[96:99]
    v_mfma_f32_16x16x32_bf16 v[128:131], a[176:179], a[192:195], v[128:131]
    v_mfma_f32_16x16x32_bf16 v[128:131], a[180:183], a[196:199], v[128:131]
    ds_read_b128 a[228:231], v1 offset:38912
    s_waitcnt lgkmcnt(5)
    v_mfma_f32_16x16x32_bf16 v[56:59], a[40:43], v[28:31], v[56:59]
    ds_read_b128 v[168:171], v1 offset:39936
    v_mfma_f32_16x16x32_bf16 v[56:59], a[44:47], v[124:127], v[56:59]
    global_load_dwordx4 v[172:175], v81, s[14:15] offset:-4096 sc1
    v_mfma_f32_16x16x32_bf16 v[92:95], a[88:91], v[28:31], v[92:95]
    v_mfma_f32_16x16x32_bf16 v[92:95], a[92:95], v[124:127], v[92:95]
    v_mfma_f32_16x16x32_bf16 v[96:99], a[136:139], v[28:31], v[96:99]
    v_mfma_f32_16x16x32_bf16 v[96:99], a[140:143], v[124:127], v[96:99]
    v_mfma_f32_16x16x32_bf16 v[128:131], a[184:187], v[28:31], v[128:131]
    global_load_dwordx4 a[192:195], v81, s[14:15] offset:-3072 sc1
    v_mfma_f32_16x16x32_bf16 v[128:131], a[188:191], v[124:127], v[128:131]
    s_waitcnt lgkmcnt(2)
    v_mfma_f32_16x16x32_bf16 v[180:183], v[140:143], v[48:51], 0
    v_cvt_pk_bf16_f32 v204, v56, v57
    v_cvt_pk_bf16_f32 v205, v58, v59
    v_mfma_f32_16x16x32_bf16 v[180:183], v[188:191], v[196:199], v[180:183]
    v_mfma_f32_16x16x32_bf16 v[212:215], v[84:87], v[48:51], 0
    v_cvt_pk_bf16_f32 v206, v92, v93
    v_cvt_pk_bf16_f32 v207, v94, v95
    v_mfma_f32_16x16x32_bf16 v[212:215], v[104:107], v[196:199], v[212:215]
    ds_read_b128 a[196:199], v1 offset:40960
    v_mfma_f32_16x16x32_bf16 v[20:23], a[0:3], a[248:251], 0
    ds_read_b128 v[40:43], v1 offset:41984
    v_cvt_pk_bf16_f32 v60, v96, v97
    v_mfma_f32_16x16x32_bf16 v[20:23], a[4:7], v[136:139], v[20:23]
    v_cvt_pk_bf16_f32 v61, v98, v99
    v_mfma_f32_16x16x32_bf16 v[100:103], a[48:51], a[248:251], 0
    v_cvt_pk_bf16_f32 v82, v128, v129
    v_cvt_pk_bf16_f32 v83, v130, v131
    v_mfma_f32_16x16x32_bf16 v[100:103], a[52:55], v[136:139], v[100:103]
    ds_write_b64 v13, v[82:83]
    v_mfma_f32_16x16x32_bf16 v[108:111], a[96:99], a[248:251], 0
    v_cvt_pk_bf16_f32 v116, v180, v181
    v_cvt_pk_bf16_f32 v117, v182, v183
    v_mfma_f32_16x16x32_bf16 v[108:111], a[100:103], v[136:139], v[108:111]
    global_load_dwordx4 v[156:159], v81, s[14:15] offset:-2048 sc1
    v_mfma_f32_16x16x32_bf16 v[192:195], a[144:147], a[248:251], 0
    v_cvt_pk_bf16_f32 v118, v212, v213
    v_cvt_pk_bf16_f32 v119, v214, v215
    v_mfma_f32_16x16x32_bf16 v[192:195], a[148:151], v[136:139], v[192:195]
    ds_read_b128 v[232:235], v1 offset:43008
    v_mfma_f32_16x16x32_bf16 v[244:247], v[140:143], v[88:91], 0
    ds_read_b128 v[248:251], v1 offset:44032
    v_mfma_f32_16x16x32_bf16 v[244:247], v[188:191], v[120:123], v[244:247]
    v_mfma_f32_16x16x32_bf16 v[24:27], v[84:87], v[88:91], 0
    buffer_store_dwordx4 v[116:119], v6, s[8:11], 0 offen offset:512 nt
    v_mfma_f32_16x16x32_bf16 v[24:27], v[104:107], v[120:123], v[24:27]
    s_waitcnt lgkmcnt(5)
    v_mfma_f32_16x16x32_bf16 v[20:23], a[8:11], a[228:231], v[20:23]
    v_mfma_f32_16x16x32_bf16 v[20:23], a[12:15], v[168:171], v[20:23]
    v_mfma_f32_16x16x32_bf16 v[100:103], a[56:59], a[228:231], v[100:103]
    v_mfma_f32_16x16x32_bf16 v[100:103], a[60:63], v[168:171], v[100:103]
    v_mfma_f32_16x16x32_bf16 v[108:111], a[104:107], a[228:231], v[108:111]
    v_cvt_pk_bf16_f32 v32, v244, v245
    v_cvt_pk_bf16_f32 v33, v246, v247
    v_mfma_f32_16x16x32_bf16 v[108:111], a[108:111], v[168:171], v[108:111]
    v_mfma_f32_16x16x32_bf16 v[192:195], a[152:155], a[228:231], v[192:195]
    v_cvt_pk_bf16_f32 v34, v24, v25
    v_cvt_pk_bf16_f32 v35, v26, v27
    v_mfma_f32_16x16x32_bf16 v[192:195], a[156:159], v[168:171], v[192:195]
    ds_read_b128 a[248:251], v1 offset:45056
    v_mfma_f32_16x16x32_bf16 v[36:39], v[140:143], v[184:187], 0
    ds_read_b128 v[144:147], v1 offset:46080
    v_mfma_f32_16x16x32_bf16 v[36:39], v[188:191], v[148:151], v[36:39]
    global_load_dwordx4 a[228:231], v81, s[14:15] offset:-1024 sc1
    v_mfma_f32_16x16x32_bf16 v[176:179], v[84:87], v[184:187], 0
    v_mfma_f32_16x16x32_bf16 v[176:179], v[104:107], v[148:151], v[176:179]
    s_waitcnt lgkmcnt(5)
    v_mfma_f32_16x16x32_bf16 v[20:23], a[16:19], a[196:199], v[20:23]
    v_mfma_f32_16x16x32_bf16 v[20:23], a[20:23], v[40:43], v[20:23]
    v_mfma_f32_16x16x32_bf16 v[100:103], a[64:67], a[196:199], v[100:103]
    buffer_store_dwordx4 v[32:35], v10, s[8:11], 0 offen offset:512 nt
    v_mfma_f32_16x16x32_bf16 v[100:103], a[68:71], v[40:43], v[100:103]
    ds_read_b128 v[200:203], v1 offset:47104
    ds_read_b128 v[208:211], v1 offset:48128
    v_mfma_f32_16x16x32_bf16 v[108:111], a[112:115], a[196:199], v[108:111]
    v_cvt_pk_bf16_f32 v216, v36, v37
    v_cvt_pk_bf16_f32 v217, v38, v39
    v_mfma_f32_16x16x32_bf16 v[108:111], a[116:119], v[40:43], v[108:111]
    v_mfma_f32_16x16x32_bf16 v[192:195], a[160:163], a[196:199], v[192:195]
    v_cvt_pk_bf16_f32 v218, v176, v177
    v_cvt_pk_bf16_f32 v219, v178, v179
    v_mfma_f32_16x16x32_bf16 v[192:195], a[164:167], v[40:43], v[192:195]
    s_waitcnt lgkmcnt(4)
    v_mfma_f32_16x16x32_bf16 v[20:23], a[24:27], v[232:235], v[20:23]
    v_mfma_f32_16x16x32_bf16 v[20:23], a[28:31], v[248:251], v[20:23]
    v_mfma_f32_16x16x32_bf16 v[100:103], a[72:75], v[232:235], v[100:103]
    v_mfma_f32_16x16x32_bf16 v[100:103], a[76:79], v[248:251], v[100:103]
    ds_read_b128 a[196:199], v1 offset:49152
    ds_read_b128 v[220:223], v1 offset:50176
    v_mfma_f32_16x16x32_bf16 v[108:111], a[120:123], v[232:235], v[108:111]
    global_load_dwordx4 v[228:231], v81, s[14:15] sc1
    v_mfma_f32_16x16x32_bf16 v[108:111], a[124:127], v[248:251], v[108:111]
    v_mfma_f32_16x16x32_bf16 v[192:195], a[168:171], v[232:235], v[192:195]
    v_mfma_f32_16x16x32_bf16 v[192:195], a[172:175], v[248:251], v[192:195]
    v_mfma_f32_16x16x32_bf16 v[236:239], v[140:143], v[132:135], 0
    v_mfma_f32_16x16x32_bf16 v[236:239], v[188:191], v[68:71], v[236:239]
    buffer_store_dwordx4 v[216:219], v7, s[8:11], 0 offen offset:512 nt
    v_mfma_f32_16x16x32_bf16 v[28:31], v[84:87], v[132:135], 0
    v_mfma_f32_16x16x32_bf16 v[28:31], v[104:107], v[68:71], v[28:31]
    s_waitcnt lgkmcnt(4)
    v_mfma_f32_16x16x32_bf16 v[20:23], a[32:35], a[248:251], v[20:23]
    v_mfma_f32_16x16x32_bf16 v[20:23], a[36:39], v[144:147], v[20:23]
    v_mfma_f32_16x16x32_bf16 v[100:103], a[80:83], a[248:251], v[100:103]
    v_mfma_f32_16x16x32_bf16 v[100:103], a[84:87], v[144:147], v[100:103]
    ds_read_b128 v[44:47], v3 offset:28672
    v_add_u32 v80, 49152, v5
    v_mfma_f32_16x16x32_bf16 v[108:111], a[128:131], a[248:251], v[108:111]
    ds_read_b128 v[56:59], v3 offset:30720
    ds_read_b128 v[92:95], v1 offset:51200
    v_mfma_f32_16x16x32_bf16 v[108:111], a[132:135], v[144:147], v[108:111]
    ds_read_b128 v[96:99], v3 offset:29696
    ds_read_b128 v[124:127], v1 offset:52224
    v_mfma_f32_16x16x32_bf16 v[192:195], a[176:179], a[248:251], v[192:195]
    ds_read_b128 v[224:227], v3 offset:31744
    v_cvt_pk_bf16_f32 v240, v236, v237
    v_mfma_f32_16x16x32_bf16 v[192:195], a[180:183], v[144:147], v[192:195]
    v_cvt_pk_bf16_f32 v241, v238, v239
    s_waitcnt lgkmcnt(8)
    v_mfma_f32_16x16x32_bf16 v[20:23], a[40:43], v[200:203], v[20:23]
    v_cvt_pk_bf16_f32 v242, v28, v29
    v_cvt_pk_bf16_f32 v243, v30, v31
    v_mfma_f32_16x16x32_bf16 v[20:23], a[44:47], v[208:211], v[20:23]
    global_load_dwordx4 a[248:251], v81, s[14:15] offset:1024 sc1
    v_mfma_f32_16x16x32_bf16 v[100:103], a[88:91], v[200:203], v[100:103]
    v_mfma_f32_16x16x32_bf16 v[100:103], a[92:95], v[208:211], v[100:103]
    ds_read_b128 v[252:255], v1 offset:53248
    ds_read_b128 v[24:27], v1 offset:54272
    v_mfma_f32_16x16x32_bf16 v[108:111], a[136:139], v[200:203], v[108:111]
    v_mfma_f32_16x16x32_bf16 v[108:111], a[140:143], v[208:211], v[108:111]
    v_mfma_f32_16x16x32_bf16 v[192:195], a[184:187], v[200:203], v[192:195]
    buffer_store_dwordx4 v[240:243], v8, s[8:11], 0 offen offset:512 nt
    v_mfma_f32_16x16x32_bf16 v[192:195], a[188:191], v[208:211], v[192:195]
    s_waitcnt lgkmcnt(8)
    v_mfma_f32_16x16x32_bf16 v[32:35], a[0:3], a[196:199], 0
    v_cvt_pk_bf16_f32 v36, v20, v21
    v_cvt_pk_bf16_f32 v37, v22, v23
    v_mfma_f32_16x16x32_bf16 v[32:35], a[4:7], v[220:223], v[32:35]
    v_mfma_f32_16x16x32_bf16 v[40:43], a[48:51], a[196:199], 0
    v_cvt_pk_bf16_f32 v38, v100, v101
    v_cvt_pk_bf16_f32 v39, v102, v103
    v_mfma_f32_16x16x32_bf16 v[40:43], a[52:55], v[220:223], v[40:43]
    ds_read_b128 v[116:119], v1 offset:55296
    ds_read_b128 v[128:131], v1 offset:56320
    v_mfma_f32_16x16x32_bf16 v[136:139], a[96:99], a[196:199], 0
    v_cvt_pk_bf16_f32 v168, v108, v109
    v_cvt_pk_bf16_f32 v169, v110, v111
    v_mfma_f32_16x16x32_bf16 v[136:139], a[100:103], v[220:223], v[136:139]
    v_mfma_f32_16x16x32_bf16 v[176:179], a[144:147], a[196:199], 0
    v_cvt_pk_bf16_f32 v82, v192, v193
    v_cvt_pk_bf16_f32 v83, v194, v195
    v_mfma_f32_16x16x32_bf16 v[176:179], a[148:151], v[220:223], v[176:179]
    s_waitcnt lgkmcnt(4)
    v_mfma_f32_16x16x32_bf16 v[180:183], v[44:47], v[164:167], 0
    global_load_dwordx4 v[212:215], v80, s[14:15] offset:-4096 sc1
    v_mfma_f32_16x16x32_bf16 v[180:183], v[56:59], v[76:79], v[180:183]
    ds_write_b64 v13, v[82:83] offset:1024
    v_mfma_f32_16x16x32_bf16 v[232:235], v[96:99], v[164:167], 0
    v_mfma_f32_16x16x32_bf16 v[232:235], v[224:227], v[76:79], v[232:235]
    ds_read_b128 a[196:199], v1 offset:57344
    v_mfma_f32_16x16x32_bf16 v[32:35], a[8:11], v[92:95], v[32:35]
    ds_read_b128 v[244:247], v1 offset:58368
    v_mfma_f32_16x16x32_bf16 v[32:35], a[12:15], v[124:127], v[32:35]
    global_load_dwordx4 v[20:23], v80, s[14:15] offset:-3072 sc1
    v_mfma_f32_16x16x32_bf16 v[40:43], a[56:59], v[92:95], v[40:43]
    v_mfma_f32_16x16x32_bf16 v[40:43], a[60:63], v[124:127], v[40:43]
    v_mfma_f32_16x16x32_bf16 v[136:139], a[104:107], v[92:95], v[136:139]
    v_cvt_pk_bf16_f32 v28, v180, v181
    v_cvt_pk_bf16_f32 v29, v182, v183
    v_mfma_f32_16x16x32_bf16 v[136:139], a[108:111], v[124:127], v[136:139]
    v_mfma_f32_16x16x32_bf16 v[176:179], a[152:155], v[92:95], v[176:179]
    v_cvt_pk_bf16_f32 v30, v232, v233
    v_cvt_pk_bf16_f32 v31, v234, v235
    v_mfma_f32_16x16x32_bf16 v[176:179], a[156:159], v[124:127], v[176:179]
    ds_read_b128 v[44:47], v1 offset:59392
    s_waitcnt lgkmcnt(6)
    v_mfma_f32_16x16x32_bf16 v[32:35], a[16:19], v[252:255], v[32:35]
    ds_read_b128 v[56:59], v1 offset:60416
    v_mfma_f32_16x16x32_bf16 v[32:35], a[20:23], v[24:27], v[32:35]
    global_load_dwordx4 v[84:87], v80, s[14:15] offset:-2048 sc1
    v_mfma_f32_16x16x32_bf16 v[40:43], a[64:67], v[252:255], v[40:43]
    v_mfma_f32_16x16x32_bf16 v[40:43], a[68:71], v[24:27], v[40:43]
    v_mfma_f32_16x16x32_bf16 v[136:139], a[112:115], v[252:255], v[136:139]
    v_mfma_f32_16x16x32_bf16 v[136:139], a[116:119], v[24:27], v[136:139]
    v_mfma_f32_16x16x32_bf16 v[176:179], a[160:163], v[252:255], v[176:179]
    buffer_store_dwordx4 v[28:31], v11, s[8:11], 0 offen offset:512 nt
    v_mfma_f32_16x16x32_bf16 v[176:179], a[164:167], v[24:27], v[176:179]
    s_waitcnt lgkmcnt(5)
    v_mfma_f32_16x16x32_bf16 v[32:35], a[24:27], v[116:119], v[32:35]
    v_mfma_f32_16x16x32_bf16 v[32:35], a[28:31], v[128:131], v[32:35]
    v_mfma_f32_16x16x32_bf16 v[40:43], a[72:75], v[116:119], v[40:43]
    v_mfma_f32_16x16x32_bf16 v[40:43], a[76:79], v[128:131], v[40:43]
    v_mfma_f32_16x16x32_bf16 v[136:139], a[120:123], v[116:119], v[136:139]
    v_mfma_f32_16x16x32_bf16 v[136:139], a[124:127], v[128:131], v[136:139]
    v_mfma_f32_16x16x32_bf16 v[176:179], a[168:171], v[116:119], v[176:179]
    v_mfma_f32_16x16x32_bf16 v[176:179], a[172:175], v[128:131], v[176:179]
    ds_read_b128 v[96:99], v1 offset:61440
    s_waitcnt lgkmcnt(3)
    v_mfma_f32_16x16x32_bf16 v[32:35], a[32:35], a[196:199], v[32:35]
    s_waitcnt vmcnt(24)
    s_barrier
    v_mfma_f32_16x16x32_bf16 v[32:35], a[36:39], v[244:247], v[32:35]
    ds_read_b64 v[62:63], v3 offset:18440
    ds_read_b64 v[170:171], v3 offset:19464
    v_mfma_f32_16x16x32_bf16 v[40:43], a[80:83], a[196:199], v[40:43]
    ds_read_b128 v[100:103], v1 offset:62464
    v_mfma_f32_16x16x32_bf16 v[40:43], a[84:87], v[244:247], v[40:43]
    global_load_dwordx4 v[104:107], v80, s[14:15] offset:-1024 sc1
    v_mfma_f32_16x16x32_bf16 v[136:139], a[128:131], a[196:199], v[136:139]
    v_mfma_f32_16x16x32_bf16 v[136:139], a[132:135], v[244:247], v[136:139]
    v_mfma_f32_16x16x32_bf16 v[176:179], a[176:179], a[196:199], v[176:179]
    v_mfma_f32_16x16x32_bf16 v[176:179], a[180:183], v[244:247], v[176:179]
    s_waitcnt lgkmcnt(4)
    v_mfma_f32_16x16x32_bf16 v[32:35], a[40:43], v[44:47], v[32:35]
    global_load_dwordx4 v[108:111], v80, s[14:15] sc1
    v_mfma_f32_16x16x32_bf16 v[32:35], a[44:47], v[56:59], v[32:35]
    v_mfma_f32_16x16x32_bf16 v[40:43], a[88:91], v[44:47], v[40:43]
    v_mfma_f32_16x16x32_bf16 v[40:43], a[92:95], v[56:59], v[40:43]
    ds_read_b128 a[196:199], v1 offset:63488
    ds_read_b128 v[140:143], v1 offset:64512
    v_mfma_f32_16x16x32_bf16 v[136:139], a[136:139], v[44:47], v[136:139]
    v_mfma_f32_16x16x32_bf16 v[136:139], a[140:143], v[56:59], v[136:139]
    v_mfma_f32_16x16x32_bf16 v[176:179], a[184:187], v[44:47], v[176:179]
    v_mfma_f32_16x16x32_bf16 v[176:179], a[188:191], v[56:59], v[176:179]
    s_waitcnt lgkmcnt(3)
    v_mfma_f32_16x16x32_bf16 v[144:147], v[204:207], v[48:51], 0
    v_cvt_pk_bf16_f32 v188, v32, v33
    v_cvt_pk_bf16_f32 v189, v34, v35
    v_mfma_f32_16x16x32_bf16 v[144:147], v[60:63], v[196:199], v[144:147]
    global_load_dwordx4 v[192:195], v80, s[14:15] offset:1024 sc1
    v_mfma_f32_16x16x32_bf16 v[200:203], v[36:39], v[48:51], 0
    v_cvt_pk_bf16_f32 v190, v40, v41
    v_cvt_pk_bf16_f32 v191, v42, v43
    v_mfma_f32_16x16x32_bf16 v[200:203], v[168:171], v[196:199], v[200:203]
    s_waitcnt vmcnt(20)
    v_mfma_f32_16x16x32_bf16 v[208:211], v[160:163], a[220:223], 0
    v_cvt_pk_bf16_f32 v216, v136, v137
    v_cvt_pk_bf16_f32 v217, v138, v139
    v_mfma_f32_16x16x32_bf16 v[208:211], a[200:203], a[224:227], v[208:211]
    v_mfma_f32_16x16x32_bf16 v[208:211], v[64:67], a[236:239], v[208:211]
    v_cvt_pk_bf16_f32 v82, v176, v177
    v_cvt_pk_bf16_f32 v83, v178, v179
    v_mfma_f32_16x16x32_bf16 v[208:211], a[232:235], a[240:243], v[208:211]
    v_add_u32 v81, 55296, v5
    s_waitcnt lgkmcnt(2)
    v_mfma_f32_16x16x32_bf16 v[220:223], a[0:3], v[96:99], 0
    ds_write_b64 v13, v[82:83] offset:4096
    v_mfma_f32_16x16x32_bf16 v[220:223], a[4:7], v[100:103], v[220:223]
    v_cvt_pk_bf16_f32 v224, v144, v145
    v_cvt_pk_bf16_f32 v225, v146, v147
    v_mfma_f32_16x16x32_bf16 v[236:239], a[48:51], v[96:99], 0
    v_cvt_pk_bf16_f32 v226, v200, v201
    v_cvt_pk_bf16_f32 v227, v202, v203
    v_mfma_f32_16x16x32_bf16 v[236:239], a[52:55], v[100:103], v[236:239]
    ds_read_b128 a[200:203], v2
    ds_read_b128 a[232:235], v2 offset:1024
    v_mfma_f32_16x16x32_bf16 v[240:243], a[96:99], v[96:99], 0
    buffer_store_dwordx4 v[224:227], v6, s[8:11], 0 offen offset:576 nt
    v_mfma_f32_16x16x32_bf16 v[240:243], a[100:103], v[100:103], v[240:243]
    v_mfma_f32_16x16x32_bf16 v[248:251], a[144:147], v[96:99], 0
    v_mfma_f32_16x16x32_bf16 v[248:251], a[148:151], v[100:103], v[248:251]
    v_mfma_f32_16x16x32_bf16 v[24:27], v[204:207], v[88:91], 0
    v_mfma_f32_16x16x32_bf16 v[24:27], v[60:63], v[120:123], v[24:27]
    v_mfma_f32_16x16x32_bf16 v[28:31], v[36:39], v[88:91], 0
    v_mfma_f32_16x16x32_bf16 v[28:31], v[168:171], v[120:123], v[28:31]
    ds_read_b128 v[32:35], v2 offset:2048
    s_waitcnt lgkmcnt(4)
    v_mfma_f32_16x16x32_bf16 v[220:223], a[8:11], a[196:199], v[220:223]
    ds_read_b128 v[44:47], v2 offset:3072
    v_mfma_f32_16x16x32_bf16 v[220:223], a[12:15], v[140:143], v[220:223]
    global_load_dwordx4 v[56:59], v81, s[14:15] offset:-4096 sc1
    v_mfma_f32_16x16x32_bf16 v[236:239], a[56:59], a[196:199], v[236:239]
    v_mfma_f32_16x16x32_bf16 v[236:239], a[60:63], v[140:143], v[236:239]
    v_mfma_f32_16x16x32_bf16 v[240:243], a[104:107], a[196:199], v[240:243]
    v_cvt_pk_bf16_f32 v92, v24, v25
    v_cvt_pk_bf16_f32 v93, v26, v27
    v_mfma_f32_16x16x32_bf16 v[240:243], a[108:111], v[140:143], v[240:243]
    v_mfma_f32_16x16x32_bf16 v[248:251], a[152:155], a[196:199], v[248:251]
    v_cvt_pk_bf16_f32 v94, v28, v29
    v_cvt_pk_bf16_f32 v95, v30, v31
    v_mfma_f32_16x16x32_bf16 v[248:251], a[156:159], v[140:143], v[248:251]
    v_mfma_f32_16x16x32_bf16 v[116:119], v[204:207], v[184:187], 0
    global_load_dwordx4 v[124:127], v81, s[14:15] offset:-3072 sc1
    v_mfma_f32_16x16x32_bf16 v[116:119], v[60:63], v[148:151], v[116:119]
    v_mfma_f32_16x16x32_bf16 v[128:131], v[36:39], v[184:187], 0
    v_mfma_f32_16x16x32_bf16 v[128:131], v[168:171], v[148:151], v[128:131]
    s_waitcnt vmcnt(18)
    v_mfma_f32_16x16x32_bf16 v[208:211], a[244:247], v[52:55], v[208:211]
    v_mfma_f32_16x16x32_bf16 v[208:211], a[208:211], a[252:255], v[208:211]
    buffer_store_dwordx4 v[92:95], v10, s[8:11], 0 offen offset:576 nt
    v_mfma_f32_16x16x32_bf16 v[208:211], v[172:175], v[72:75], v[208:211]
    v_mfma_f32_16x16x32_bf16 v[208:211], a[192:195], a[204:207], v[208:211]
    ds_read_b128 a[196:199], v2 offset:4096
    s_waitcnt lgkmcnt(3)
    v_mfma_f32_16x16x32_bf16 v[220:223], a[16:19], a[200:203], v[220:223]
    ds_read_b128 a[244:247], v2 offset:5120
    v_cvt_pk_bf16_f32 v180, v116, v117
    v_mfma_f32_16x16x32_bf16 v[220:223], a[20:23], a[232:235], v[220:223]
    v_cvt_pk_bf16_f32 v181, v118, v119
    v_mfma_f32_16x16x32_bf16 v[236:239], a[64:67], a[200:203], v[236:239]
    v_cvt_pk_bf16_f32 v182, v128, v129
    v_cvt_pk_bf16_f32 v183, v130, v131
    v_mfma_f32_16x16x32_bf16 v[236:239], a[68:71], a[232:235], v[236:239]
    v_mfma_f32_16x16x32_bf16 v[240:243], a[112:115], a[200:203], v[240:243]
    v_mfma_f32_16x16x32_bf16 v[240:243], a[116:119], a[232:235], v[240:243]
    v_mfma_f32_16x16x32_bf16 v[248:251], a[160:163], a[200:203], v[248:251]
    global_load_dwordx4 a[192:195], v81, s[14:15] offset:-2048 sc1
    v_mfma_f32_16x16x32_bf16 v[248:251], a[164:167], a[232:235], v[248:251]
    ds_read_b128 a[208:211], v2 offset:6144
    s_waitcnt lgkmcnt(3)
    v_mfma_f32_16x16x32_bf16 v[220:223], a[24:27], v[32:35], v[220:223]
    ds_read_b128 v[232:235], v2 offset:7168
    v_mfma_f32_16x16x32_bf16 v[220:223], a[28:31], v[44:47], v[220:223]
    v_mfma_f32_16x16x32_bf16 v[236:239], a[72:75], v[32:35], v[236:239]
    v_mfma_f32_16x16x32_bf16 v[236:239], a[76:79], v[44:47], v[236:239]
    buffer_store_dwordx4 v[180:183], v7, s[8:11], 0 offen offset:576 nt
    v_mfma_f32_16x16x32_bf16 v[240:243], a[120:123], v[32:35], v[240:243]
    v_mfma_f32_16x16x32_bf16 v[240:243], a[124:127], v[44:47], v[240:243]
    v_mfma_f32_16x16x32_bf16 v[248:251], a[168:171], v[32:35], v[248:251]
    v_mfma_f32_16x16x32_bf16 v[248:251], a[172:175], v[44:47], v[248:251]
    ds_read_b128 a[200:203], v2 offset:8192
    v_mfma_f32_16x16x32_bf16 v[244:247], v[204:207], v[132:135], 0
    ds_read_b128 a[232:235], v2 offset:9216
    v_mfma_f32_16x16x32_bf16 v[244:247], v[60:63], v[68:71], v[244:247]
    v_mfma_f32_16x16x32_bf16 v[252:255], v[36:39], v[132:135], 0
    v_mfma_f32_16x16x32_bf16 v[252:255], v[168:171], v[68:71], v[252:255]
    s_waitcnt vmcnt(14)
    v_mfma_f32_16x16x32_bf16 v[208:211], v[156:159], v[112:115], v[208:211]
    global_load_dwordx4 v[24:27], v81, s[14:15] offset:-1024 sc1
    v_mfma_f32_16x16x32_bf16 v[208:211], a[228:231], v[152:155], v[208:211]
    v_mfma_f32_16x16x32_bf16 v[208:211], v[228:231], a[212:215], v[208:211]
    v_mfma_f32_16x16x32_bf16 v[208:211], a[248:251], a[216:219], v[208:211]
    s_waitcnt lgkmcnt(4)
    v_mfma_f32_16x16x32_bf16 v[220:223], a[32:35], a[196:199], v[220:223]
    v_cvt_pk_bf16_f32 v28, v244, v245
    v_cvt_pk_bf16_f32 v29, v246, v247
    v_mfma_f32_16x16x32_bf16 v[220:223], a[36:39], a[244:247], v[220:223]
    global_load_dwordx4 a[228:231], v81, s[14:15] sc1
    v_mfma_f32_16x16x32_bf16 v[236:239], a[80:83], a[196:199], v[236:239]
    v_cvt_pk_bf16_f32 v30, v252, v253
    v_cvt_pk_bf16_f32 v31, v254, v255
    v_mfma_f32_16x16x32_bf16 v[236:239], a[84:87], a[244:247], v[236:239]
    ds_read_b128 a[248:251], v3 offset:16384
    ds_read_b128 v[40:43], v2 offset:10240
    v_mfma_f32_16x16x32_bf16 v[240:243], a[128:131], a[196:199], v[240:243]
    ds_read_b128 v[64:67], v3 offset:18432
    ds_read_b128 v[92:95], v2 offset:11264
    v_mfma_f32_16x16x32_bf16 v[240:243], a[132:135], a[244:247], v[240:243]
    ds_read_b128 v[96:99], v3 offset:17408
    v_mfma_f32_16x16x32_bf16 v[248:251], a[176:179], a[196:199], v[248:251]
    ds_read_b128 v[100:103], v3 offset:19456
    v_cvt_pk_bf16_f32 v82, v208, v209
    v_mfma_f32_16x16x32_bf16 v[248:251], a[180:183], a[244:247], v[248:251]
    v_cvt_pk_bf16_f32 v83, v210, v211
    s_waitcnt lgkmcnt(8)
    v_mfma_f32_16x16x32_bf16 v[220:223], a[40:43], a[208:211], v[220:223]
    buffer_store_dwordx2 v[82:83], v17, s[8:11], 0 offen nt
    v_mfma_f32_16x16x32_bf16 v[220:223], a[44:47], v[232:235], v[220:223]
    v_mfma_f32_16x16x32_bf16 v[236:239], a[88:91], a[208:211], v[236:239]
    v_mfma_f32_16x16x32_bf16 v[236:239], a[92:95], v[232:235], v[236:239]
    ds_read_b128 a[196:199], v2 offset:12288
    ds_read_b128 a[244:247], v2 offset:13312
    v_mfma_f32_16x16x32_bf16 v[240:243], a[136:139], a[208:211], v[240:243]
    v_mfma_f32_16x16x32_bf16 v[240:243], a[140:143], v[232:235], v[240:243]
    v_mfma_f32_16x16x32_bf16 v[248:251], a[184:187], a[208:211], v[248:251]
    v_mfma_f32_16x16x32_bf16 v[248:251], a[188:191], v[232:235], v[248:251]
    s_waitcnt lgkmcnt(8)
    v_mfma_f32_16x16x32_bf16 v[116:119], a[0:3], a[200:203], 0
    v_cvt_pk_bf16_f32 v136, v220, v221
    v_cvt_pk_bf16_f32 v137, v222, v223
    v_mfma_f32_16x16x32_bf16 v[116:119], a[4:7], a[232:235], v[116:119]
    buffer_store_dwordx4 v[28:31], v8, s[8:11], 0 offen offset:576 nt
    v_mfma_f32_16x16x32_bf16 v[140:143], a[48:51], a[200:203], 0
    v_cvt_pk_bf16_f32 v138, v236, v237
    v_cvt_pk_bf16_f32 v139, v238, v239
    v_mfma_f32_16x16x32_bf16 v[140:143], a[52:55], a[232:235], v[140:143]
    ds_read_b128 a[208:211], v2 offset:14336
    ds_read_b128 v[144:147], v2 offset:15360
    v_mfma_f32_16x16x32_bf16 v[160:163], a[96:99], a[200:203], 0
    v_cvt_pk_bf16_f32 v172, v240, v241
    v_cvt_pk_bf16_f32 v173, v242, v243
    v_mfma_f32_16x16x32_bf16 v[160:163], a[100:103], a[232:235], v[160:163]
    v_mfma_f32_16x16x32_bf16 v[176:179], a[144:147], a[200:203], 0
    v_cvt_pk_bf16_f32 v82, v248, v249
    v_cvt_pk_bf16_f32 v83, v250, v251
    v_mfma_f32_16x16x32_bf16 v[176:179], a[148:151], a[232:235], v[176:179]
    s_waitcnt lgkmcnt(4)
    v_mfma_f32_16x16x32_bf16 v[200:203], a[248:251], v[164:167], 0
    ds_write_b64 v13, v[82:83] offset:5120
    v_mfma_f32_16x16x32_bf16 v[200:203], v[64:67], v[76:79], v[200:203]
    v_mfma_f32_16x16x32_bf16 v[224:227], v[96:99], v[164:167], 0
    global_load_dwordx4 a[200:203], v81, s[14:15] offset:1024 sc1
    v_mfma_f32_16x16x32_bf16 v[224:227], v[100:103], v[76:79], v[224:227]
    ds_read_b128 a[232:235], v2 offset:16384
    v_mfma_f32_16x16x32_bf16 v[116:119], a[8:11], v[40:43], v[116:119]
    ds_read_b128 a[248:251], v2 offset:17408
    v_mfma_f32_16x16x32_bf16 v[116:119], a[12:15], v[92:95], v[116:119]
    v_mfma_f32_16x16x32_bf16 v[140:143], a[56:59], v[40:43], v[140:143]
    v_mfma_f32_16x16x32_bf16 v[140:143], a[60:63], v[92:95], v[140:143]
    v_mfma_f32_16x16x32_bf16 v[160:163], a[104:107], v[40:43], v[160:163]
    v_cvt_pk_bf16_f32 v32, v200, v201
    v_cvt_pk_bf16_f32 v33, v202, v203
    v_mfma_f32_16x16x32_bf16 v[160:163], a[108:111], v[92:95], v[160:163]
    v_mfma_f32_16x16x32_bf16 v[176:179], a[152:155], v[40:43], v[176:179]
    v_cvt_pk_bf16_f32 v34, v224, v225
    v_cvt_pk_bf16_f32 v35, v226, v227
    v_mfma_f32_16x16x32_bf16 v[176:179], a[156:159], v[92:95], v[176:179]
    s_waitcnt lgkmcnt(5)
    v_mfma_f32_16x16x32_bf16 v[116:119], a[16:19], a[196:199], v[116:119]
    s_waitcnt lgkmcnt(2)
    s_barrier
    v_mfma_f32_16x16x32_bf16 v[116:119], a[20:23], a[244:247], v[116:119]
    buffer_store_dwordx4 v[32:35], v11, s[8:11], 0 offen offset:576 nt
    v_mfma_f32_16x16x32_bf16 v[140:143], a[64:67], a[196:199], v[140:143]
    v_mfma_f32_16x16x32_bf16 v[140:143], a[68:71], a[244:247], v[140:143]
    ds_read_b128 v[36:39], v2 offset:18432
    ds_read_b128 v[44:47], v2 offset:19456
    v_mfma_f32_16x16x32_bf16 v[160:163], a[112:115], a[196:199], v[160:163]
    ds_read_b64 v[218:219], v3 offset:22536
    v_mfma_f32_16x16x32_bf16 v[160:163], a[116:119], a[244:247], v[160:163]
    v_mfma_f32_16x16x32_bf16 v[176:179], a[160:163], a[196:199], v[176:179]
    ds_read_b64 v[174:175], v3 offset:23560
    v_mfma_f32_16x16x32_bf16 v[176:179], a[164:167], a[244:247], v[176:179]
    v_mfma_f32_16x16x32_bf16 v[116:119], a[24:27], a[208:211], v[116:119]
    v_mfma_f32_16x16x32_bf16 v[116:119], a[28:31], v[144:147], v[116:119]
    v_mfma_f32_16x16x32_bf16 v[140:143], a[72:75], a[208:211], v[140:143]
    v_mfma_f32_16x16x32_bf16 v[140:143], a[76:79], v[144:147], v[140:143]
    v_mfma_f32_16x16x32_bf16 v[160:163], a[120:123], a[208:211], v[160:163]
    v_mfma_f32_16x16x32_bf16 v[160:163], a[124:127], v[144:147], v[160:163]
    v_mfma_f32_16x16x32_bf16 v[176:179], a[168:171], a[208:211], v[176:179]
    v_mfma_f32_16x16x32_bf16 v[176:179], a[172:175], v[144:147], v[176:179]
    ds_read_b128 a[196:199], v2 offset:20480
    s_waitcnt lgkmcnt(5)
    v_mfma_f32_16x16x32_bf16 v[116:119], a[32:35], a[232:235], v[116:119]
    ds_read_b128 a[244:247], v2 offset:21504
    v_mfma_f32_16x16x32_bf16 v[116:119], a[36:39], a[248:251], v[116:119]
    v_mfma_f32_16x16x32_bf16 v[140:143], a[80:83], a[232:235], v[140:143]
    v_mfma_f32_16x16x32_bf16 v[140:143], a[84:87], a[248:251], v[140:143]
L_st9:
    s_cbranch_execz L_stdone
    v_mfma_f32_16x16x32_bf16 v[160:163], a[128:131], a[232:235], v[160:163]
    v_mfma_f32_16x16x32_bf16 v[160:163], a[132:135], a[248:251], v[160:163]
    ds_read_b128 a[208:211], v2 offset:22528
    ds_read_b128 v[60:63], v2 offset:23552
    v_mfma_f32_16x16x32_bf16 v[176:179], a[176:179], a[232:235], v[176:179]
    v_mfma_f32_16x16x32_bf16 v[176:179], a[180:183], a[248:251], v[176:179]
    s_waitcnt lgkmcnt(4)
    v_mfma_f32_16x16x32_bf16 v[128:131], v[188:191], v[48:51], 0
    v_mfma_f32_16x16x32_bf16 v[128:131], v[216:219], v[196:199], v[128:131]
    v_mfma_f32_16x16x32_bf16 v[156:159], v[136:139], v[48:51], 0
    v_mfma_f32_16x16x32_bf16 v[156:159], v[172:175], v[196:199], v[156:159]
    ds_read_b128 v[168:171], v3 offset:20480
    v_mfma_f32_16x16x32_bf16 v[116:119], a[40:43], v[36:39], v[116:119]
    ds_read_b128 a[232:235], v3 offset:22528
    ds_read_b128 a[248:251], v2 offset:24576
    v_mfma_f32_16x16x32_bf16 v[116:119], a[44:47], v[44:47], v[116:119]
    ds_read_b128 v[180:183], v3 offset:21504
    ds_read_b128 v[204:207], v2 offset:25600
    v_mfma_f32_16x16x32_bf16 v[140:143], a[88:91], v[36:39], v[140:143]
    ds_read_b128 v[208:211], v3 offset:23552
    v_mfma_f32_16x16x32_bf16 v[140:143], a[92:95], v[44:47], v[140:143]
    v_mfma_f32_16x16x32_bf16 v[160:163], a[136:139], v[36:39], v[160:163]
    v_cvt_pk_bf16_f32 v220, v128, v129
    v_cvt_pk_bf16_f32 v221, v130, v131
    v_mfma_f32_16x16x32_bf16 v[160:163], a[140:143], v[44:47], v[160:163]
    ds_read_b128 v[228:231], v2 offset:26624
    ds_read_b128 v[232:235], v2 offset:27648
    v_mfma_f32_16x16x32_bf16 v[176:179], a[184:187], v[36:39], v[176:179]
    v_cvt_pk_bf16_f32 v222, v156, v157
    v_cvt_pk_bf16_f32 v223, v158, v159
    v_mfma_f32_16x16x32_bf16 v[176:179], a[188:191], v[44:47], v[176:179]
    ds_read_b128 v[244:247], v2 offset:28672
    v_mfma_f32_16x16x32_bf16 v[252:255], v[188:191], v[184:187], 0
    ds_read_b128 v[28:31], v2 offset:29696
    v_cvt_pk_bf16_f32 v32, v116, v117
    v_mfma_f32_16x16x32_bf16 v[252:255], v[216:219], v[148:151], v[252:255]
    ds_read_b128 v[40:43], v2 offset:30720
    ds_read_b128 v[64:67], v2 offset:31744
    v_mfma_f32_16x16x32_bf16 v[80:83], v[136:139], v[184:187], 0
    buffer_store_dwordx4 v[220:223], v6, s[8:11], 0 offen offset:640 nt
    v_mfma_f32_16x16x32_bf16 v[80:83], v[172:175], v[148:151], v[80:83]
    v_cvt_pk_bf16_f32 v33, v118, v119
    s_waitcnt lgkmcnt(14)
    v_mfma_f32_16x16x32_bf16 v[92:95], a[144:147], a[196:199], 0
    v_cvt_pk_bf16_f32 v34, v140, v141
    v_cvt_pk_bf16_f32 v35, v142, v143
    v_mfma_f32_16x16x32_bf16 v[92:95], a[148:151], a[244:247], v[92:95]
    v_cvt_pk_bf16_f32 v96, v160, v161
    v_mfma_f32_16x16x32_bf16 v[100:103], v[188:191], v[132:135], 0
    v_cvt_pk_bf16_f32 v144, v176, v177
    v_cvt_pk_bf16_f32 v145, v178, v179
    v_mfma_f32_16x16x32_bf16 v[100:103], v[216:219], v[68:71], v[100:103]
    ds_write_b64 v13, v[144:145] offset:8192
    v_mfma_f32_16x16x32_bf16 v[200:203], v[136:139], v[132:135], 0
    v_cvt_pk_bf16_f32 v224, v252, v253
    v_cvt_pk_bf16_f32 v225, v254, v255
    v_mfma_f32_16x16x32_bf16 v[200:203], v[172:175], v[68:71], v[200:203]
    v_cvt_pk_bf16_f32 v97, v162, v163
    s_waitcnt lgkmcnt(13)
    v_mfma_f32_16x16x32_bf16 v[92:95], a[152:155], a[208:211], v[92:95]
    v_cvt_pk_bf16_f32 v226, v80, v81
    v_cvt_pk_bf16_f32 v227, v82, v83
    v_mfma_f32_16x16x32_bf16 v[92:95], a[156:159], v[60:63], v[92:95]
    s_waitcnt lgkmcnt(7)
    v_mfma_f32_16x16x32_bf16 v[236:239], v[168:171], v[164:167], 0
    buffer_store_dwordx4 v[224:227], v7, s[8:11], 0 offen offset:640 nt
    v_mfma_f32_16x16x32_bf16 v[236:239], a[232:235], v[76:79], v[236:239]
    v_mfma_f32_16x16x32_bf16 v[240:243], v[180:183], v[164:167], 0
    v_cvt_pk_bf16_f32 v248, v100, v101
    v_cvt_pk_bf16_f32 v249, v102, v103
    v_mfma_f32_16x16x32_bf16 v[240:243], v[208:211], v[76:79], v[240:243]
    v_mfma_f32_16x16x32_bf16 v[92:95], a[160:163], a[248:251], v[92:95]
    v_cvt_pk_bf16_f32 v250, v200, v201
    v_cvt_pk_bf16_f32 v251, v202, v203
    v_mfma_f32_16x16x32_bf16 v[92:95], a[164:167], v[204:207], v[92:95]
    v_mfma_f32_16x16x32_bf16 v[36:39], v[188:191], v[88:91], 0
    v_mfma_f32_16x16x32_bf16 v[36:39], v[216:219], v[120:123], v[36:39]
    v_mfma_f32_16x16x32_bf16 v[44:47], v[136:139], v[88:91], 0
    v_cvt_pk_bf16_f32 v80, v236, v237
    v_cvt_pk_bf16_f32 v81, v238, v239
    v_mfma_f32_16x16x32_bf16 v[44:47], v[172:175], v[120:123], v[44:47]
    s_waitcnt lgkmcnt(5)
    v_mfma_f32_16x16x32_bf16 v[92:95], a[168:171], v[228:231], v[92:95]
    s_waitcnt lgkmcnt(0)
    s_barrier
    v_mfma_f32_16x16x32_bf16 v[92:95], a[172:175], v[232:235], v[92:95]
    ds_read_b128 a[232:235], v3 offset:24576
    v_mfma_f32_16x16x32_bf16 v[92:95], a[176:179], v[244:247], v[92:95]
    ds_read_b128 v[116:119], v3 offset:26624
    ds_read_b64 v[98:99], v3 offset:26632
    v_mfma_f32_16x16x32_bf16 v[92:95], a[180:183], v[28:31], v[92:95]
    v_cvt_pk_bf16_f32 v82, v240, v241
    v_mfma_f32_16x16x32_bf16 v[92:95], a[184:187], v[40:43], v[92:95]
    v_cvt_pk_bf16_f32 v83, v242, v243
    v_cvt_pk_bf16_f32 v128, v36, v37
    v_mfma_f32_16x16x32_bf16 v[92:95], a[188:191], v[64:67], v[92:95]
    v_cvt_pk_bf16_f32 v129, v38, v39
    v_add_u32 v146, 49152, v5
    v_mfma_f32_16x16x32_bf16 v[140:143], a[0:3], a[196:199], 0
    v_cvt_pk_bf16_f32 v130, v44, v45
    v_cvt_pk_bf16_f32 v131, v46, v47
    v_mfma_f32_16x16x32_bf16 v[140:143], a[4:7], a[244:247], v[140:143]
    buffer_store_dwordx4 v[248:251], v8, s[8:11], 0 offen offset:640 nt
    v_mfma_f32_16x16x32_bf16 v[140:143], a[8:11], a[208:211], v[140:143]
    v_mfma_f32_16x16x32_bf16 v[140:143], a[12:15], v[60:63], v[140:143]
    v_mfma_f32_16x16x32_bf16 v[140:143], a[16:19], a[248:251], v[140:143]
    v_mfma_f32_16x16x32_bf16 v[140:143], a[20:23], v[204:207], v[140:143]
    v_mfma_f32_16x16x32_bf16 v[140:143], a[24:27], v[228:231], v[140:143]
    v_cvt_pk_bf16_f32 v144, v92, v93
    v_cvt_pk_bf16_f32 v145, v94, v95
    v_mfma_f32_16x16x32_bf16 v[140:143], a[28:31], v[232:235], v[140:143]
    ds_write_b64 v13, v[144:145] offset:9216
    v_mfma_f32_16x16x32_bf16 v[140:143], a[32:35], v[244:247], v[140:143]
    v_mfma_f32_16x16x32_bf16 v[140:143], a[36:39], v[28:31], v[140:143]
    v_mfma_f32_16x16x32_bf16 v[140:143], a[40:43], v[40:43], v[140:143]
    buffer_store_dwordx4 v[80:83], v11, s[8:11], 0 offen offset:640 nt
    v_mfma_f32_16x16x32_bf16 v[140:143], a[44:47], v[64:67], v[140:143]
    s_waitcnt lgkmcnt(2)
    v_mfma_f32_16x16x32_bf16 v[156:159], a[232:235], v[164:167], 0
    v_mfma_f32_16x16x32_bf16 v[156:159], v[116:119], v[76:79], v[156:159]
    s_waitcnt lgkmcnt(1)
    v_mfma_f32_16x16x32_bf16 v[160:163], v[32:35], v[88:91], 0
    v_mfma_f32_16x16x32_bf16 v[160:163], v[96:99], v[120:123], v[160:163]
    v_mfma_f32_16x16x32_bf16 v[168:171], v[32:35], v[48:51], 0
    s_waitcnt lgkmcnt(0)
    s_barrier
    v_mfma_f32_16x16x32_bf16 v[168:171], v[96:99], v[196:199], v[168:171]
    ds_read_b128 a[232:235], v3 offset:25600
    v_mfma_f32_16x16x32_bf16 v[176:179], v[32:35], v[184:187], 0
    ds_read_b128 v[180:183], v3 offset:27648
    v_cvt_pk_bf16_f32 v220, v140, v141
    v_mfma_f32_16x16x32_bf16 v[176:179], v[96:99], v[148:151], v[176:179]
    v_cvt_pk_bf16_f32 v221, v142, v143
    v_mfma_f32_16x16x32_bf16 v[224:227], v[32:35], v[132:135], 0
    buffer_store_dwordx4 v[128:131], v10, s[8:11], 0 offen offset:640 nt
    v_mfma_f32_16x16x32_bf16 v[224:227], v[96:99], v[68:71], v[224:227]
    v_cvt_pk_bf16_f32 v252, v156, v157
    v_cvt_pk_bf16_f32 v253, v158, v159
    v_mfma_f32_16x16x32_bf16 v[36:39], a[48:51], a[196:199], 0
    v_cvt_pk_bf16_f32 v44, v160, v161
    v_cvt_pk_bf16_f32 v45, v162, v163
    v_mfma_f32_16x16x32_bf16 v[36:39], a[52:55], a[244:247], v[36:39]
    v_mfma_f32_16x16x32_bf16 v[36:39], a[56:59], a[208:211], v[36:39]
    v_cvt_pk_bf16_f32 v32, v168, v169
    v_cvt_pk_bf16_f32 v33, v170, v171
    v_mfma_f32_16x16x32_bf16 v[36:39], a[60:63], v[60:63], v[36:39]
    v_mfma_f32_16x16x32_bf16 v[36:39], a[64:67], a[248:251], v[36:39]
    v_cvt_pk_bf16_f32 v80, v176, v177
    v_cvt_pk_bf16_f32 v81, v178, v179
    v_mfma_f32_16x16x32_bf16 v[36:39], a[68:71], v[204:207], v[36:39]
    ds_read_b128 v[92:95], v146
    v_mfma_f32_16x16x32_bf16 v[36:39], a[72:75], v[228:231], v[36:39]
    ds_read_b128 v[96:99], v146 offset:1024
    v_cvt_pk_bf16_f32 v100, v224, v225
    v_mfma_f32_16x16x32_bf16 v[36:39], a[76:79], v[232:235], v[36:39]
    ds_read_b128 v[116:119], v146 offset:2048
    v_cvt_pk_bf16_f32 v101, v226, v227
    v_mfma_f32_16x16x32_bf16 v[36:39], a[80:83], v[244:247], v[36:39]
    ds_read_b128 v[128:131], v146 offset:3072
    v_mfma_f32_16x16x32_bf16 v[36:39], a[84:87], v[28:31], v[36:39]
    v_mfma_f32_16x16x32_bf16 v[36:39], a[88:91], v[40:43], v[36:39]
    ds_read_b64 v[138:139], v3 offset:27656
    v_mfma_f32_16x16x32_bf16 v[36:39], a[92:95], v[64:67], v[36:39]
    ds_read_b128 v[140:143], v146 offset:4096
    s_waitcnt lgkmcnt(6)
    v_mfma_f32_16x16x32_bf16 v[172:175], a[232:235], v[164:167], 0
    ds_read_b128 v[188:191], v146 offset:5120
    v_mfma_f32_16x16x32_bf16 v[172:175], v[180:183], v[76:79], v[172:175]
    ds_read_b128 v[200:203], v146 offset:6144
    v_mfma_f32_16x16x32_bf16 v[208:211], a[96:99], a[196:199], 0
    ds_read_b128 v[216:219], v146 offset:7168
    v_mfma_f32_16x16x32_bf16 v[208:211], a[100:103], a[244:247], v[208:211]
    ds_read_b128 a[232:235], v146 offset:8192
    v_mfma_f32_16x16x32_bf16 v[208:211], a[104:107], a[208:211], v[208:211]
    ds_read_b128 v[236:239], v146 offset:9216
    v_mfma_f32_16x16x32_bf16 v[208:211], a[108:111], v[60:63], v[208:211]
    ds_read_b128 a[196:199], v146 offset:10240
    v_mfma_f32_16x16x32_bf16 v[208:211], a[112:115], a[248:251], v[208:211]
    v_cvt_pk_bf16_f32 v222, v36, v37
    v_cvt_pk_bf16_f32 v223, v38, v39
    v_mfma_f32_16x16x32_bf16 v[208:211], a[116:119], v[204:207], v[208:211]
    ds_read_b128 a[208:211], v146 offset:11264
    ds_read_b128 a[244:247], v5
    v_mfma_f32_16x16x32_bf16 v[208:211], a[120:123], v[228:231], v[208:211]
    v_cvt_pk_bf16_f32 v254, v172, v173
    v_cvt_pk_bf16_f32 v255, v174, v175
    v_mfma_f32_16x16x32_bf16 v[208:211], a[124:127], v[232:235], v[208:211]
    buffer_store_dwordx4 v[252:255], v11, s[8:11], 0 offen offset:704 nt
    v_mfma_f32_16x16x32_bf16 v[208:211], a[128:131], v[244:247], v[208:211]
    ds_read_b128 a[248:251], v5 offset:1024
    ds_read_b128 v[240:243], v5 offset:2048
    v_mfma_f32_16x16x32_bf16 v[208:211], a[132:135], v[28:31], v[208:211]
    ds_read_b128 v[248:251], v5 offset:3072
    v_mfma_f32_16x16x32_bf16 v[208:211], a[136:139], v[40:43], v[208:211]
    v_mfma_f32_16x16x32_bf16 v[208:211], a[140:143], v[64:67], v[208:211]
    ds_read_b128 v[36:39], v5 offset:4096
    s_waitcnt lgkmcnt(14)
    v_mfma_f32_16x16x32_bf16 v[60:63], v[92:95], a[220:223], 0
    ds_read_b128 v[76:79], v5 offset:5120
    v_mfma_f32_16x16x32_bf16 v[60:63], v[96:99], a[224:227], v[60:63]
    ds_read_b128 v[28:31], v5 offset:6144
    v_mfma_f32_16x16x32_bf16 v[60:63], v[116:119], a[236:239], v[60:63]
    s_nop 0
    v_cvt_pk_bf16_f32 v136, v208, v209
    v_cvt_pk_bf16_f32 v137, v210, v211
    v_mfma_f32_16x16x32_bf16 v[60:63], v[128:131], a[240:243], v[60:63]
    ds_read_b128 v[40:43], v5 offset:7168
    s_waitcnt lgkmcnt(15)
    v_mfma_f32_16x16x32_bf16 v[64:67], v[220:223], v[48:51], 0
    ds_read_b128 v[92:95], v5 offset:8192
    ds_read_b128 v[96:99], v5 offset:9216
    v_mfma_f32_16x16x32_bf16 v[64:67], v[136:139], v[196:199], v[64:67]
    ds_read_b128 v[116:119], v5 offset:10240
    s_waitcnt lgkmcnt(15)
    v_mfma_f32_16x16x32_bf16 v[60:63], v[140:143], v[52:55], v[60:63]
    ds_read_b128 v[144:147], v5 offset:11264
    v_mfma_f32_16x16x32_bf16 v[60:63], v[188:191], a[252:255], v[60:63]
    v_mfma_f32_16x16x32_bf16 v[60:63], v[200:203], v[72:75], v[60:63]
    v_mfma_f32_16x16x32_bf16 v[60:63], v[216:219], a[204:207], v[60:63]
    s_waitcnt lgkmcnt(12)
    v_mfma_f32_16x16x32_bf16 v[60:63], a[232:235], v[112:115], v[60:63]
    v_mfma_f32_16x16x32_bf16 v[60:63], v[236:239], v[152:155], v[60:63]
    v_mfma_f32_16x16x32_bf16 v[60:63], a[196:199], a[212:215], v[60:63]
    v_cvt_pk_bf16_f32 v34, v64, v65
    v_cvt_pk_bf16_f32 v35, v66, v67
    v_mfma_f32_16x16x32_bf16 v[60:63], a[208:211], a[216:219], v[60:63]
    s_waitcnt lgkmcnt(8)
    v_mfma_f32_16x16x32_bf16 v[156:159], a[244:247], a[220:223], 0
    buffer_store_dwordx4 v[32:35], v6, s[8:11], 0 offen offset:704 nt
    v_mfma_f32_16x16x32_bf16 v[156:159], a[248:251], a[224:227], v[156:159]
    v_mfma_f32_16x16x32_bf16 v[156:159], v[240:243], a[236:239], v[156:159]
    v_mfma_f32_16x16x32_bf16 v[156:159], v[248:251], a[240:243], v[156:159]
    v_mfma_f32_16x16x32_bf16 v[160:163], v[220:223], v[184:187], 0
    v_mfma_f32_16x16x32_bf16 v[160:163], v[136:139], v[148:151], v[160:163]
    s_waitcnt lgkmcnt(4)
    v_mfma_f32_16x16x32_bf16 v[156:159], v[36:39], v[52:55], v[156:159]
    v_cvt_pk_bf16_f32 v164, v60, v61
    v_cvt_pk_bf16_f32 v165, v62, v63
    v_mfma_f32_16x16x32_bf16 v[156:159], v[76:79], a[252:255], v[156:159]
    v_mfma_f32_16x16x32_bf16 v[156:159], v[28:31], v[72:75], v[156:159]
    v_mfma_f32_16x16x32_bf16 v[156:159], v[40:43], a[204:207], v[156:159]
    s_waitcnt lgkmcnt(0)
    v_mfma_f32_16x16x32_bf16 v[156:159], v[92:95], v[112:115], v[156:159]
    buffer_store_dwordx2 v[164:165], v17, s[8:11], 0 offen offset:640 nt
    v_mfma_f32_16x16x32_bf16 v[156:159], v[96:99], v[152:155], v[156:159]
    v_mfma_f32_16x16x32_bf16 v[156:159], v[116:119], a[212:215], v[156:159]
    v_cvt_pk_bf16_f32 v82, v160, v161
    v_cvt_pk_bf16_f32 v83, v162, v163
    v_mfma_f32_16x16x32_bf16 v[156:159], v[144:147], a[216:219], v[156:159]
    v_mfma_f32_16x16x32_bf16 v[168:171], v[220:223], v[132:135], 0
    buffer_store_dwordx4 v[80:83], v7, s[8:11], 0 offen offset:704 nt
    v_mfma_f32_16x16x32_bf16 v[168:171], v[136:139], v[68:71], v[168:171]
    s_waitcnt vmcnt(23)
    v_mfma_f32_16x16x32_bf16 v[172:175], v[212:215], a[220:223], 0
    v_mfma_f32_16x16x32_bf16 v[172:175], v[20:23], a[224:227], v[172:175]
    v_mfma_f32_16x16x32_bf16 v[172:175], v[84:87], a[236:239], v[172:175]
    v_mfma_f32_16x16x32_bf16 v[172:175], v[104:107], a[240:243], v[172:175]
    s_waitcnt vmcnt(18)
    v_mfma_f32_16x16x32_bf16 v[172:175], v[108:111], v[52:55], v[172:175]
    v_cvt_pk_bf16_f32 v166, v156, v157
    v_cvt_pk_bf16_f32 v167, v158, v159
    v_mfma_f32_16x16x32_bf16 v[172:175], v[192:195], a[252:255], v[172:175]
    v_mfma_f32_16x16x32_bf16 v[172:175], v[56:59], v[72:75], v[172:175]
    v_cvt_pk_bf16_f32 v102, v168, v169
    v_cvt_pk_bf16_f32 v103, v170, v171
    v_mfma_f32_16x16x32_bf16 v[172:175], v[124:127], a[204:207], v[172:175]
    v_mfma_f32_16x16x32_bf16 v[176:179], v[220:223], v[88:91], 0
    buffer_store_dwordx4 v[100:103], v8, s[8:11], 0 offen offset:704 nt
    v_mfma_f32_16x16x32_bf16 v[176:179], v[136:139], v[120:123], v[176:179]
    s_waitcnt vmcnt(11)
    v_mfma_f32_16x16x32_bf16 v[172:175], a[192:195], v[112:115], v[172:175]
    v_mfma_f32_16x16x32_bf16 v[172:175], v[24:27], v[152:155], v[172:175]
    v_mfma_f32_16x16x32_bf16 v[172:175], a[228:231], a[212:215], v[172:175]
    v_mfma_f32_16x16x32_bf16 v[172:175], a[200:203], a[216:219], v[172:175]
    s_nop 7
    v_cvt_pk_bf16_f32 v164, v172, v173
    v_cvt_pk_bf16_f32 v165, v174, v175
    buffer_store_dwordx2 v[164:165], v17, s[8:11], 0 offen offset:128 nt
    buffer_store_dwordx2 v[166:167], v17, s[8:11], 0 offen offset:512 nt
    v_cvt_pk_bf16_f32 v46, v176, v177
    v_cvt_pk_bf16_f32 v47, v178, v179
    buffer_store_dwordx4 v[44:47], v10, s[8:11], 0 offen offset:704 nt
    s_endpgm
L_slowC:
    s_mov_b32 s40, 0
L_slowC_loop:
    global_load_dword v213, v212, s[32:33] offset:68 sc1
    s_waitcnt vmcnt(0)
    v_cmp_gt_u32 vcc, 72, v213
    s_add_u32 s40, s40, 1
    s_nop 0
    s_cbranch_vccz L_backC
    s_sleep 1
    s_cmp_lt_u32 s40, 400000
    s_cbranch_scc1 L_slowC_loop
    s_branch L_backC
L_slowN:
    s_mov_b32 s40, 0
L_slowN_loop:
    global_load_dword v142, v140, s[32:33] offset:192 sc1
    s_waitcnt vmcnt(0)
    v_cmp_gt_u32 vcc, 72, v142
    s_add_u32 s40, s40, 1
    s_nop 0
    s_cbranch_vccz L_backN
    s_sleep 1
    s_cmp_lt_u32 s40, 400000
    s_cbranch_scc1 L_slowN_loop
    s_branch L_backN
L_end:
    s_endpgm
.fill 64, 4, 0xbf800000
.section .rodata,"a"
.p2align 6
.amdhsa_kernel standalone__swin_window_attn__vision_kernel
  .amdhsa_next_free_vgpr 512
  .amdhsa_next_free_sgpr 102
  .amdhsa_accum_offset 256
  .amdhsa_group_segment_fixed_size 0
  .amdhsa_kernarg_size 48
  .amdhsa_user_sgpr_count 2
  .amdhsa_user_sgpr_kernarg_segment_ptr 1
  .amdhsa_system_sgpr_workgroup_id_x 1
.end_amdhsa_kernel
```
